```python
import torch

def _softmax(x, axis=-1):
    return torch.softmax(x, dim=axis)
def _gelu(x):
    return torch.nn.functional.gelu(x, approximate="tanh")
def _silu(x):
    return torch.nn.functional.silu(x)
def _sigmoid(x):
    return torch.sigmoid(x)
def _layernorm(x, axis=-1, eps=1e-5):
    m = x.mean(dim=axis, keepdim=True)
    v = x.var(dim=axis, keepdim=True, unbiased=False)
    return (x - m) / torch.sqrt(v + eps)
def _scatter_add(tgt, idx, src, axis=0):
    return tgt.clone().index_add_(axis, idx, src)
def _segment_sum(src, seg, n):
    out = torch.zeros((n,) + src.shape[1:], dtype=src.dtype)
    return out.index_add_(0, seg, src)
def _pad(x, pw):
    flat = tuple(v for pair in reversed(pw) for v in pair)
    return torch.nn.functional.pad(x, flat)

kernel_name = 'gated_mix__grouped_kv_mqa__dense_activation_squared_relu__prompt'

def setup_inputs():

    _w = (lambda a: (lambda t: t.to(torch.bfloat16) if t.is_floating_point() else t)(torch.as_tensor(a)))
    def _A_setup():
        B, S, D, H = 1, 2048, 1024, 32
        Dh = D // H
        return {
            "x": _w((lambda *s: torch.randn(*s, dtype=torch.bfloat16) * 0.05)(B, S, D)),
            "wq": _w((lambda *s: torch.randn(*s, dtype=torch.bfloat16) * 0.8)(D, H * Dh)),
            "wk": _w((lambda *s: torch.randn(*s, dtype=torch.bfloat16) * 0.8)(D, Dh)),
            "wv": _w((lambda *s: torch.randn(*s, dtype=torch.bfloat16) * 0.1)(D, Dh)),
            "wo": _w((lambda *s: torch.randn(*s, dtype=torch.bfloat16) * 0.1)(H * Dh, D)),
        }
    _A_in = _A_setup()

    def _B_setup():
        B, S, D, F = 1, 2048, 1024, 3584
        return {
            "x": _w((lambda *s: torch.randn(*s, dtype=torch.bfloat16) * 0.05)(B, S, D)),
            "w1": _w((lambda *s: torch.randn(*s, dtype=torch.bfloat16) * 0.05)(D, F)),
            "b1": _w((lambda *s: torch.randn(*s, dtype=torch.bfloat16) * 0.05)(F)),
            "w2": _w((lambda *s: torch.randn(*s, dtype=torch.bfloat16) * 0.05)(F, D)),
            "b2": _w((lambda *s: torch.randn(*s, dtype=torch.bfloat16) * 0.05)(D)),
        }
    _B_in = _B_setup()

    return {
        "A_x": _A_in["x"],
        "A_wq": _A_in["wq"],
        "A_wk": _A_in["wk"],
        "A_wv": _A_in["wv"],
        "A_wo": _A_in["wo"],
        "B_x": _B_in["x"],
        "B_w1": _B_in["w1"],
        "B_b1": _B_in["b1"],
        "B_w2": _B_in["w2"],
        "B_b2": _B_in["b2"],
        "gate_w": _w((lambda *s: torch.randn(*s, dtype=torch.bfloat16) * 0.05)(1024) * 16.0),
    }

def reference(A_x, A_wq, A_wk, A_wv, A_wo, B_x, B_w1, B_b1, B_w2, B_b2, gate_w):
    def _A_ref(x, wq, wk, wv, wo):
        B, S, D = x.shape
        H = 32
        Dh = D // H
        q = (lambda x, *d: x.permute(*d))((x @ wq).reshape(B, S, H, Dh), 0, 2, 1, 3)
        k = x @ wk
        v = x @ wv
        scores = torch.einsum("bhqd,bkd->bhqk", q, k) * (Dh ** -0.5)
        p = _softmax(scores, axis=-1)
        o = torch.einsum("bhqk,bkd->bhqd", p, v)
        return (lambda x, *d: x.permute(*d))(o, 0, 2, 1, 3).reshape(B, S, H * Dh) @ wo

    def _B_ref(x, w1, b1, w2, b2):
        h = torch.einsum("bsd,df->bsf", x, w1) + b1
        zero = torch.zeros_like(h)
        r = torch.where(h > zero, h, zero)
        h = r * r
        out = torch.einsum("bsf,fd->bsd", h, w2) + b2
        return out

    x = A_x
    g = _sigmoid((x * gate_w).sum(-1, keepdims=True))
    a = _A_ref(x, A_wq, A_wk, A_wv, A_wo)
    b = _B_ref(x, B_w1, B_b1, B_w2, B_b2)
    return g * a + (1 - g) * b
```

```asm
; @launch grid=(256,1,1) block=(512,1,1) lds=158208
.amdgcn_target "amdgcn-amd-amdhsa--gfx950"
.text
.globl gated_mix__grouped_kv_mqa__dense_activation_squared_relu__prompt_kernel
.p2align 8
.type gated_mix__grouped_kv_mqa__dense_activation_squared_relu__prompt_kernel,@function
gated_mix__grouped_kv_mqa__dense_activation_squared_relu__prompt_kernel:
  s_cmp_ge_u32 s2, 256
  s_cbranch_scc1 L_exit
  s_load_dwordx16 s[4:19], s[0:1], 0
  s_load_dwordx8 s[20:27], s[0:1], 64
  s_load_dwordx4 s[28:31], s[0:1], 96
  v_lshrrev_b32 v1, 6, v0
  v_and_b32 v0, 63, v0
  v_readfirstlane_b32 s3, v1
  s_lshr_b32 s68, s2, 3
  s_and_b32 s70, s2, 7
  s_lshr_b32 s71, s70, 2
  s_lshl_b32 s71, s71, 3
  s_lshr_b32 s72, s68, 2
  s_add_u32 s64, s71, s72
  s_and_b32 s71, s70, 3
  s_lshl_b32 s71, s71, 2
  s_and_b32 s72, s68, 3
  s_add_u32 s65, s71, s72
  s_lshr_b32 s71, s70, 2
  s_lshl_b32 s71, s71, 3
  s_lshr_b32 s72, s68, 2
  s_add_u32 s66, s71, s72
  s_and_b32 s71, s70, 3
  s_and_b32 s72, s68, 3
  s_lshl_b32 s72, s72, 2
  s_add_u32 s67, s71, s72
  s_xor_b32 s67, s67, 1
  s_mov_b32 s101, s65
  s_mov_b32 s72, 0x76542310
  s_mov_b32 s73, 0xfedcba98
  s_lshl_b32 s71, s101, 2
  s_lshr_b64 s[72:73], s[72:73], s71
  s_and_b32 s100, s72, 15
  s_and_b32 s69, s3, 3
  v_and_b32 v1, 15, v0
  v_lshrrev_b32 v2, 4, v0
  s_cmp_lt_u32 s3, 4
  s_cbranch_scc1 L_roleG
  s_setprio 2
  v_lshrrev_b32 v16, 3, v0
  v_lshlrev_b32 v16, 11, v16
  v_and_b32 v17, 7, v0
  v_xor_b32 v18, v17, v2
  v_lshl_add_u32 v18, v18, 4, v16
  v_and_b32 v20, 1, v2
  v_lshlrev_b32 v20, 2, v20
  v_xor_b32 v20, v20, v17
  v_lshl_add_u32 v148, v20, 4, v16
  v_xor_b32 v19, 32, v148
  v_add_u32 v149, 15360, v19
  s_lshl2_add_u32 s82, s64, s69
  s_lshl_b32 s82, s82, 16
  v_xor_b32 v19, 0, v18
  v_add_u32 v144, 0, v19
  v_xor_b32 v19, 64, v18
  v_add_u32 v145, 15360, v19
  v_xor_b32 v19, 0, v18
  v_add_u32 v146, 30720, v19
  v_xor_b32 v19, 64, v18
  v_add_u32 v147, 46080, v19
  s_mul_i32 s70, s69, 114688
  s_mul_i32 s71, s65, 448
  s_add_u32 s81, s70, s71
  s_mul_i32 s80, s69, 7168
  s_movk_i32 s72, 6720
  v_add_u32 v16, 0, v0
  v_mul_u32_u24 v17, 2341, v16
  v_lshrrev_b32 v17, 16, v17
  v_bfe_u32 v18, v17, 3, 1
  v_lshlrev_b32 v18, 1, v18
  v_xor_b32 v16, v16, v18
  v_lshlrev_b32 v16, 4, v16
  v_mad_u32_u24 v3, v17, s72, v16
  v_add_u32 v16, 64, v0
  v_mul_u32_u24 v17, 2341, v16
  v_lshrrev_b32 v17, 16, v17
  v_bfe_u32 v18, v17, 3, 1
  v_lshlrev_b32 v18, 1, v18
  v_xor_b32 v16, v16, v18
  v_lshlrev_b32 v16, 4, v16
  v_mad_u32_u24 v4, v17, s72, v16
  v_subrev_u32 v4, 1024, v4
  s_waitcnt lgkmcnt(0)
  s_mov_b32 s48, s30
  s_mov_b32 s49, s31
  s_mov_b32 s50, 19300352
  s_mov_b32 s51, 0x20000
  s_mov_b32 s32, s4
  s_mov_b32 s33, s5
  s_mov_b32 s34, 4194304
  s_mov_b32 s35, 0x20000
  s_mov_b32 s56, s6
  s_mov_b32 s57, s7
  s_mov_b32 s58, 2097152
  s_mov_b32 s59, 0x20000
  s_mov_b32 s36, s16
  s_mov_b32 s37, s17
  s_mov_b32 s38, 7340032
  s_mov_b32 s39, 0x20000
  s_lshl_b32 s15, s69, 12
  s_lshl_b32 s18, s69, 11
  s_lshl_b32 s14, s69, 15
  s_lshl_b32 s70, s100, 7
  s_add_u32 s14, s14, s70
  s_add_u32 s70, s64, s101
  s_bitcmp1_b32 s70, 0
  s_cbranch_scc0 L_d0a
  s_add_u32 m0, s80, 0
  s_nop 0
  buffer_load_dwordx4 v3, s[36:39], s81 offen offset:0 lds
  buffer_load_dwordx4 v4, s[36:39], s81 offen offset:1024 lds
  v_add_u32 v16, 128, v0
  v_mul_u32_u24 v17, 2341, v16
  v_lshrrev_b32 v17, 16, v17
  v_bfe_u32 v18, v17, 3, 1
  v_lshlrev_b32 v18, 1, v18
  v_xor_b32 v16, v16, v18
  v_lshlrev_b32 v16, 4, v16
  v_mad_u32_u24 v5, v17, s72, v16
  v_subrev_u32 v5, 2048, v5
  buffer_load_dwordx4 v5, s[36:39], s81 offen offset:2048 lds
  v_add_u32 v16, 192, v0
  v_mul_u32_u24 v17, 2341, v16
  v_lshrrev_b32 v17, 16, v17
  v_bfe_u32 v18, v17, 3, 1
  v_lshlrev_b32 v18, 1, v18
  v_xor_b32 v16, v16, v18
  v_lshlrev_b32 v16, 4, v16
  v_mad_u32_u24 v6, v17, s72, v16
  v_subrev_u32 v6, 3072, v6
  buffer_load_dwordx4 v6, s[36:39], s81 offen offset:3072 lds
  v_add_u32 v16, 256, v0
  v_mul_u32_u24 v17, 2341, v16
  v_lshrrev_b32 v17, 16, v17
  v_bfe_u32 v18, v17, 3, 1
  v_lshlrev_b32 v18, 1, v18
  v_xor_b32 v16, v16, v18
  v_lshlrev_b32 v16, 4, v16
  v_mad_u32_u24 v7, v17, s72, v16
  s_add_u32 m0, s80, 4096
  s_nop 0
  buffer_load_dwordx4 v7, s[36:39], s81 offen offset:0 lds
  v_add_u32 v16, 320, v0
  v_mul_u32_u24 v17, 2341, v16
  v_lshrrev_b32 v17, 16, v17
  v_bfe_u32 v18, v17, 3, 1
  v_lshlrev_b32 v18, 1, v18
  v_xor_b32 v16, v16, v18
  v_lshlrev_b32 v16, 4, v16
  v_mad_u32_u24 v8, v17, s72, v16
  v_subrev_u32 v8, 1024, v8
  buffer_load_dwordx4 v8, s[36:39], s81 offen offset:1024 lds
  v_add_u32 v16, 384, v0
  v_mul_u32_u24 v17, 2341, v16
  v_lshrrev_b32 v17, 16, v17
  v_bfe_u32 v18, v17, 3, 1
  v_lshlrev_b32 v18, 1, v18
  v_xor_b32 v16, v16, v18
  v_lshlrev_b32 v16, 4, v16
  v_mad_u32_u24 v9, v17, s72, v16
  v_subrev_u32 v9, 2048, v9
  buffer_load_dwordx4 v9, s[36:39], s81 offen offset:2048 lds
  s_add_u32 s81, s81, 458752
  s_add_u32 m0, s15, 73728
  s_nop 0
  buffer_load_dwordx4 v144, s[32:35], s82 offen offset:0 lds
  buffer_load_dwordx4 v145, s[32:35], s82 offen offset:1024 lds
  buffer_load_dwordx4 v146, s[32:35], s82 offen offset:2048 lds
  buffer_load_dwordx4 v147, s[32:35], s82 offen offset:3072 lds
  s_add_u32 s82, s82, 128
  s_add_u32 m0, s18, 57344
  s_nop 0
  buffer_load_dwordx4 v148, s[56:59], s14 offen offset:0 lds
  buffer_load_dwordx4 v149, s[56:59], s14 offen offset:1024 lds
  s_add_u32 s14, s14, 131072
  s_branch L_d0b
L_d0a:
  s_add_u32 m0, s15, 73728
  s_nop 0
  buffer_load_dwordx4 v144, s[32:35], s82 offen offset:0 lds
  buffer_load_dwordx4 v145, s[32:35], s82 offen offset:1024 lds
  buffer_load_dwordx4 v146, s[32:35], s82 offen offset:2048 lds
  buffer_load_dwordx4 v147, s[32:35], s82 offen offset:3072 lds
  s_add_u32 s82, s82, 128
  s_add_u32 m0, s18, 57344
  s_nop 0
  buffer_load_dwordx4 v148, s[56:59], s14 offen offset:0 lds
  buffer_load_dwordx4 v149, s[56:59], s14 offen offset:1024 lds
  s_add_u32 s14, s14, 131072
  s_add_u32 m0, s80, 0
  s_nop 0
  buffer_load_dwordx4 v3, s[36:39], s81 offen offset:0 lds
  buffer_load_dwordx4 v4, s[36:39], s81 offen offset:1024 lds
  v_add_u32 v16, 128, v0
  v_mul_u32_u24 v17, 2341, v16
  v_lshrrev_b32 v17, 16, v17
  v_bfe_u32 v18, v17, 3, 1
  v_lshlrev_b32 v18, 1, v18
  v_xor_b32 v16, v16, v18
  v_lshlrev_b32 v16, 4, v16
  v_mad_u32_u24 v5, v17, s72, v16
  v_subrev_u32 v5, 2048, v5
  buffer_load_dwordx4 v5, s[36:39], s81 offen offset:2048 lds
  v_add_u32 v16, 192, v0
  v_mul_u32_u24 v17, 2341, v16
  v_lshrrev_b32 v17, 16, v17
  v_bfe_u32 v18, v17, 3, 1
  v_lshlrev_b32 v18, 1, v18
  v_xor_b32 v16, v16, v18
  v_lshlrev_b32 v16, 4, v16
  v_mad_u32_u24 v6, v17, s72, v16
  v_subrev_u32 v6, 3072, v6
  buffer_load_dwordx4 v6, s[36:39], s81 offen offset:3072 lds
  v_add_u32 v16, 256, v0
  v_mul_u32_u24 v17, 2341, v16
  v_lshrrev_b32 v17, 16, v17
  v_bfe_u32 v18, v17, 3, 1
  v_lshlrev_b32 v18, 1, v18
  v_xor_b32 v16, v16, v18
  v_lshlrev_b32 v16, 4, v16
  v_mad_u32_u24 v7, v17, s72, v16
  s_add_u32 m0, s80, 4096
  s_nop 0
  buffer_load_dwordx4 v7, s[36:39], s81 offen offset:0 lds
  v_add_u32 v16, 320, v0
  v_mul_u32_u24 v17, 2341, v16
  v_lshrrev_b32 v17, 16, v17
  v_bfe_u32 v18, v17, 3, 1
  v_lshlrev_b32 v18, 1, v18
  v_xor_b32 v16, v16, v18
  v_lshlrev_b32 v16, 4, v16
  v_mad_u32_u24 v8, v17, s72, v16
  v_subrev_u32 v8, 1024, v8
  buffer_load_dwordx4 v8, s[36:39], s81 offen offset:1024 lds
  v_add_u32 v16, 384, v0
  v_mul_u32_u24 v17, 2341, v16
  v_lshrrev_b32 v17, 16, v17
  v_bfe_u32 v18, v17, 3, 1
  v_lshlrev_b32 v18, 1, v18
  v_xor_b32 v16, v16, v18
  v_lshlrev_b32 v16, 4, v16
  v_mad_u32_u24 v9, v17, s72, v16
  v_subrev_u32 v9, 2048, v9
  buffer_load_dwordx4 v9, s[36:39], s81 offen offset:2048 lds
  s_add_u32 s81, s81, 458752
L_d0b:
  s_setprio 1
  s_waitcnt vmcnt(6)
  s_cmp_eq_u32 s69, 3
  s_cbranch_scc1 L_st2
L_st0:
  s_add_u32 m0, s15, 90112
  s_nop 0
  buffer_load_dwordx4 v144, s[32:35], s82 offen offset:0 lds
  buffer_load_dwordx4 v145, s[32:35], s82 offen offset:1024 lds
  buffer_load_dwordx4 v146, s[32:35], s82 offen offset:2048 lds
  buffer_load_dwordx4 v147, s[32:35], s82 offen offset:3072 lds
  s_add_u32 s82, s82, 128
  s_add_u32 m0, s18, 65536
  s_nop 0
  buffer_load_dwordx4 v148, s[56:59], s14 offen offset:0 lds
  buffer_load_dwordx4 v149, s[56:59], s14 offen offset:1024 lds
  s_add_u32 s14, s14, 131072
  s_waitcnt vmcnt(6)
  s_barrier
  s_branch L_a1m0
L_st2:
  s_and_b32 s83, s68, 7
  s_lshl_b32 s70, s83, 5
  s_and_b32 s71, s2, 4
  s_lshl2_add_u32 s70, s71, s70
  s_lshr_b32 s71, s68, 3
  s_lshl2_add_u32 s70, s71, s70
  s_and_b32 s71, s2, 3
  s_mul_i32 s19, s70, 7168
  s_mul_i32 s72, s71, 1792
  s_add_u32 s19, s19, s72
  s_lshl2_add_u32 s22, s70, s71
  s_lshl_b32 s22, s22, 9
  s_and_b32 s71, s2, 7
  s_lshl_b32 s71, s71, 5
  s_add_u32 s71, s71, s68
  s_lshl_b32 s76, s71, 14
  v_lshrrev_b32 v16, 3, v0
  v_lshlrev_b32 v16, 11, v16
  v_and_b32 v17, 7, v0
  v_lshl_add_u32 v150, v17, 7, v16
  v_lshlrev_b32 v151, 7, v0
  v_mul_u32_u24 v16, 7168, v2
  v_lshl_add_u32 v152, v1, 7, v16
  v_lshrrev_b32 v16, 2, v0
  v_and_b32 v17, 3, v0
  v_lshlrev_b32 v17, 7, v17
  v_lshl_add_u32 v153, v16, 11, v17
  s_mov_b32 exec_lo, 0x0f0f0f0f
  s_mov_b32 exec_hi, 0x0f0f0f0f
  buffer_load_dword v250, v150, s[32:35], s76 offen
  s_cmp_lt_u32 s83, 7
  s_cselect_b32 s70, s19, 1073741824
  s_cselect_b32 s71, s22, 1073741824
  s_mov_b32 exec_lo, 0x3fff3fff
  s_mov_b32 exec_hi, 0x3fff3fff
  buffer_load_dword v250, v152, s[36:39], s70 offen
  s_mov_b64 exec, 0xffff
  buffer_load_dword v250, v153, s[56:59], s71 offen
  s_mov_b64 exec, -1
  s_cselect_b32 s70, 1835008, 0
  s_cselect_b32 s71, 524288, 0
  s_add_u32 s19, s19, s70
  s_add_u32 s22, s22, s71
  s_and_b32 s76, s76, 4063232
  v_lshrrev_b32 v16, 1, v0
  v_and_b32 v17, 1, v0
  v_lshlrev_b32 v17, 7, v17
  v_lshl_add_u32 v150, v16, 11, v17
  s_bfe_u32 s77, s101, 0x10002
  s_lshr_b32 s78, s101, 3
  s_lshl_b32 s78, s78, 2
  s_and_b32 s70, s101, 3
  s_add_u32 s78, s78, s70
  s_lshl_b32 s78, s78, 4
  s_lshl_b32 s70, s64, 7
  s_add_u32 s78, s78, s70
  s_cmp_eq_u32 s77, 0
  s_cselect_b32 s40, s8, s10
  s_cselect_b32 s41, s9, s11
  s_mov_b32 s42, 65536
  s_mov_b32 s43, 0x20000
  v_lshlrev_b32 v15, 4, v0
  s_mov_b32 s44, s24
  s_mov_b32 s45, s25
  s_mov_b32 s46, 2048
  s_mov_b32 s47, 0x20000
  s_mov_b32 s52, s28
  s_mov_b32 s53, s29
  s_mov_b32 s54, 256
  s_mov_b32 s55, 0x20000
  s_lshl_b32 s70, s78, 5
  s_mov_b64 exec, 15
  buffer_load_dword v250, v151, s[40:43], s70 offen
  s_mov_b64 exec, -1
  s_mov_b32 m0, 156160
  s_nop 0
  buffer_load_dwordx4 v15, s[44:47], 0 offen offset:0 lds
  buffer_load_dwordx4 v15, s[44:47], 0 offen offset:1024 lds
  s_add_u32 m0, s15, 90112
  s_nop 0
  buffer_load_dwordx4 v144, s[32:35], s82 offen offset:0 lds
  buffer_load_dwordx4 v145, s[32:35], s82 offen offset:1024 lds
  buffer_load_dwordx4 v146, s[32:35], s82 offen offset:2048 lds
  buffer_load_dwordx4 v147, s[32:35], s82 offen offset:3072 lds
  s_add_u32 s82, s82, 128
  s_add_u32 m0, s18, 65536
  s_nop 0
  buffer_load_dwordx4 v148, s[56:59], s14 offen offset:0 lds
  buffer_load_dwordx4 v149, s[56:59], s14 offen offset:1024 lds
  s_add_u32 s14, s14, 131072
  s_waitcnt vmcnt(12)
  s_barrier
  s_branch L_a1m2
L_roleG:
  s_and_b32 s77, s69, 1
  s_lshr_b32 s78, s69, 1
  s_cmp_lt_u32 s69, 2
  s_cbranch_scc0 L_nocode
  s_getpc_b64 s[60:61]
L_pc:
  s_mov_b32 s62, L_codeend-L_pc
  s_mov_b32 s63, 0x20000
  s_lshl_b32 s71, s68, 10
  s_lshl_b32 s72, s69, 15
  s_add_u32 s71, s71, s72
  v_lshlrev_b32 v29, 7, v0
  s_mov_b64 exec, 0xff
  buffer_load_dword v70, v29, s[60:63], s71 offen
  s_mov_b64 exec, -1
L_nocode:
  s_mul_i32 s70, s65, 448
  s_mul_i32 s71, s78, 224
  s_add_u32 s70, s70, s71
  v_lshlrev_b32 v14, 2, v0
  s_mov_b32 s34, 7168
  s_mov_b32 s35, 0x20000
  s_setprio 3
  s_waitcnt lgkmcnt(0)
  s_mov_b32 s32, s18
  s_mov_b32 s33, s19
  buffer_load_dword v33, v14, s[32:35], s70 offen
  s_setprio 0
  s_waitcnt lgkmcnt(0)
  s_mov_b32 s48, s30
  s_mov_b32 s49, s31
  s_mov_b32 s50, 19300352
  s_mov_b32 s51, 0x20000
  v_mov_b64 v[112:113], 0
  v_mov_b64 v[114:115], 0
  v_mov_b64 v[116:117], 0
  v_mov_b64 v[118:119], 0
  v_mov_b64 v[120:121], 0
  v_mov_b64 v[122:123], 0
  v_mov_b64 v[124:125], 0
  v_mov_b64 v[126:127], 0
  v_mov_b64 v[128:129], 0
  v_mov_b64 v[130:131], 0
  v_mov_b64 v[132:133], 0
  v_mov_b64 v[134:135], 0
  v_mov_b64 v[136:137], 0
  v_mov_b64 v[138:139], 0
  v_mov_b64 v[140:141], 0
  v_mov_b64 v[142:143], 0
  v_lshrrev_b32 v14, 1, v1
  v_xor_b32 v14, v14, v2
  v_lshlrev_b32 v14, 4, v14
  v_lshl_add_u32 v14, v1, 7, v14
  s_lshl_b32 s70, s77, 13
  s_add_u32 s70, s70, 73728
  v_add_u32 v16, s70, v14
  v_xor_b32 v17, 64, v16
  s_mov_b32 s79, 0
  v_lshrrev_b32 v14, 2, v1
  v_lshl_add_u32 v14, v2, 3, v14
  v_and_b32 v29, 3, v1
  v_lshlrev_b32 v29, 3, v29
  v_mul_u32_u24 v30, 448, v14
  v_add_u32 v30, v30, v29
  s_mul_i32 s70, s78, 224
  v_add_u32 v30, s70, v30
  v_and_b32 v31, 1, v2
  v_lshlrev_b32 v32, 5, v31
  s_lshl_b32 s71, s78, 1
  s_sub_u32 s71, 1, s71
  v_mul_lo_u32 v32, v32, s71
  v_add_u32 v18, v30, v32
  v_sub_u32 v19, v30, v32
  v_lshrrev_b32 v32, 3, v1
  v_lshl_add_u32 v31, v32, 1, v31
  s_lshl_b32 s70, s78, 1
  v_xor_b32 v31, s70, v31
  v_lshl_add_u32 v29, v31, 5, v29
  v_lshl_add_u32 v29, v14, 7, v29
  v_add_u32 v20, 57344, v29
  v_xor_b32 v21, 32, v20
  v_lshrrev_b32 v22, 3, v0
  v_lshlrev_b32 v22, 11, v22
  v_and_b32 v23, 1, v2
  v_lshlrev_b32 v23, 2, v23
  v_and_b32 v24, 7, v0
  v_xor_b32 v23, v23, v24
  v_lshl_add_u32 v22, v23, 4, v22
  s_lshl_b32 s70, s67, 7
  v_add_u32 v22, s70, v22
  v_xor_b32 v23, 0, v22
  v_add_u32 v3, 0, v23
  v_xor_b32 v23, 32, v22
  v_add_u32 v4, 15360, v23
  v_xor_b32 v23, 0, v22
  v_add_u32 v5, 30720, v23
  v_xor_b32 v23, 32, v22
  v_add_u32 v6, 46080, v23
  s_lshl_b32 s70, s69, 14
  v_lshrrev_b32 v14, 2, v1
  v_lshl_add_u32 v14, v2, 3, v14
  v_and_b32 v15, 3, v1
  v_lshlrev_b32 v15, 3, v15
  v_lshl_add_u32 v14, v14, 7, v15
  v_and_b32 v15, 1, v2
  v_lshrrev_b32 v30, 3, v1
  v_lshl_add_u32 v15, v30, 1, v15
  v_lshl_add_u32 v14, v15, 5, v14
  v_add_u32 v14, s70, v14
  v_xor_b32 v7, 0, v14
  v_xor_b32 v8, 32, v14
  v_xor_b32 v9, 64, v14
  v_xor_b32 v10, 96, v14
  s_add_u32 s70, s69, 1
  s_and_b32 s70, s70, 3
  s_lshl_b32 s70, s70, 11
  v_lshl_add_u32 v11, v0, 4, s70
  s_add_u32 s70, s69, 2
  s_and_b32 s70, s70, 3
  s_lshl_b32 s70, s70, 11
  v_lshl_add_u32 v12, v0, 4, s70
  s_add_u32 s70, s69, 3
  s_and_b32 s70, s70, 3
  s_lshl_b32 s70, s70, 11
  v_lshl_add_u32 v13, v0, 4, s70
  s_add_u32 s70, s69, 4
  s_and_b32 s70, s70, 3
  s_lshl_b32 s70, s70, 11
  v_lshl_add_u32 v14, v0, 4, s70
  v_and_b32 v28, 1, v2
  v_lshlrev_b32 v28, 10, v28
  v_lshrrev_b32 v29, 1, v2
  v_lshl_add_u32 v28, v29, 8, v28
  v_lshl_add_u32 v15, v1, 4, v28
  v_mov_b32 v30, 155648
  ds_write_b128 v30, v[112:115]
  v_lshlrev_b32 v29, 3, v2
  s_waitcnt vmcnt(0) lgkmcnt(0)
  ds_bpermute_b32 v48, v29, v33 offset:0
  ds_bpermute_b32 v49, v29, v33 offset:4
  ds_bpermute_b32 v50, v29, v33 offset:32
  ds_bpermute_b32 v51, v29, v33 offset:36
  ds_bpermute_b32 v52, v29, v33 offset:64
  ds_bpermute_b32 v53, v29, v33 offset:68
  ds_bpermute_b32 v54, v29, v33 offset:96
  ds_bpermute_b32 v55, v29, v33 offset:100
  ds_bpermute_b32 v56, v29, v33 offset:128
  ds_bpermute_b32 v57, v29, v33 offset:132
  ds_bpermute_b32 v58, v29, v33 offset:160
  ds_bpermute_b32 v59, v29, v33 offset:164
  ds_bpermute_b32 v60, v29, v33 offset:192
  ds_bpermute_b32 v61, v29, v33 offset:196
  s_waitcnt lgkmcnt(12)
  v_lshlrev_b32 v144, 16, v48
  v_and_b32 v145, 0xffff0000, v48
  v_lshlrev_b32 v146, 16, v49
  v_and_b32 v147, 0xffff0000, v49
  v_mov_b64 v[148:149], v[144:145]
  v_mov_b64 v[150:151], v[146:147]
  v_mov_b64 v[152:153], v[144:145]
  v_mov_b64 v[154:155], v[146:147]
  v_mov_b64 v[156:157], v[144:145]
  v_mov_b64 v[158:159], v[146:147]
  s_waitcnt lgkmcnt(10)
  v_lshlrev_b32 v160, 16, v50
  v_and_b32 v161, 0xffff0000, v50
  v_lshlrev_b32 v162, 16, v51
  v_and_b32 v163, 0xffff0000, v51
  v_mov_b64 v[164:165], v[160:161]
  v_mov_b64 v[166:167], v[162:163]
  v_mov_b64 v[168:169], v[160:161]
  v_mov_b64 v[170:171], v[162:163]
  v_mov_b64 v[172:173], v[160:161]
  v_mov_b64 v[174:175], v[162:163]
  s_waitcnt lgkmcnt(8)
  v_lshlrev_b32 v176, 16, v52
  v_and_b32 v177, 0xffff0000, v52
  v_lshlrev_b32 v178, 16, v53
  v_and_b32 v179, 0xffff0000, v53
  v_mov_b64 v[180:181], v[176:177]
  v_mov_b64 v[182:183], v[178:179]
  v_mov_b64 v[184:185], v[176:177]
  v_mov_b64 v[186:187], v[178:179]
  v_mov_b64 v[188:189], v[176:177]
  v_mov_b64 v[190:191], v[178:179]
  s_waitcnt lgkmcnt(6)
  v_lshlrev_b32 v192, 16, v54
  v_and_b32 v193, 0xffff0000, v54
  v_lshlrev_b32 v194, 16, v55
  v_and_b32 v195, 0xffff0000, v55
  v_mov_b64 v[196:197], v[192:193]
  v_mov_b64 v[198:199], v[194:195]
  v_mov_b64 v[200:201], v[192:193]
  v_mov_b64 v[202:203], v[194:195]
  v_mov_b64 v[204:205], v[192:193]
  v_mov_b64 v[206:207], v[194:195]
  s_waitcnt lgkmcnt(4)
  v_lshlrev_b32 v208, 16, v56
  v_and_b32 v209, 0xffff0000, v56
  v_lshlrev_b32 v210, 16, v57
  v_and_b32 v211, 0xffff0000, v57
  v_mov_b64 v[212:213], v[208:209]
  v_mov_b64 v[214:215], v[210:211]
  v_mov_b64 v[216:217], v[208:209]
  v_mov_b64 v[218:219], v[210:211]
  v_mov_b64 v[220:221], v[208:209]
  v_mov_b64 v[222:223], v[210:211]
  s_waitcnt lgkmcnt(2)
  v_lshlrev_b32 v224, 16, v58
  v_and_b32 v225, 0xffff0000, v58
  v_lshlrev_b32 v226, 16, v59
  v_and_b32 v227, 0xffff0000, v59
  v_mov_b64 v[228:229], v[224:225]
  v_mov_b64 v[230:231], v[226:227]
  v_mov_b64 v[232:233], v[224:225]
  v_mov_b64 v[234:235], v[226:227]
  v_mov_b64 v[236:237], v[224:225]
  v_mov_b64 v[238:239], v[226:227]
  s_waitcnt lgkmcnt(0)
  v_lshlrev_b32 v240, 16, v60
  v_and_b32 v241, 0xffff0000, v60
  v_lshlrev_b32 v242, 16, v61
  v_and_b32 v243, 0xffff0000, v61
  v_mov_b64 v[244:245], v[240:241]
  v_mov_b64 v[246:247], v[242:243]
  v_mov_b64 v[248:249], v[240:241]
  v_mov_b64 v[250:251], v[242:243]
  v_mov_b64 v[252:253], v[240:241]
  v_mov_b64 v[254:255], v[242:243]
  s_mov_b32 s76, 0
  s_barrier
  ds_read_b64_tr_b16 v[24:25], v20 offset:0
  ds_read_b64_tr_b16 v[26:27], v20 offset:512
  ds_read_b64_tr_b16 v[28:29], v20 offset:4096
  ds_read_b64_tr_b16 v[30:31], v20 offset:4608
  ds_read_b128 v[48:51], v16 offset:0
  ds_read_b128 v[64:67], v17 offset:0
  ds_read_b128 v[52:55], v16 offset:2048
  ds_read_b128 v[68:71], v17 offset:2048
  ds_read_b128 v[56:59], v16 offset:4096
  ds_read_b128 v[72:75], v17 offset:4096
  ds_read_b128 v[60:63], v16 offset:6144
  ds_read_b128 v[76:79], v17 offset:6144
  ds_read_b64_tr_b16 v[32:33], v21 offset:0
  ds_read_b64_tr_b16 v[34:35], v21 offset:512
  ds_read_b64_tr_b16 v[36:37], v21 offset:4096
  ds_read_b64_tr_b16 v[38:39], v21 offset:4608
.p2align 3
L_g1loop:
  s_waitcnt lgkmcnt(4)
  v_mfma_f32_16x16x32_bf16 v[112:115], v[24:27], v[48:51], v[112:115]
  ds_read_b64_tr_b16 v[40:41], v18 offset:0
  v_mfma_f32_16x16x32_bf16 v[112:115], v[28:31], v[64:67], v[112:115]
  ds_read_b64_tr_b16 v[42:43], v18 offset:1792
  v_mfma_f32_16x16x32_bf16 v[116:119], v[28:31], v[68:71], v[116:119]
  ds_read_b64_tr_b16 v[44:45], v18 offset:14336
  v_mfma_f32_16x16x32_bf16 v[116:119], v[24:27], v[52:55], v[116:119]
  ds_read_b64_tr_b16 v[46:47], v18 offset:16128
  v_mfma_f32_16x16x32_bf16 v[120:123], v[24:27], v[56:59], v[120:123]
  v_mfma_f32_16x16x32_bf16 v[120:123], v[28:31], v[72:75], v[120:123]
  v_mfma_f32_16x16x32_bf16 v[124:127], v[28:31], v[76:79], v[124:127]
  v_mfma_f32_16x16x32_bf16 v[124:127], v[24:27], v[60:63], v[124:127]
  s_waitcnt lgkmcnt(4)
  v_mfma_f32_16x16x32_bf16 v[140:143], v[32:35], v[60:63], v[140:143]
  ds_read_b64_tr_b16 v[24:25], v19 offset:32
  v_mfma_f32_16x16x32_bf16 v[140:143], v[36:39], v[76:79], v[140:143]
  ds_read_b64_tr_b16 v[26:27], v19 offset:1824
  v_mfma_f32_16x16x32_bf16 v[136:139], v[36:39], v[72:75], v[136:139]
  ds_read_b64_tr_b16 v[28:29], v19 offset:14368
  v_mfma_f32_16x16x32_bf16 v[136:139], v[32:35], v[56:59], v[136:139]
  ds_read_b64_tr_b16 v[30:31], v19 offset:16160
  v_mfma_f32_16x16x32_bf16 v[132:135], v[32:35], v[52:55], v[132:135]
  s_add_u32 s79, s79, 1
  s_cmp_eq_u32 s79, 3
  v_mfma_f32_16x16x32_bf16 v[132:135], v[36:39], v[68:71], v[132:135]
  s_cselect_b32 s79, 0, s79
  s_cselect_b32 s70, 49152, 0
  v_mfma_f32_16x16x32_bf16 v[128:131], v[36:39], v[64:67], v[128:131]
  s_sub_u32 s70, 16384, s70
  v_mfma_f32_16x16x32_bf16 v[128:131], v[32:35], v[48:51], v[128:131]
  s_waitcnt lgkmcnt(4)
  v_mfma_f32_16x16x32_bf16 v[144:147], v[40:43], v[48:51], v[144:147]
  ds_read_b64_tr_b16 v[32:33], v18 offset:64
  v_mfma_f32_16x16x32_bf16 v[144:147], v[44:47], v[64:67], v[144:147]
  ds_read_b64_tr_b16 v[34:35], v18 offset:1856
  v_mfma_f32_16x16x32_bf16 v[148:151], v[44:47], v[68:71], v[148:151]
  ds_read_b64_tr_b16 v[36:37], v18 offset:14400
  v_mfma_f32_16x16x32_bf16 v[148:151], v[40:43], v[52:55], v[148:151]
  ds_read_b64_tr_b16 v[38:39], v18 offset:16192
  v_mfma_f32_16x16x32_bf16 v[152:155], v[40:43], v[56:59], v[152:155]
  v_add_u32 v16, s70, v16
  v_mfma_f32_16x16x32_bf16 v[152:155], v[44:47], v[72:75], v[152:155]
  v_add_u32 v17, s70, v17
  v_mfma_f32_16x16x32_bf16 v[156:159], v[44:47], v[76:79], v[156:159]
  v_mfma_f32_16x16x32_bf16 v[156:159], v[40:43], v[60:63], v[156:159]
  s_waitcnt lgkmcnt(4)
  v_mfma_f32_16x16x32_bf16 v[172:175], v[24:27], v[60:63], v[172:175]
  ds_read_b64_tr_b16 v[40:41], v19 offset:96
  v_mfma_f32_16x16x32_bf16 v[172:175], v[28:31], v[76:79], v[172:175]
  ds_read_b64_tr_b16 v[42:43], v19 offset:1888
  v_mfma_f32_16x16x32_bf16 v[168:171], v[28:31], v[72:75], v[168:171]
  ds_read_b64_tr_b16 v[44:45], v19 offset:14432
  v_mfma_f32_16x16x32_bf16 v[168:171], v[24:27], v[56:59], v[168:171]
  ds_read_b64_tr_b16 v[46:47], v19 offset:16224
  v_mfma_f32_16x16x32_bf16 v[164:167], v[24:27], v[52:55], v[164:167]
  v_mfma_f32_16x16x32_bf16 v[164:167], v[28:31], v[68:71], v[164:167]
  v_mfma_f32_16x16x32_bf16 v[160:163], v[28:31], v[64:67], v[160:163]
  v_mfma_f32_16x16x32_bf16 v[160:163], v[24:27], v[48:51], v[160:163]
  s_waitcnt lgkmcnt(4)
  v_mfma_f32_16x16x32_bf16 v[176:179], v[32:35], v[48:51], v[176:179]
  ds_read_b64_tr_b16 v[24:25], v18 offset:128
  s_barrier
  v_mfma_f32_16x16x32_bf16 v[176:179], v[36:39], v[64:67], v[176:179]
  ds_read_b64_tr_b16 v[26:27], v18 offset:1920
  v_mfma_f32_16x16x32_bf16 v[180:183], v[36:39], v[68:71], v[180:183]
  ds_read_b64_tr_b16 v[28:29], v18 offset:14464
  v_mfma_f32_16x16x32_bf16 v[180:183], v[32:35], v[52:55], v[180:183]
  ds_read_b64_tr_b16 v[30:31], v18 offset:16256
  v_mfma_f32_16x16x32_bf16 v[184:187], v[32:35], v[56:59], v[184:187]
  ds_read_b128 v[80:83], v16 offset:0
  v_mfma_f32_16x16x32_bf16 v[184:187], v[36:39], v[72:75], v[184:187]
  ds_read_b128 v[96:99], v17 offset:0
  v_mfma_f32_16x16x32_bf16 v[188:191], v[36:39], v[76:79], v[188:191]
  ds_read_b128 v[84:87], v16 offset:2048
  v_mfma_f32_16x16x32_bf16 v[188:191], v[32:35], v[60:63], v[188:191]
  s_waitcnt lgkmcnt(7)
  v_mfma_f32_16x16x32_bf16 v[204:207], v[40:43], v[60:63], v[204:207]
  ds_read_b64_tr_b16 v[32:33], v19 offset:160
  v_mfma_f32_16x16x32_bf16 v[204:207], v[44:47], v[76:79], v[204:207]
  ds_read_b64_tr_b16 v[34:35], v19 offset:1952
  v_mfma_f32_16x16x32_bf16 v[200:203], v[44:47], v[72:75], v[200:203]
  ds_read_b64_tr_b16 v[36:37], v19 offset:14496
  v_mfma_f32_16x16x32_bf16 v[200:203], v[40:43], v[56:59], v[200:203]
  ds_read_b64_tr_b16 v[38:39], v19 offset:16288
  v_mfma_f32_16x16x32_bf16 v[196:199], v[40:43], v[52:55], v[196:199]
  ds_read_b128 v[100:103], v17 offset:2048
  v_mfma_f32_16x16x32_bf16 v[196:199], v[44:47], v[68:71], v[196:199]
  ds_read_b128 v[88:91], v16 offset:4096
  v_mfma_f32_16x16x32_bf16 v[192:195], v[44:47], v[64:67], v[192:195]
  ds_read_b128 v[104:107], v17 offset:4096
  v_mfma_f32_16x16x32_bf16 v[192:195], v[40:43], v[48:51], v[192:195]
  s_waitcnt lgkmcnt(10)
  v_mfma_f32_16x16x32_bf16 v[208:211], v[24:27], v[48:51], v[208:211]
  ds_read_b64_tr_b16 v[40:41], v18 offset:192
  v_mfma_f32_16x16x32_bf16 v[208:211], v[28:31], v[64:67], v[208:211]
  ds_read_b64_tr_b16 v[42:43], v18 offset:1984
  v_mfma_f32_16x16x32_bf16 v[212:215], v[28:31], v[68:71], v[212:215]
  ds_read_b64_tr_b16 v[44:45], v18 offset:14528
  v_mfma_f32_16x16x32_bf16 v[212:215], v[24:27], v[52:55], v[212:215]
  ds_read_b64_tr_b16 v[46:47], v18 offset:16320
  v_mfma_f32_16x16x32_bf16 v[216:219], v[24:27], v[56:59], v[216:219]
  ds_read_b128 v[92:95], v16 offset:6144
  v_mfma_f32_16x16x32_bf16 v[216:219], v[28:31], v[72:75], v[216:219]
  ds_read_b128 v[108:111], v17 offset:6144
  v_mfma_f32_16x16x32_bf16 v[220:223], v[28:31], v[76:79], v[220:223]
  v_mfma_f32_16x16x32_bf16 v[220:223], v[24:27], v[60:63], v[220:223]
  s_waitcnt lgkmcnt(9)
  v_mfma_f32_16x16x32_bf16 v[236:239], v[32:35], v[60:63], v[236:239]
  ds_read_b64_tr_b16 v[24:25], v20 offset:8192
  v_mfma_f32_16x16x32_bf16 v[236:239], v[36:39], v[76:79], v[236:239]
  ds_read_b64_tr_b16 v[26:27], v20 offset:8704
  v_mfma_f32_16x16x32_bf16 v[232:235], v[36:39], v[72:75], v[232:235]
  ds_read_b64_tr_b16 v[28:29], v20 offset:12288
  v_mfma_f32_16x16x32_bf16 v[232:235], v[32:35], v[56:59], v[232:235]
  ds_read_b64_tr_b16 v[30:31], v20 offset:12800
  v_mfma_f32_16x16x32_bf16 v[228:231], v[32:35], v[52:55], v[228:231]
  v_mfma_f32_16x16x32_bf16 v[228:231], v[36:39], v[68:71], v[228:231]
  v_mfma_f32_16x16x32_bf16 v[224:227], v[36:39], v[64:67], v[224:227]
  v_mfma_f32_16x16x32_bf16 v[224:227], v[32:35], v[48:51], v[224:227]
  s_waitcnt lgkmcnt(6)
  v_mfma_f32_16x16x32_bf16 v[240:243], v[40:43], v[48:51], v[240:243]
  ds_read_b64_tr_b16 v[32:33], v21 offset:8192
  v_mfma_f32_16x16x32_bf16 v[240:243], v[44:47], v[64:67], v[240:243]
  ds_read_b64_tr_b16 v[34:35], v21 offset:8704
  v_mfma_f32_16x16x32_bf16 v[244:247], v[44:47], v[68:71], v[244:247]
  ds_read_b64_tr_b16 v[36:37], v21 offset:12288
  v_mfma_f32_16x16x32_bf16 v[244:247], v[40:43], v[52:55], v[244:247]
  ds_read_b64_tr_b16 v[38:39], v21 offset:12800
  v_mfma_f32_16x16x32_bf16 v[248:251], v[40:43], v[56:59], v[248:251]
  s_barrier
  v_mfma_f32_16x16x32_bf16 v[248:251], v[44:47], v[72:75], v[248:251]
  s_add_u32 s76, s76, 1
  v_mfma_f32_16x16x32_bf16 v[252:255], v[44:47], v[76:79], v[252:255]
  s_cmp_eq_u32 s76, 8
  v_mfma_f32_16x16x32_bf16 v[252:255], v[40:43], v[60:63], v[252:255]
  s_cbranch_scc1 L_g1last
  s_waitcnt lgkmcnt(4)
  v_mfma_f32_16x16x32_bf16 v[112:115], v[24:27], v[80:83], v[112:115]
  ds_read_b64_tr_b16 v[40:41], v18 offset:28672
  v_mfma_f32_16x16x32_bf16 v[112:115], v[28:31], v[96:99], v[112:115]
  ds_read_b64_tr_b16 v[42:43], v18 offset:30464
  v_mfma_f32_16x16x32_bf16 v[116:119], v[28:31], v[100:103], v[116:119]
  ds_read_b64_tr_b16 v[44:45], v18 offset:43008
  v_mfma_f32_16x16x32_bf16 v[116:119], v[24:27], v[84:87], v[116:119]
  ds_read_b64_tr_b16 v[46:47], v18 offset:44800
  v_mfma_f32_16x16x32_bf16 v[120:123], v[24:27], v[88:91], v[120:123]
  v_mfma_f32_16x16x32_bf16 v[120:123], v[28:31], v[104:107], v[120:123]
  v_mfma_f32_16x16x32_bf16 v[124:127], v[28:31], v[108:111], v[124:127]
  v_mfma_f32_16x16x32_bf16 v[124:127], v[24:27], v[92:95], v[124:127]
  s_waitcnt lgkmcnt(4)
  v_mfma_f32_16x16x32_bf16 v[140:143], v[32:35], v[92:95], v[140:143]
  ds_read_b64_tr_b16 v[24:25], v19 offset:28704
  v_mfma_f32_16x16x32_bf16 v[140:143], v[36:39], v[108:111], v[140:143]
  ds_read_b64_tr_b16 v[26:27], v19 offset:30496
  v_mfma_f32_16x16x32_bf16 v[136:139], v[36:39], v[104:107], v[136:139]
  ds_read_b64_tr_b16 v[28:29], v19 offset:43040
  v_mfma_f32_16x16x32_bf16 v[136:139], v[32:35], v[88:91], v[136:139]
  ds_read_b64_tr_b16 v[30:31], v19 offset:44832
  v_mfma_f32_16x16x32_bf16 v[132:135], v[32:35], v[84:87], v[132:135]
  s_add_u32 s79, s79, 1
  s_cmp_eq_u32 s79, 3
  v_mfma_f32_16x16x32_bf16 v[132:135], v[36:39], v[100:103], v[132:135]
  s_cselect_b32 s79, 0, s79
  s_cselect_b32 s70, 49152, 0
  v_mfma_f32_16x16x32_bf16 v[128:131], v[36:39], v[96:99], v[128:131]
  s_sub_u32 s70, 16384, s70
  v_mfma_f32_16x16x32_bf16 v[128:131], v[32:35], v[80:83], v[128:131]
  s_waitcnt lgkmcnt(4)
  v_mfma_f32_16x16x32_bf16 v[144:147], v[40:43], v[80:83], v[144:147]
  ds_read_b64_tr_b16 v[32:33], v18 offset:28736
  v_mfma_f32_16x16x32_bf16 v[144:147], v[44:47], v[96:99], v[144:147]
  ds_read_b64_tr_b16 v[34:35], v18 offset:30528
  v_mfma_f32_16x16x32_bf16 v[148:151], v[44:47], v[100:103], v[148:151]
  ds_read_b64_tr_b16 v[36:37], v18 offset:43072
  v_mfma_f32_16x16x32_bf16 v[148:151], v[40:43], v[84:87], v[148:151]
  ds_read_b64_tr_b16 v[38:39], v18 offset:44864
  v_mfma_f32_16x16x32_bf16 v[152:155], v[40:43], v[88:91], v[152:155]
  v_add_u32 v16, s70, v16
  v_mfma_f32_16x16x32_bf16 v[152:155], v[44:47], v[104:107], v[152:155]
  v_add_u32 v17, s70, v17
  v_mfma_f32_16x16x32_bf16 v[156:159], v[44:47], v[108:111], v[156:159]
  v_mfma_f32_16x16x32_bf16 v[156:159], v[40:43], v[92:95], v[156:159]
  s_waitcnt lgkmcnt(4)
  v_mfma_f32_16x16x32_bf16 v[172:175], v[24:27], v[92:95], v[172:175]
  ds_read_b64_tr_b16 v[40:41], v19 offset:28768
  v_mfma_f32_16x16x32_bf16 v[172:175], v[28:31], v[108:111], v[172:175]
  ds_read_b64_tr_b16 v[42:43], v19 offset:30560
  v_mfma_f32_16x16x32_bf16 v[168:171], v[28:31], v[104:107], v[168:171]
  ds_read_b64_tr_b16 v[44:45], v19 offset:43104
  v_mfma_f32_16x16x32_bf16 v[168:171], v[24:27], v[88:91], v[168:171]
  ds_read_b64_tr_b16 v[46:47], v19 offset:44896
  v_mfma_f32_16x16x32_bf16 v[164:167], v[24:27], v[84:87], v[164:167]
  v_mfma_f32_16x16x32_bf16 v[164:167], v[28:31], v[100:103], v[164:167]
  v_mfma_f32_16x16x32_bf16 v[160:163], v[28:31], v[96:99], v[160:163]
  v_mfma_f32_16x16x32_bf16 v[160:163], v[24:27], v[80:83], v[160:163]
  s_waitcnt lgkmcnt(4)
  v_mfma_f32_16x16x32_bf16 v[176:179], v[32:35], v[80:83], v[176:179]
  ds_read_b64_tr_b16 v[24:25], v18 offset:28800
  s_barrier
  v_mfma_f32_16x16x32_bf16 v[176:179], v[36:39], v[96:99], v[176:179]
  ds_read_b64_tr_b16 v[26:27], v18 offset:30592
  v_mfma_f32_16x16x32_bf16 v[180:183], v[36:39], v[100:103], v[180:183]
  ds_read_b64_tr_b16 v[28:29], v18 offset:43136
  v_mfma_f32_16x16x32_bf16 v[180:183], v[32:35], v[84:87], v[180:183]
  ds_read_b64_tr_b16 v[30:31], v18 offset:44928
  v_mfma_f32_16x16x32_bf16 v[184:187], v[32:35], v[88:91], v[184:187]
  ds_read_b128 v[48:51], v16 offset:0
  v_mfma_f32_16x16x32_bf16 v[184:187], v[36:39], v[104:107], v[184:187]
  ds_read_b128 v[64:67], v17 offset:0
  v_mfma_f32_16x16x32_bf16 v[188:191], v[36:39], v[108:111], v[188:191]
  ds_read_b128 v[52:55], v16 offset:2048
  v_mfma_f32_16x16x32_bf16 v[188:191], v[32:35], v[92:95], v[188:191]
  s_waitcnt lgkmcnt(7)
  v_mfma_f32_16x16x32_bf16 v[204:207], v[40:43], v[92:95], v[204:207]
  ds_read_b64_tr_b16 v[32:33], v19 offset:28832
  v_mfma_f32_16x16x32_bf16 v[204:207], v[44:47], v[108:111], v[204:207]
  ds_read_b64_tr_b16 v[34:35], v19 offset:30624
  v_mfma_f32_16x16x32_bf16 v[200:203], v[44:47], v[104:107], v[200:203]
  ds_read_b64_tr_b16 v[36:37], v19 offset:43168
  v_mfma_f32_16x16x32_bf16 v[200:203], v[40:43], v[88:91], v[200:203]
  ds_read_b64_tr_b16 v[38:39], v19 offset:44960
  v_mfma_f32_16x16x32_bf16 v[196:199], v[40:43], v[84:87], v[196:199]
  ds_read_b128 v[68:71], v17 offset:2048
  v_mfma_f32_16x16x32_bf16 v[196:199], v[44:47], v[100:103], v[196:199]
  ds_read_b128 v[56:59], v16 offset:4096
  v_mfma_f32_16x16x32_bf16 v[192:195], v[44:47], v[96:99], v[192:195]
  ds_read_b128 v[72:75], v17 offset:4096
  v_mfma_f32_16x16x32_bf16 v[192:195], v[40:43], v[80:83], v[192:195]
  s_waitcnt lgkmcnt(10)
  v_mfma_f32_16x16x32_bf16 v[208:211], v[24:27], v[80:83], v[208:211]
  ds_read_b64_tr_b16 v[40:41], v18 offset:28864
  v_mfma_f32_16x16x32_bf16 v[208:211], v[28:31], v[96:99], v[208:211]
  ds_read_b64_tr_b16 v[42:43], v18 offset:30656
  v_mfma_f32_16x16x32_bf16 v[212:215], v[28:31], v[100:103], v[212:215]
  ds_read_b64_tr_b16 v[44:45], v18 offset:43200
  v_mfma_f32_16x16x32_bf16 v[212:215], v[24:27], v[84:87], v[212:215]
  ds_read_b64_tr_b16 v[46:47], v18 offset:44992
  v_mfma_f32_16x16x32_bf16 v[216:219], v[24:27], v[88:91], v[216:219]
  ds_read_b128 v[60:63], v16 offset:6144
  v_mfma_f32_16x16x32_bf16 v[216:219], v[28:31], v[104:107], v[216:219]
  ds_read_b128 v[76:79], v17 offset:6144
  v_mfma_f32_16x16x32_bf16 v[220:223], v[28:31], v[108:111], v[220:223]
  v_mfma_f32_16x16x32_bf16 v[220:223], v[24:27], v[92:95], v[220:223]
  s_waitcnt lgkmcnt(9)
  v_mfma_f32_16x16x32_bf16 v[236:239], v[32:35], v[92:95], v[236:239]
  ds_read_b64_tr_b16 v[24:25], v20 offset:0
  v_mfma_f32_16x16x32_bf16 v[236:239], v[36:39], v[108:111], v[236:239]
  ds_read_b64_tr_b16 v[26:27], v20 offset:512
  v_mfma_f32_16x16x32_bf16 v[232:235], v[36:39], v[104:107], v[232:235]
  ds_read_b64_tr_b16 v[28:29], v20 offset:4096
  v_mfma_f32_16x16x32_bf16 v[232:235], v[32:35], v[88:91], v[232:235]
  ds_read_b64_tr_b16 v[30:31], v20 offset:4608
  v_mfma_f32_16x16x32_bf16 v[228:231], v[32:35], v[84:87], v[228:231]
  v_mfma_f32_16x16x32_bf16 v[228:231], v[36:39], v[100:103], v[228:231]
  v_mfma_f32_16x16x32_bf16 v[224:227], v[36:39], v[96:99], v[224:227]
  v_mfma_f32_16x16x32_bf16 v[224:227], v[32:35], v[80:83], v[224:227]
  s_waitcnt lgkmcnt(6)
  v_mfma_f32_16x16x32_bf16 v[240:243], v[40:43], v[80:83], v[240:243]
  ds_read_b64_tr_b16 v[32:33], v21 offset:0
  v_mfma_f32_16x16x32_bf16 v[240:243], v[44:47], v[96:99], v[240:243]
  ds_read_b64_tr_b16 v[34:35], v21 offset:512
  v_mfma_f32_16x16x32_bf16 v[244:247], v[44:47], v[100:103], v[244:247]
  ds_read_b64_tr_b16 v[36:37], v21 offset:4096
  v_mfma_f32_16x16x32_bf16 v[244:247], v[40:43], v[84:87], v[244:247]
  ds_read_b64_tr_b16 v[38:39], v21 offset:4608
  v_mfma_f32_16x16x32_bf16 v[248:251], v[40:43], v[88:91], v[248:251]
  s_barrier
  v_mfma_f32_16x16x32_bf16 v[248:251], v[44:47], v[104:107], v[248:251]
  v_mfma_f32_16x16x32_bf16 v[252:255], v[44:47], v[108:111], v[252:255]
  v_mfma_f32_16x16x32_bf16 v[252:255], v[40:43], v[92:95], v[252:255]
  s_branch L_g1loop
L_g1last:
  s_waitcnt lgkmcnt(4)
  v_mfma_f32_16x16x32_bf16 v[112:115], v[24:27], v[80:83], v[112:115]
  ds_read_b64_tr_b16 v[40:41], v18 offset:28672
  v_mfma_f32_16x16x32_bf16 v[112:115], v[28:31], v[96:99], v[112:115]
  ds_read_b64_tr_b16 v[42:43], v18 offset:30464
  v_mfma_f32_16x16x32_bf16 v[116:119], v[28:31], v[100:103], v[116:119]
  ds_read_b64_tr_b16 v[44:45], v18 offset:43008
  v_mfma_f32_16x16x32_bf16 v[116:119], v[24:27], v[84:87], v[116:119]
  ds_read_b64_tr_b16 v[46:47], v18 offset:44800
  v_mfma_f32_16x16x32_bf16 v[120:123], v[24:27], v[88:91], v[120:123]
  s_lshl_b32 s72, s77, 13
  s_lshl_b32 s73, s78, 11
  v_mfma_f32_16x16x32_bf16 v[120:123], v[28:31], v[104:107], v[120:123]
  s_add_u32 s72, s72, s73
  s_add_u32 s72, s72, 73728
  v_mfma_f32_16x16x32_bf16 v[124:127], v[28:31], v[108:111], v[124:127]
  v_lshl_add_u32 v64, v0, 4, s72
  v_mfma_f32_16x16x32_bf16 v[124:127], v[24:27], v[92:95], v[124:127]
  s_waitcnt lgkmcnt(4)
  v_mfma_f32_16x16x32_bf16 v[140:143], v[32:35], v[92:95], v[140:143]
  ds_read_b64_tr_b16 v[24:25], v19 offset:28704
  v_mfma_f32_16x16x32_bf16 v[140:143], v[36:39], v[108:111], v[140:143]
  ds_read_b64_tr_b16 v[26:27], v19 offset:30496
  v_mfma_f32_16x16x32_bf16 v[136:139], v[36:39], v[104:107], v[136:139]
  ds_read_b64_tr_b16 v[28:29], v19 offset:43040
  v_mfma_f32_16x16x32_bf16 v[136:139], v[32:35], v[88:91], v[136:139]
  ds_read_b64_tr_b16 v[30:31], v19 offset:44832
  v_mfma_f32_16x16x32_bf16 v[132:135], v[32:35], v[84:87], v[132:135]
  v_mfma_f32_16x16x32_bf16 v[132:135], v[36:39], v[100:103], v[132:135]
  v_mfma_f32_16x16x32_bf16 v[128:131], v[36:39], v[96:99], v[128:131]
  v_mfma_f32_16x16x32_bf16 v[128:131], v[32:35], v[80:83], v[128:131]
  s_waitcnt lgkmcnt(4)
  v_mfma_f32_16x16x32_bf16 v[144:147], v[40:43], v[80:83], v[144:147]
  ds_read_b64_tr_b16 v[32:33], v18 offset:28736
  v_mfma_f32_16x16x32_bf16 v[144:147], v[44:47], v[96:99], v[144:147]
  ds_read_b64_tr_b16 v[34:35], v18 offset:30528
  v_mfma_f32_16x16x32_bf16 v[148:151], v[44:47], v[100:103], v[148:151]
  ds_read_b64_tr_b16 v[36:37], v18 offset:43072
  v_mfma_f32_16x16x32_bf16 v[148:151], v[40:43], v[84:87], v[148:151]
  ds_read_b64_tr_b16 v[38:39], v18 offset:44864
  v_mfma_f32_16x16x32_bf16 v[152:155], v[40:43], v[88:91], v[152:155]
  v_cvt_pk_bf16_f32 v48, v112, v113
  v_cvt_pk_bf16_f32 v49, v114, v115
  v_mfma_f32_16x16x32_bf16 v[152:155], v[44:47], v[104:107], v[152:155]
  v_cvt_pk_bf16_f32 v52, v116, v117
  v_cvt_pk_bf16_f32 v53, v118, v119
  v_mfma_f32_16x16x32_bf16 v[156:159], v[44:47], v[108:111], v[156:159]
  v_cvt_pk_bf16_f32 v56, v120, v121
  v_cvt_pk_bf16_f32 v57, v122, v123
  v_mfma_f32_16x16x32_bf16 v[156:159], v[40:43], v[92:95], v[156:159]
  s_waitcnt lgkmcnt(4)
  v_mfma_f32_16x16x32_bf16 v[172:175], v[24:27], v[92:95], v[172:175]
  ds_read_b64_tr_b16 v[40:41], v19 offset:28768
  v_mfma_f32_16x16x32_bf16 v[172:175], v[28:31], v[108:111], v[172:175]
  ds_read_b64_tr_b16 v[42:43], v19 offset:30560
  v_mfma_f32_16x16x32_bf16 v[168:171], v[28:31], v[104:107], v[168:171]
  ds_read_b64_tr_b16 v[44:45], v19 offset:43104
  v_mfma_f32_16x16x32_bf16 v[168:171], v[24:27], v[88:91], v[168:171]
  ds_read_b64_tr_b16 v[46:47], v19 offset:44896
  v_mfma_f32_16x16x32_bf16 v[164:167], v[24:27], v[84:87], v[164:167]
  v_cvt_pk_bf16_f32 v60, v124, v125
  v_cvt_pk_bf16_f32 v61, v126, v127
  v_mfma_f32_16x16x32_bf16 v[164:167], v[28:31], v[100:103], v[164:167]
  v_cvt_pk_bf16_f32 v62, v140, v141
  v_cvt_pk_bf16_f32 v63, v142, v143
  v_mfma_f32_16x16x32_bf16 v[160:163], v[28:31], v[96:99], v[160:163]
  v_cvt_pk_bf16_f32 v58, v136, v137
  v_cvt_pk_bf16_f32 v59, v138, v139
  v_mfma_f32_16x16x32_bf16 v[160:163], v[24:27], v[80:83], v[160:163]
  s_waitcnt lgkmcnt(4)
  v_mfma_f32_16x16x32_bf16 v[176:179], v[32:35], v[80:83], v[176:179]
  ds_read_b64_tr_b16 v[24:25], v18 offset:28800
  v_mfma_f32_16x16x32_bf16 v[176:179], v[36:39], v[96:99], v[176:179]
  ds_read_b64_tr_b16 v[26:27], v18 offset:30592
  v_mfma_f32_16x16x32_bf16 v[180:183], v[36:39], v[100:103], v[180:183]
  ds_read_b64_tr_b16 v[28:29], v18 offset:43136
  v_mfma_f32_16x16x32_bf16 v[180:183], v[32:35], v[84:87], v[180:183]
  ds_read_b64_tr_b16 v[30:31], v18 offset:44928
  v_mfma_f32_16x16x32_bf16 v[184:187], v[32:35], v[88:91], v[184:187]
  v_cvt_pk_bf16_f32 v54, v132, v133
  v_cvt_pk_bf16_f32 v55, v134, v135
  v_mfma_f32_16x16x32_bf16 v[184:187], v[36:39], v[104:107], v[184:187]
  v_cvt_pk_bf16_f32 v50, v128, v129
  v_cvt_pk_bf16_f32 v51, v130, v131
  v_mfma_f32_16x16x32_bf16 v[188:191], v[36:39], v[108:111], v[188:191]
  v_mfma_f32_16x16x32_bf16 v[188:191], v[32:35], v[92:95], v[188:191]
  s_waitcnt lgkmcnt(4)
  v_mfma_f32_16x16x32_bf16 v[204:207], v[40:43], v[92:95], v[204:207]
  ds_read_b64_tr_b16 v[32:33], v19 offset:28832
  v_mfma_f32_16x16x32_bf16 v[204:207], v[44:47], v[108:111], v[204:207]
  ds_read_b64_tr_b16 v[34:35], v19 offset:30624
  v_mfma_f32_16x16x32_bf16 v[200:203], v[44:47], v[104:107], v[200:203]
  ds_read_b64_tr_b16 v[36:37], v19 offset:43168
  v_mfma_f32_16x16x32_bf16 v[200:203], v[40:43], v[88:91], v[200:203]
  ds_read_b64_tr_b16 v[38:39], v19 offset:44960
  v_mfma_f32_16x16x32_bf16 v[196:199], v[40:43], v[84:87], v[196:199]
  v_mfma_f32_16x16x32_bf16 v[196:199], v[44:47], v[100:103], v[196:199]
  v_mfma_f32_16x16x32_bf16 v[192:195], v[44:47], v[96:99], v[192:195]
  s_barrier
  v_mfma_f32_16x16x32_bf16 v[192:195], v[40:43], v[80:83], v[192:195]
  s_waitcnt lgkmcnt(4)
  v_mfma_f32_16x16x32_bf16 v[208:211], v[24:27], v[80:83], v[208:211]
  ds_read_b64_tr_b16 v[40:41], v18 offset:28864
  v_mfma_f32_16x16x32_bf16 v[208:211], v[28:31], v[96:99], v[208:211]
  ds_read_b64_tr_b16 v[42:43], v18 offset:30656
  v_mfma_f32_16x16x32_bf16 v[212:215], v[28:31], v[100:103], v[212:215]
  ds_read_b64_tr_b16 v[44:45], v18 offset:43200
  v_mfma_f32_16x16x32_bf16 v[212:215], v[24:27], v[84:87], v[212:215]
  ds_read_b64_tr_b16 v[46:47], v18 offset:44992
  v_mfma_f32_16x16x32_bf16 v[216:219], v[24:27], v[88:91], v[216:219]
  ds_write_b128 v64, v[48:51] offset:0
  v_mfma_f32_16x16x32_bf16 v[216:219], v[28:31], v[104:107], v[216:219]
  v_mfma_f32_16x16x32_bf16 v[220:223], v[28:31], v[108:111], v[220:223]
  v_mfma_f32_16x16x32_bf16 v[220:223], v[24:27], v[92:95], v[220:223]
  ds_write_b128 v64, v[52:55] offset:1024
  s_waitcnt lgkmcnt(6)
  v_mfma_f32_16x16x32_bf16 v[236:239], v[32:35], v[92:95], v[236:239]
  v_mfma_f32_16x16x32_bf16 v[236:239], v[36:39], v[108:111], v[236:239]
  v_mfma_f32_16x16x32_bf16 v[232:235], v[36:39], v[104:107], v[232:235]
  ds_write_b128 v64, v[56:59] offset:4096
  v_mfma_f32_16x16x32_bf16 v[232:235], v[32:35], v[88:91], v[232:235]
  v_mfma_f32_16x16x32_bf16 v[228:231], v[32:35], v[84:87], v[228:231]
  v_mfma_f32_16x16x32_bf16 v[228:231], v[36:39], v[100:103], v[228:231]
  ds_write_b128 v64, v[60:63] offset:5120
  v_mfma_f32_16x16x32_bf16 v[224:227], v[36:39], v[96:99], v[224:227]
  v_mfma_f32_16x16x32_bf16 v[224:227], v[32:35], v[80:83], v[224:227]
  s_waitcnt lgkmcnt(4)
  v_mfma_f32_16x16x32_bf16 v[240:243], v[40:43], v[80:83], v[240:243]
  v_mfma_f32_16x16x32_bf16 v[240:243], v[44:47], v[96:99], v[240:243]
  v_mfma_f32_16x16x32_bf16 v[244:247], v[44:47], v[100:103], v[244:247]
  v_mfma_f32_16x16x32_bf16 v[244:247], v[40:43], v[84:87], v[244:247]
  v_mfma_f32_16x16x32_bf16 v[248:251], v[40:43], v[88:91], v[248:251]
  s_waitcnt lgkmcnt(0)
  s_setprio 2
  s_barrier
  v_mfma_f32_16x16x32_bf16 v[248:251], v[44:47], v[104:107], v[248:251]
  v_mfma_f32_16x16x32_bf16 v[252:255], v[44:47], v[108:111], v[252:255]
  v_mfma_f32_16x16x32_bf16 v[252:255], v[40:43], v[92:95], v[252:255]
  s_mul_i32 s74, s64, 1179648
  s_mul_i32 s75, s65, 57344
  s_add_u32 s74, s74, s75
  s_lshl_b32 s75, s77, 12
  s_add_u32 s74, s74, s75
  s_mul_i32 s75, s78, 25088
  s_add_u32 s74, s74, s75
  s_mul_i32 s82, s78, 7168
  s_add_u32 s82, s82, 512
  s_sub_u32 s83, 8192, s82
  v_max_f32 v144, 0, v144
  v_max_f32 v145, 0, v145
  v_max_f32 v146, 0, v146
  v_max_f32 v147, 0, v147
  v_pk_mul_f32 v[144:145], v[144:145], v[144:145]
  v_pk_mul_f32 v[146:147], v[146:147], v[146:147]
  v_cvt_pk_bf16_f32 v48, v144, v145
  v_cvt_pk_bf16_f32 v49, v146, v147
  v_max_f32 v148, 0, v148
  v_max_f32 v149, 0, v149
  v_max_f32 v150, 0, v150
  v_max_f32 v151, 0, v151
  v_pk_mul_f32 v[148:149], v[148:149], v[148:149]
  v_pk_mul_f32 v[150:151], v[150:151], v[150:151]
  v_cvt_pk_bf16_f32 v50, v148, v149
  v_cvt_pk_bf16_f32 v51, v150, v151
  s_nop 1
  v_permlane16_swap_b32 v48, v50
  v_permlane16_swap_b32 v49, v51
  buffer_store_dwordx4 v[48:51], v15, s[48:51], s74 offen offset:0 sc1
  v_max_f32 v152, 0, v152
  v_max_f32 v153, 0, v153
  v_max_f32 v154, 0, v154
  v_max_f32 v155, 0, v155
  v_pk_mul_f32 v[152:153], v[152:153], v[152:153]
  v_pk_mul_f32 v[154:155], v[154:155], v[154:155]
  v_cvt_pk_bf16_f32 v52, v152, v153
  v_cvt_pk_bf16_f32 v53, v154, v155
  v_max_f32 v156, 0, v156
  v_max_f32 v157, 0, v157
  v_max_f32 v158, 0, v158
  v_max_f32 v159, 0, v159
  v_pk_mul_f32 v[156:157], v[156:157], v[156:157]
  v_pk_mul_f32 v[158:159], v[158:159], v[158:159]
  v_cvt_pk_bf16_f32 v54, v156, v157
  v_cvt_pk_bf16_f32 v55, v158, v159
  s_nop 1
  v_permlane16_swap_b32 v52, v54
  v_permlane16_swap_b32 v53, v55
  buffer_store_dwordx4 v[52:55], v15, s[48:51], s74 offen offset:2048 sc1
  s_add_u32 s74, s74, s82
  v_max_f32 v160, 0, v160
  v_max_f32 v161, 0, v161
  v_max_f32 v162, 0, v162
  v_max_f32 v163, 0, v163
  v_pk_mul_f32 v[160:161], v[160:161], v[160:161]
  v_pk_mul_f32 v[162:163], v[162:163], v[162:163]
  v_cvt_pk_bf16_f32 v56, v160, v161
  v_cvt_pk_bf16_f32 v57, v162, v163
  v_max_f32 v164, 0, v164
  v_max_f32 v165, 0, v165
  v_max_f32 v166, 0, v166
  v_max_f32 v167, 0, v167
  v_pk_mul_f32 v[164:165], v[164:165], v[164:165]
  v_pk_mul_f32 v[166:167], v[166:167], v[166:167]
  v_cvt_pk_bf16_f32 v58, v164, v165
  v_cvt_pk_bf16_f32 v59, v166, v167
  s_nop 1
  v_permlane16_swap_b32 v56, v58
  v_permlane16_swap_b32 v57, v59
  buffer_store_dwordx4 v[56:59], v15, s[48:51], s74 offen offset:0 sc1
  v_max_f32 v168, 0, v168
  v_max_f32 v169, 0, v169
  v_max_f32 v170, 0, v170
  v_max_f32 v171, 0, v171
  v_pk_mul_f32 v[168:169], v[168:169], v[168:169]
  v_pk_mul_f32 v[170:171], v[170:171], v[170:171]
  v_cvt_pk_bf16_f32 v60, v168, v169
  v_cvt_pk_bf16_f32 v61, v170, v171
  v_max_f32 v172, 0, v172
  v_max_f32 v173, 0, v173
  v_max_f32 v174, 0, v174
  v_max_f32 v175, 0, v175
  v_pk_mul_f32 v[172:173], v[172:173], v[172:173]
  v_pk_mul_f32 v[174:175], v[174:175], v[174:175]
  v_cvt_pk_bf16_f32 v62, v172, v173
  v_cvt_pk_bf16_f32 v63, v174, v175
  s_nop 1
  v_permlane16_swap_b32 v60, v62
  v_permlane16_swap_b32 v61, v63
  buffer_store_dwordx4 v[60:63], v15, s[48:51], s74 offen offset:2048 sc1
  s_add_u32 s74, s74, s83
  v_max_f32 v176, 0, v176
  v_max_f32 v177, 0, v177
  v_max_f32 v178, 0, v178
  v_max_f32 v179, 0, v179
  v_pk_mul_f32 v[176:177], v[176:177], v[176:177]
  v_pk_mul_f32 v[178:179], v[178:179], v[178:179]
  v_cvt_pk_bf16_f32 v48, v176, v177
  v_cvt_pk_bf16_f32 v49, v178, v179
  v_max_f32 v180, 0, v180
  v_max_f32 v181, 0, v181
  v_max_f32 v182, 0, v182
  v_max_f32 v183, 0, v183
  v_pk_mul_f32 v[180:181], v[180:181], v[180:181]
  v_pk_mul_f32 v[182:183], v[182:183], v[182:183]
  v_cvt_pk_bf16_f32 v50, v180, v181
  v_cvt_pk_bf16_f32 v51, v182, v183
  s_nop 1
  v_permlane16_swap_b32 v48, v50
  v_permlane16_swap_b32 v49, v51
  buffer_store_dwordx4 v[48:51], v15, s[48:51], s74 offen offset:0 sc1
  v_max_f32 v184, 0, v184
  v_max_f32 v185, 0, v185
  v_max_f32 v186, 0, v186
  v_max_f32 v187, 0, v187
  v_pk_mul_f32 v[184:185], v[184:185], v[184:185]
  v_pk_mul_f32 v[186:187], v[186:187], v[186:187]
  v_cvt_pk_bf16_f32 v52, v184, v185
  v_cvt_pk_bf16_f32 v53, v186, v187
  v_max_f32 v188, 0, v188
  v_max_f32 v189, 0, v189
  v_max_f32 v190, 0, v190
  v_max_f32 v191, 0, v191
  v_pk_mul_f32 v[188:189], v[188:189], v[188:189]
  v_pk_mul_f32 v[190:191], v[190:191], v[190:191]
  v_cvt_pk_bf16_f32 v54, v188, v189
  v_cvt_pk_bf16_f32 v55, v190, v191
  s_nop 1
  v_permlane16_swap_b32 v52, v54
  v_permlane16_swap_b32 v53, v55
  buffer_store_dwordx4 v[52:55], v15, s[48:51], s74 offen offset:2048 sc1
  s_add_u32 s74, s74, s82
  v_max_f32 v192, 0, v192
  v_max_f32 v193, 0, v193
  v_max_f32 v194, 0, v194
  v_max_f32 v195, 0, v195
  v_pk_mul_f32 v[192:193], v[192:193], v[192:193]
  v_pk_mul_f32 v[194:195], v[194:195], v[194:195]
  v_cvt_pk_bf16_f32 v56, v192, v193
  v_cvt_pk_bf16_f32 v57, v194, v195
  v_max_f32 v196, 0, v196
  v_max_f32 v197, 0, v197
  v_max_f32 v198, 0, v198
  v_max_f32 v199, 0, v199
  v_pk_mul_f32 v[196:197], v[196:197], v[196:197]
  v_pk_mul_f32 v[198:199], v[198:199], v[198:199]
  v_cvt_pk_bf16_f32 v58, v196, v197
  v_cvt_pk_bf16_f32 v59, v198, v199
  s_nop 1
  v_permlane16_swap_b32 v56, v58
  v_permlane16_swap_b32 v57, v59
  buffer_store_dwordx4 v[56:59], v15, s[48:51], s74 offen offset:0 sc1
  v_max_f32 v200, 0, v200
  v_max_f32 v201, 0, v201
  v_max_f32 v202, 0, v202
  v_max_f32 v203, 0, v203
  v_pk_mul_f32 v[200:201], v[200:201], v[200:201]
  v_pk_mul_f32 v[202:203], v[202:203], v[202:203]
  v_cvt_pk_bf16_f32 v60, v200, v201
  v_cvt_pk_bf16_f32 v61, v202, v203
  v_max_f32 v204, 0, v204
  v_max_f32 v205, 0, v205
  v_max_f32 v206, 0, v206
  v_max_f32 v207, 0, v207
  v_pk_mul_f32 v[204:205], v[204:205], v[204:205]
  v_pk_mul_f32 v[206:207], v[206:207], v[206:207]
  v_cvt_pk_bf16_f32 v62, v204, v205
  v_cvt_pk_bf16_f32 v63, v206, v207
  s_nop 1
  v_permlane16_swap_b32 v60, v62
  v_permlane16_swap_b32 v61, v63
  buffer_store_dwordx4 v[60:63], v15, s[48:51], s74 offen offset:2048 sc1
  s_add_u32 s74, s74, s83
  v_max_f32 v208, 0, v208
  v_max_f32 v209, 0, v209
  v_max_f32 v210, 0, v210
  v_max_f32 v211, 0, v211
  v_pk_mul_f32 v[208:209], v[208:209], v[208:209]
  v_pk_mul_f32 v[210:211], v[210:211], v[210:211]
  v_cvt_pk_bf16_f32 v48, v208, v209
  v_cvt_pk_bf16_f32 v49, v210, v211
  v_max_f32 v212, 0, v212
  v_max_f32 v213, 0, v213
  v_max_f32 v214, 0, v214
  v_max_f32 v215, 0, v215
  v_pk_mul_f32 v[212:213], v[212:213], v[212:213]
  v_pk_mul_f32 v[214:215], v[214:215], v[214:215]
  v_cvt_pk_bf16_f32 v50, v212, v213
  v_cvt_pk_bf16_f32 v51, v214, v215
  s_nop 1
  v_permlane16_swap_b32 v48, v50
  v_permlane16_swap_b32 v49, v51
  buffer_store_dwordx4 v[48:51], v15, s[48:51], s74 offen offset:0 sc1
  v_max_f32 v216, 0, v216
  v_max_f32 v217, 0, v217
  v_max_f32 v218, 0, v218
  v_max_f32 v219, 0, v219
  v_pk_mul_f32 v[216:217], v[216:217], v[216:217]
  v_pk_mul_f32 v[218:219], v[218:219], v[218:219]
  v_cvt_pk_bf16_f32 v52, v216, v217
  v_cvt_pk_bf16_f32 v53, v218, v219
  v_max_f32 v220, 0, v220
  v_max_f32 v221, 0, v221
  v_max_f32 v222, 0, v222
  v_max_f32 v223, 0, v223
  v_pk_mul_f32 v[220:221], v[220:221], v[220:221]
  v_pk_mul_f32 v[222:223], v[222:223], v[222:223]
  v_cvt_pk_bf16_f32 v54, v220, v221
  v_cvt_pk_bf16_f32 v55, v222, v223
  s_nop 1
  v_permlane16_swap_b32 v52, v54
  v_permlane16_swap_b32 v53, v55
  buffer_store_dwordx4 v[52:55], v15, s[48:51], s74 offen offset:2048 sc1
  s_add_u32 s74, s74, s82
  v_max_f32 v224, 0, v224
  v_max_f32 v225, 0, v225
  v_max_f32 v226, 0, v226
  v_max_f32 v227, 0, v227
  v_pk_mul_f32 v[224:225], v[224:225], v[224:225]
  v_pk_mul_f32 v[226:227], v[226:227], v[226:227]
  v_cvt_pk_bf16_f32 v56, v224, v225
  v_cvt_pk_bf16_f32 v57, v226, v227
  v_max_f32 v228, 0, v228
  v_max_f32 v229, 0, v229
  v_max_f32 v230, 0, v230
  v_max_f32 v231, 0, v231
  v_pk_mul_f32 v[228:229], v[228:229], v[228:229]
  v_pk_mul_f32 v[230:231], v[230:231], v[230:231]
  v_cvt_pk_bf16_f32 v58, v228, v229
  v_cvt_pk_bf16_f32 v59, v230, v231
  s_nop 1
  v_permlane16_swap_b32 v56, v58
  v_permlane16_swap_b32 v57, v59
  buffer_store_dwordx4 v[56:59], v15, s[48:51], s74 offen offset:0 sc1
  v_max_f32 v232, 0, v232
  v_max_f32 v233, 0, v233
  v_max_f32 v234, 0, v234
  v_max_f32 v235, 0, v235
  v_pk_mul_f32 v[232:233], v[232:233], v[232:233]
  v_pk_mul_f32 v[234:235], v[234:235], v[234:235]
  v_cvt_pk_bf16_f32 v60, v232, v233
  v_cvt_pk_bf16_f32 v61, v234, v235
  v_max_f32 v236, 0, v236
  v_max_f32 v237, 0, v237
  v_max_f32 v238, 0, v238
  v_max_f32 v239, 0, v239
  v_pk_mul_f32 v[236:237], v[236:237], v[236:237]
  v_pk_mul_f32 v[238:239], v[238:239], v[238:239]
  v_cvt_pk_bf16_f32 v62, v236, v237
  v_cvt_pk_bf16_f32 v63, v238, v239
  s_nop 1
  v_permlane16_swap_b32 v60, v62
  v_permlane16_swap_b32 v61, v63
  buffer_store_dwordx4 v[60:63], v15, s[48:51], s74 offen offset:2048 sc1
  s_add_u32 s74, s74, s83
  v_max_f32 v240, 0, v240
  v_max_f32 v241, 0, v241
  v_max_f32 v242, 0, v242
  v_max_f32 v243, 0, v243
  v_pk_mul_f32 v[240:241], v[240:241], v[240:241]
  v_pk_mul_f32 v[242:243], v[242:243], v[242:243]
  v_cvt_pk_bf16_f32 v48, v240, v241
  v_cvt_pk_bf16_f32 v49, v242, v243
  v_max_f32 v244, 0, v244
  v_max_f32 v245, 0, v245
  v_max_f32 v246, 0, v246
  v_max_f32 v247, 0, v247
  v_pk_mul_f32 v[244:245], v[244:245], v[244:245]
  v_pk_mul_f32 v[246:247], v[246:247], v[246:247]
  v_cvt_pk_bf16_f32 v50, v244, v245
  v_cvt_pk_bf16_f32 v51, v246, v247
  s_nop 1
  v_permlane16_swap_b32 v48, v50
  v_permlane16_swap_b32 v49, v51
  buffer_store_dwordx4 v[48:51], v15, s[48:51], s74 offen offset:0 sc1
  v_max_f32 v248, 0, v248
  v_max_f32 v249, 0, v249
  v_max_f32 v250, 0, v250
  v_max_f32 v251, 0, v251
  v_pk_mul_f32 v[248:249], v[248:249], v[248:249]
  v_pk_mul_f32 v[250:251], v[250:251], v[250:251]
  v_cvt_pk_bf16_f32 v52, v248, v249
  v_cvt_pk_bf16_f32 v53, v250, v251
  v_max_f32 v252, 0, v252
  v_max_f32 v253, 0, v253
  v_max_f32 v254, 0, v254
  v_max_f32 v255, 0, v255
  v_pk_mul_f32 v[252:253], v[252:253], v[252:253]
  v_pk_mul_f32 v[254:255], v[254:255], v[254:255]
  v_cvt_pk_bf16_f32 v54, v252, v253
  v_cvt_pk_bf16_f32 v55, v254, v255
  s_nop 1
  v_permlane16_swap_b32 v52, v54
  v_permlane16_swap_b32 v53, v55
  buffer_store_dwordx4 v[52:55], v15, s[48:51], s74 offen offset:2048 sc1
  s_add_u32 s74, s74, s82
  s_mov_b32 s36, s20
  s_mov_b32 s37, s21
  s_mov_b32 s38, 7340032
  s_mov_b32 s39, 0x20000
  s_lshl_b32 s81, s69, 14
  s_mul_i32 s79, s69, 1835008
  s_add_u32 m0, s81, 0
  s_nop 0
  buffer_load_dwordx4 v3, s[36:39], s79 offen offset:0 lds
  buffer_load_dwordx4 v4, s[36:39], s79 offen offset:1024 lds
  buffer_load_dwordx4 v5, s[36:39], s79 offen offset:2048 lds
  buffer_load_dwordx4 v6, s[36:39], s79 offen offset:3072 lds
  s_add_u32 s79, s79, 65536
  s_add_u32 m0, s81, 4096
  s_nop 0
  buffer_load_dwordx4 v3, s[36:39], s79 offen offset:0 lds
  buffer_load_dwordx4 v4, s[36:39], s79 offen offset:1024 lds
  buffer_load_dwordx4 v5, s[36:39], s79 offen offset:2048 lds
  buffer_load_dwordx4 v6, s[36:39], s79 offen offset:3072 lds
  s_add_u32 s79, s79, 65536
  s_lshr_b32 s71, s65, 2
  s_and_b32 s72, s65, 3
  s_lshl_b32 s70, s64, 13
  s_lshl_b32 s71, s71, 7
  s_add_u32 s70, s70, s71
  s_lshl2_add_u32 s70, s72, s70
  s_add_u32 s70, s70, 19169280
  v_mov_b32 v17, 155652
  v_mov_b32 v15, 1
  s_waitcnt vmcnt(8)
  s_mov_b64 exec, 1
  ds_add_rtn_u32 v16, v17, v15
  s_mov_b64 exec, 0xffff
  v_lshlrev_b32 v17, 9, v0
  s_waitcnt lgkmcnt(0)
  v_readfirstlane_b32 s71, v16
  s_cmp_eq_u32 s71, 3
  s_cbranch_scc0 L_nofl_1
  buffer_store_dword v15, v17, s[48:51], s70 offen sc1
L_nofl_1:
  s_mov_b64 exec, -1
  s_add_u32 m0, s81, 8192
  s_nop 0
  buffer_load_dwordx4 v3, s[36:39], s79 offen offset:0 lds
  buffer_load_dwordx4 v4, s[36:39], s79 offen offset:1024 lds
  buffer_load_dwordx4 v5, s[36:39], s79 offen offset:2048 lds
  buffer_load_dwordx4 v6, s[36:39], s79 offen offset:3072 lds
  s_add_u32 s79, s79, 65536
  s_add_u32 m0, s81, 12288
  s_nop 0
  buffer_load_dwordx4 v3, s[36:39], s79 offen offset:0 lds
  buffer_load_dwordx4 v4, s[36:39], s79 offen offset:1024 lds
  buffer_load_dwordx4 v5, s[36:39], s79 offen offset:2048 lds
  buffer_load_dwordx4 v6, s[36:39], s79 offen offset:3072 lds
  s_add_u32 s79, s79, 65536
  s_mul_i32 s80, s66, 1179648
  s_mul_i32 s71, s69, 229376
  s_add_u32 s80, s80, s71
  s_lshl_b32 s72, s66, 9
  s_add_u32 s72, s72, 19136512
  v_lshlrev_b32 v15, 2, v1
  s_add_u32 s70, s69, 1
  s_and_b32 s70, s70, 3
  s_lshl_b32 s70, s70, 7
  s_add_u32 s70, s70, s72
  buffer_load_dword v16, v15, s[48:51], s70 offen offset:0 sc1
  buffer_load_dword v18, v15, s[48:51], s70 offen offset:64 sc1
  s_add_u32 s70, s69, 2
  s_and_b32 s70, s70, 3
  s_lshl_b32 s70, s70, 7
  s_add_u32 s70, s70, s72
  buffer_load_dword v20, v15, s[48:51], s70 offen offset:0 sc1
  buffer_load_dword v22, v15, s[48:51], s70 offen offset:64 sc1
  s_add_u32 s70, s69, 3
  s_and_b32 s70, s70, 3
  s_lshl_b32 s70, s70, 7
  s_add_u32 s70, s70, s72
  buffer_load_dword v24, v15, s[48:51], s70 offen offset:0 sc1
  buffer_load_dword v26, v15, s[48:51], s70 offen offset:64 sc1
  s_add_u32 s70, s69, 4
  s_and_b32 s70, s70, 3
  s_lshl_b32 s70, s70, 7
  s_add_u32 s70, s70, s72
  buffer_load_dword v28, v15, s[48:51], s70 offen offset:0 sc1
  buffer_load_dword v30, v15, s[48:51], s70 offen offset:64 sc1
  s_bfe_u32 s70, s2, 0x10002
  s_lshl_b32 s70, s70, 5
  s_add_u32 s73, s70, s68
  s_lshl_b32 s70, s69, 6
  s_add_u32 s70, s70, s73
  s_lshr_b32 s83, s70, 5
  s_bfe_u32 s71, s70, 0x20003
  s_mul_i32 s71, s71, 1835008
  s_and_b32 s70, s70, 7
  s_lshl_b32 s70, s70, 15
  s_add_u32 s70, s70, s71
  s_add_u32 s71, s83, 2
  s_lshl_b32 s71, s71, 18
  s_add_u32 s70, s70, s71
  s_cmp_eq_u32 s83, 5
  s_cselect_b32 s83, -1, s83
  s_lshl_b32 s71, s73, 15
  s_and_b32 s72, s67, 3
  s_lshl_b32 s72, s72, 7
  s_add_u32 s70, s70, s72
  s_add_u32 s71, s71, s72
  s_and_b32 s72, s68, 1
  s_add_u32 s72, s72, 2
  s_cmp_eq_u32 s69, 3
  s_cselect_b32 s77, s71, s70
  s_cselect_b32 s83, s72, s83
  s_cselect_b32 s56, s12, s20
  s_cselect_b32 s57, s13, s21
  s_mov_b32 s70, 7340032
  s_cselect_b32 s58, 2097152, s70
  s_mov_b32 s59, 0x20000
  s_lshl_b32 s70, s66, 4
  s_add_u32 s70, s70, s67
  s_lshl_b32 s70, s70, 2
  s_add_u32 s70, s70, s69
  s_lshl_b32 s70, s70, 7
  s_add_u32 s70, s70, 19169280
  v_and_b32 v15, 3, v0
  v_lshlrev_b32 v15, 2, v15
  s_mov_b32 s71, 262144
  s_mov_b64 exec, 15
L_wh:
  buffer_load_dword v17, v15, s[48:51], s70 offen sc1
  s_waitcnt vmcnt(0)
  v_cmp_ne_u32 vcc, 1, v17
  s_sub_u32 s71, s71, 1
  s_cbranch_vccz L_wh_x
  s_sleep 2
  s_cmp_lg_u32 s71, 0
  s_cbranch_scc1 L_wh
L_wh_x:
  s_mov_b64 exec, -1
  ds_read_b64_tr_b16 v[32:33], v7 offset:0
  ds_read_b64_tr_b16 v[34:35], v7 offset:512
  ds_read_b64_tr_b16 v[48:49], v7 offset:4096
  ds_read_b64_tr_b16 v[50:51], v7 offset:4608
  ds_read_b64_tr_b16 v[36:37], v8 offset:0
  ds_read_b64_tr_b16 v[38:39], v8 offset:512
  ds_read_b64_tr_b16 v[52:53], v8 offset:4096
  ds_read_b64_tr_b16 v[54:55], v8 offset:4608
  ds_read_b64_tr_b16 v[40:41], v9 offset:0
  ds_read_b64_tr_b16 v[42:43], v9 offset:512
  ds_read_b64_tr_b16 v[56:57], v9 offset:4096
  ds_read_b64_tr_b16 v[58:59], v9 offset:4608
  ds_read_b64_tr_b16 v[44:45], v10 offset:0
  ds_read_b64_tr_b16 v[46:47], v10 offset:512
  ds_read_b64_tr_b16 v[60:61], v10 offset:4096
  ds_read_b64_tr_b16 v[62:63], v10 offset:4608
  s_add_u32 s78, s80, 8192
  buffer_load_dwordx4 v[64:67], v11, s[48:51], s80 offen offset:0 sc1
  buffer_load_dwordx4 v[96:99], v11, s[48:51], s78 offen offset:0 sc1
  buffer_load_dwordx4 v[68:71], v11, s[48:51], s80 offen offset:1024 sc1
  buffer_load_dwordx4 v[100:103], v11, s[48:51], s78 offen offset:1024 sc1
  buffer_load_dwordx4 v[72:75], v12, s[48:51], s80 offen offset:0 sc1
  buffer_load_dwordx4 v[104:107], v12, s[48:51], s78 offen offset:0 sc1
  buffer_load_dwordx4 v[76:79], v12, s[48:51], s80 offen offset:1024 sc1
  buffer_load_dwordx4 v[108:111], v12, s[48:51], s78 offen offset:1024 sc1
  buffer_load_dwordx4 v[80:83], v13, s[48:51], s80 offen offset:0 sc1
  buffer_load_dwordx4 v[112:115], v13, s[48:51], s78 offen offset:0 sc1
  buffer_load_dwordx4 v[84:87], v13, s[48:51], s80 offen offset:1024 sc1
  buffer_load_dwordx4 v[116:119], v13, s[48:51], s78 offen offset:1024 sc1
  buffer_load_dwordx4 v[88:91], v14, s[48:51], s80 offen offset:0 sc1
  buffer_load_dwordx4 v[120:123], v14, s[48:51], s78 offen offset:0 sc1
  buffer_load_dwordx4 v[92:95], v14, s[48:51], s80 offen offset:1024 sc1
  buffer_load_dwordx4 v[124:127], v14, s[48:51], s78 offen offset:1024 sc1
  s_add_u32 s80, s80, 16384
  s_add_u32 s78, s78, 16384
  v_sub_f32 v16, 1.0, v16
  v_sub_f32 v18, 1.0, v18
  v_sub_f32 v20, 1.0, v20
  v_sub_f32 v22, 1.0, v22
  v_sub_f32 v24, 1.0, v24
  v_sub_f32 v26, 1.0, v26
  v_sub_f32 v28, 1.0, v28
  v_sub_f32 v30, 1.0, v30
  s_setprio 0
  s_mov_b32 s76, 0
  s_waitcnt vmcnt(12) lgkmcnt(8)
  v_mfma_f32_16x16x32_bf16 v[128:131], v[32:35], v[64:67], 0
  v_mfma_f32_16x16x32_bf16 v[128:131], v[48:51], v[96:99], v[128:131]
  v_mfma_f32_16x16x32_bf16 v[144:147], v[48:51], v[100:103], 0
  v_mfma_f32_16x16x32_bf16 v[144:147], v[32:35], v[68:71], v[144:147]
  v_mfma_f32_16x16x32_bf16 v[148:151], v[36:39], v[68:71], 0
  v_mfma_f32_16x16x32_bf16 v[148:151], v[52:55], v[100:103], v[148:151]
  v_mfma_f32_16x16x32_bf16 v[132:135], v[52:55], v[96:99], 0
  v_mfma_f32_16x16x32_bf16 v[132:135], v[36:39], v[64:67], v[132:135]
  s_waitcnt lgkmcnt(0)
  v_mfma_f32_16x16x32_bf16 v[136:139], v[40:43], v[64:67], 0
  v_mfma_f32_16x16x32_bf16 v[136:139], v[56:59], v[96:99], v[136:139]
  v_mfma_f32_16x16x32_bf16 v[152:155], v[56:59], v[100:103], 0
  v_mfma_f32_16x16x32_bf16 v[152:155], v[40:43], v[68:71], v[152:155]
  v_mfma_f32_16x16x32_bf16 v[156:159], v[44:47], v[68:71], 0
  v_mfma_f32_16x16x32_bf16 v[156:159], v[60:63], v[100:103], v[156:159]
  v_mfma_f32_16x16x32_bf16 v[140:143], v[60:63], v[96:99], 0
  v_mfma_f32_16x16x32_bf16 v[140:143], v[44:47], v[64:67], v[140:143]
  buffer_load_dwordx4 v[64:67], v11, s[48:51], s80 offen offset:0 sc1
  buffer_load_dwordx4 v[96:99], v11, s[48:51], s78 offen offset:0 sc1
  buffer_load_dwordx4 v[68:71], v11, s[48:51], s80 offen offset:1024 sc1
  buffer_load_dwordx4 v[100:103], v11, s[48:51], s78 offen offset:1024 sc1
  s_waitcnt vmcnt(12)
  v_mfma_f32_16x16x32_bf16 v[160:163], v[32:35], v[72:75], 0
  v_mfma_f32_16x16x32_bf16 v[160:163], v[48:51], v[104:107], v[160:163]
  v_mfma_f32_16x16x32_bf16 v[176:179], v[48:51], v[108:111], 0
  v_mfma_f32_16x16x32_bf16 v[176:179], v[32:35], v[76:79], v[176:179]
  v_mfma_f32_16x16x32_bf16 v[180:183], v[36:39], v[76:79], 0
  v_mfma_f32_16x16x32_bf16 v[180:183], v[52:55], v[108:111], v[180:183]
  v_mfma_f32_16x16x32_bf16 v[164:167], v[52:55], v[104:107], 0
  v_mfma_f32_16x16x32_bf16 v[164:167], v[36:39], v[72:75], v[164:167]
  s_add_u32 m0, s81, 0
  s_nop 0
  buffer_load_dwordx4 v3, s[36:39], s79 offen offset:0 lds
  buffer_load_dwordx4 v4, s[36:39], s79 offen offset:1024 lds
  buffer_load_dwordx4 v5, s[36:39], s79 offen offset:2048 lds
  buffer_load_dwordx4 v6, s[36:39], s79 offen offset:3072 lds
  s_add_u32 s79, s79, 65536
  v_mfma_f32_16x16x32_bf16 v[168:171], v[40:43], v[72:75], 0
  v_mfma_f32_16x16x32_bf16 v[168:171], v[56:59], v[104:107], v[168:171]
  v_mfma_f32_16x16x32_bf16 v[184:187], v[56:59], v[108:111], 0
  v_mfma_f32_16x16x32_bf16 v[184:187], v[40:43], v[76:79], v[184:187]
  v_mfma_f32_16x16x32_bf16 v[188:191], v[44:47], v[76:79], 0
  v_mfma_f32_16x16x32_bf16 v[188:191], v[60:63], v[108:111], v[188:191]
  v_mfma_f32_16x16x32_bf16 v[172:175], v[60:63], v[104:107], 0
  v_mfma_f32_16x16x32_bf16 v[172:175], v[44:47], v[72:75], v[172:175]
  buffer_load_dwordx4 v[72:75], v12, s[48:51], s80 offen offset:0 sc1
  buffer_load_dwordx4 v[104:107], v12, s[48:51], s78 offen offset:0 sc1
  buffer_load_dwordx4 v[76:79], v12, s[48:51], s80 offen offset:1024 sc1
  buffer_load_dwordx4 v[108:111], v12, s[48:51], s78 offen offset:1024 sc1
  s_waitcnt vmcnt(16)
  v_mfma_f32_16x16x32_bf16 v[192:195], v[32:35], v[80:83], 0
  v_mfma_f32_16x16x32_bf16 v[192:195], v[48:51], v[112:115], v[192:195]
  v_mfma_f32_16x16x32_bf16 v[208:211], v[48:51], v[116:119], 0
  v_mfma_f32_16x16x32_bf16 v[208:211], v[32:35], v[84:87], v[208:211]
  v_mfma_f32_16x16x32_bf16 v[212:215], v[36:39], v[84:87], 0
  v_mfma_f32_16x16x32_bf16 v[212:215], v[52:55], v[116:119], v[212:215]
  v_mfma_f32_16x16x32_bf16 v[196:199], v[52:55], v[112:115], 0
  v_mfma_f32_16x16x32_bf16 v[196:199], v[36:39], v[80:83], v[196:199]
  s_add_u32 m0, s81, 4096
  s_nop 0
  buffer_load_dwordx4 v3, s[36:39], s79 offen offset:0 lds
  buffer_load_dwordx4 v4, s[36:39], s79 offen offset:1024 lds
  buffer_load_dwordx4 v5, s[36:39], s79 offen offset:2048 lds
  buffer_load_dwordx4 v6, s[36:39], s79 offen offset:3072 lds
  s_add_u32 s79, s79, 65536
  v_mfma_f32_16x16x32_bf16 v[200:203], v[40:43], v[80:83], 0
  v_mfma_f32_16x16x32_bf16 v[200:203], v[56:59], v[112:115], v[200:203]
  v_mfma_f32_16x16x32_bf16 v[216:219], v[56:59], v[116:119], 0
  v_mfma_f32_16x16x32_bf16 v[216:219], v[40:43], v[84:87], v[216:219]
  v_mfma_f32_16x16x32_bf16 v[220:223], v[44:47], v[84:87], 0
  v_mfma_f32_16x16x32_bf16 v[220:223], v[60:63], v[116:119], v[220:223]
  v_mfma_f32_16x16x32_bf16 v[204:207], v[60:63], v[112:115], 0
  v_mfma_f32_16x16x32_bf16 v[204:207], v[44:47], v[80:83], v[204:207]
  buffer_load_dwordx4 v[80:83], v13, s[48:51], s80 offen offset:0 sc1
  buffer_load_dwordx4 v[112:115], v13, s[48:51], s78 offen offset:0 sc1
  buffer_load_dwordx4 v[84:87], v13, s[48:51], s80 offen offset:1024 sc1
  buffer_load_dwordx4 v[116:119], v13, s[48:51], s78 offen offset:1024 sc1
  s_waitcnt vmcnt(20)
  v_mfma_f32_16x16x32_bf16 v[224:227], v[32:35], v[88:91], 0
  v_mfma_f32_16x16x32_bf16 v[224:227], v[48:51], v[120:123], v[224:227]
  v_mfma_f32_16x16x32_bf16 v[240:243], v[48:51], v[124:127], 0
  v_mfma_f32_16x16x32_bf16 v[240:243], v[32:35], v[92:95], v[240:243]
  v_mfma_f32_16x16x32_bf16 v[244:247], v[36:39], v[92:95], 0
  v_mfma_f32_16x16x32_bf16 v[244:247], v[52:55], v[124:127], v[244:247]
  v_mfma_f32_16x16x32_bf16 v[228:231], v[52:55], v[120:123], 0
  v_mfma_f32_16x16x32_bf16 v[228:231], v[36:39], v[88:91], v[228:231]
  ds_read_b64_tr_b16 v[32:33], v7 offset:8192
  ds_read_b64_tr_b16 v[34:35], v7 offset:8704
  ds_read_b64_tr_b16 v[48:49], v7 offset:12288
  ds_read_b64_tr_b16 v[50:51], v7 offset:12800
  ds_read_b64_tr_b16 v[36:37], v8 offset:8192
  ds_read_b64_tr_b16 v[38:39], v8 offset:8704
  ds_read_b64_tr_b16 v[52:53], v8 offset:12288
  ds_read_b64_tr_b16 v[54:55], v8 offset:12800
  v_mfma_f32_16x16x32_bf16 v[232:235], v[40:43], v[88:91], 0
  v_mfma_f32_16x16x32_bf16 v[232:235], v[56:59], v[120:123], v[232:235]
  v_mfma_f32_16x16x32_bf16 v[248:251], v[56:59], v[124:127], 0
  v_mfma_f32_16x16x32_bf16 v[248:251], v[40:43], v[92:95], v[248:251]
  v_mfma_f32_16x16x32_bf16 v[252:255], v[44:47], v[92:95], 0
  v_mfma_f32_16x16x32_bf16 v[252:255], v[60:63], v[124:127], v[252:255]
  v_mfma_f32_16x16x32_bf16 v[236:239], v[60:63], v[120:123], 0
  v_mfma_f32_16x16x32_bf16 v[236:239], v[44:47], v[88:91], v[236:239]
  buffer_load_dwordx4 v[88:91], v14, s[48:51], s80 offen offset:0 sc1
  buffer_load_dwordx4 v[120:123], v14, s[48:51], s78 offen offset:0 sc1
  buffer_load_dwordx4 v[92:95], v14, s[48:51], s80 offen offset:1024 sc1
  buffer_load_dwordx4 v[124:127], v14, s[48:51], s78 offen offset:1024 sc1
  s_add_u32 s80, s80, 16384
  s_add_u32 s78, s78, 16384
.p2align 3
L_g2loop:
  s_cmp_eq_u32 s76, s83
  s_cbranch_scc1 L_hookF
L_hookF_r:
  s_waitcnt vmcnt(20) lgkmcnt(0)
  v_mfma_f32_16x16x32_bf16 v[128:131], v[32:35], v[64:67], v[128:131]
  v_mfma_f32_16x16x32_bf16 v[128:131], v[48:51], v[96:99], v[128:131]
  v_mfma_f32_16x16x32_bf16 v[144:147], v[48:51], v[100:103], v[144:147]
  v_mfma_f32_16x16x32_bf16 v[144:147], v[32:35], v[68:71], v[144:147]
  v_mfma_f32_16x16x32_bf16 v[148:151], v[36:39], v[68:71], v[148:151]
  v_mfma_f32_16x16x32_bf16 v[148:151], v[52:55], v[100:103], v[148:151]
  v_mfma_f32_16x16x32_bf16 v[132:135], v[52:55], v[96:99], v[132:135]
  v_mfma_f32_16x16x32_bf16 v[132:135], v[36:39], v[64:67], v[132:135]
  ds_read_b64_tr_b16 v[40:41], v9 offset:8192
  ds_read_b64_tr_b16 v[42:43], v9 offset:8704
  ds_read_b64_tr_b16 v[56:57], v9 offset:12288
  ds_read_b64_tr_b16 v[58:59], v9 offset:12800
  ds_read_b64_tr_b16 v[44:45], v10 offset:8192
  ds_read_b64_tr_b16 v[46:47], v10 offset:8704
  ds_read_b64_tr_b16 v[60:61], v10 offset:12288
  ds_read_b64_tr_b16 v[62:63], v10 offset:12800
  s_waitcnt lgkmcnt(0)
  v_mfma_f32_16x16x32_bf16 v[136:139], v[40:43], v[64:67], v[136:139]
  v_mfma_f32_16x16x32_bf16 v[136:139], v[56:59], v[96:99], v[136:139]
  v_mfma_f32_16x16x32_bf16 v[152:155], v[56:59], v[100:103], v[152:155]
  v_mfma_f32_16x16x32_bf16 v[152:155], v[40:43], v[68:71], v[152:155]
  v_mfma_f32_16x16x32_bf16 v[156:159], v[44:47], v[68:71], v[156:159]
  v_mfma_f32_16x16x32_bf16 v[156:159], v[60:63], v[100:103], v[156:159]
  v_mfma_f32_16x16x32_bf16 v[140:143], v[60:63], v[96:99], v[140:143]
  v_mfma_f32_16x16x32_bf16 v[140:143], v[44:47], v[64:67], v[140:143]
  buffer_load_dwordx4 v[64:67], v11, s[48:51], s80 offen offset:0 sc1
  buffer_load_dwordx4 v[96:99], v11, s[48:51], s78 offen offset:0 sc1
  buffer_load_dwordx4 v[68:71], v11, s[48:51], s80 offen offset:1024 sc1
  buffer_load_dwordx4 v[100:103], v11, s[48:51], s78 offen offset:1024 sc1
  s_waitcnt vmcnt(16)
  v_mfma_f32_16x16x32_bf16 v[160:163], v[32:35], v[72:75], v[160:163]
  v_mfma_f32_16x16x32_bf16 v[160:163], v[48:51], v[104:107], v[160:163]
  v_mfma_f32_16x16x32_bf16 v[176:179], v[48:51], v[108:111], v[176:179]
  v_mfma_f32_16x16x32_bf16 v[176:179], v[32:35], v[76:79], v[176:179]
  v_mfma_f32_16x16x32_bf16 v[180:183], v[36:39], v[76:79], v[180:183]
  v_mfma_f32_16x16x32_bf16 v[180:183], v[52:55], v[108:111], v[180:183]
  v_mfma_f32_16x16x32_bf16 v[164:167], v[52:55], v[104:107], v[164:167]
  v_mfma_f32_16x16x32_bf16 v[164:167], v[36:39], v[72:75], v[164:167]
  s_add_u32 m0, s81, 8192
  s_nop 0
  buffer_load_dwordx4 v3, s[36:39], s79 offen offset:0 lds
  buffer_load_dwordx4 v4, s[36:39], s79 offen offset:1024 lds
  buffer_load_dwordx4 v5, s[36:39], s79 offen offset:2048 lds
  buffer_load_dwordx4 v6, s[36:39], s79 offen offset:3072 lds
  s_add_u32 s79, s79, 65536
  v_mfma_f32_16x16x32_bf16 v[168:171], v[40:43], v[72:75], v[168:171]
  v_mfma_f32_16x16x32_bf16 v[168:171], v[56:59], v[104:107], v[168:171]
  v_mfma_f32_16x16x32_bf16 v[184:187], v[56:59], v[108:111], v[184:187]
  v_mfma_f32_16x16x32_bf16 v[184:187], v[40:43], v[76:79], v[184:187]
  v_mfma_f32_16x16x32_bf16 v[188:191], v[44:47], v[76:79], v[188:191]
  v_mfma_f32_16x16x32_bf16 v[188:191], v[60:63], v[108:111], v[188:191]
  v_mfma_f32_16x16x32_bf16 v[172:175], v[60:63], v[104:107], v[172:175]
  v_mfma_f32_16x16x32_bf16 v[172:175], v[44:47], v[72:75], v[172:175]
  buffer_load_dwordx4 v[72:75], v12, s[48:51], s80 offen offset:0 sc1
  buffer_load_dwordx4 v[104:107], v12, s[48:51], s78 offen offset:0 sc1
  buffer_load_dwordx4 v[76:79], v12, s[48:51], s80 offen offset:1024 sc1
  buffer_load_dwordx4 v[108:111], v12, s[48:51], s78 offen offset:1024 sc1
  s_waitcnt vmcnt(16)
  v_mfma_f32_16x16x32_bf16 v[192:195], v[32:35], v[80:83], v[192:195]
  v_mfma_f32_16x16x32_bf16 v[192:195], v[48:51], v[112:115], v[192:195]
  v_mfma_f32_16x16x32_bf16 v[208:211], v[48:51], v[116:119], v[208:211]
  v_mfma_f32_16x16x32_bf16 v[208:211], v[32:35], v[84:87], v[208:211]
  v_mfma_f32_16x16x32_bf16 v[212:215], v[36:39], v[84:87], v[212:215]
  v_mfma_f32_16x16x32_bf16 v[212:215], v[52:55], v[116:119], v[212:215]
  v_mfma_f32_16x16x32_bf16 v[196:199], v[52:55], v[112:115], v[196:199]
  v_mfma_f32_16x16x32_bf16 v[196:199], v[36:39], v[80:83], v[196:199]
  s_add_u32 m0, s81, 12288
  s_nop 0
  buffer_load_dwordx4 v3, s[36:39], s79 offen offset:0 lds
  buffer_load_dwordx4 v4, s[36:39], s79 offen offset:1024 lds
  buffer_load_dwordx4 v5, s[36:39], s79 offen offset:2048 lds
  buffer_load_dwordx4 v6, s[36:39], s79 offen offset:3072 lds
  s_add_u32 s79, s79, 65536
  v_mfma_f32_16x16x32_bf16 v[200:203], v[40:43], v[80:83], v[200:203]
  v_mfma_f32_16x16x32_bf16 v[200:203], v[56:59], v[112:115], v[200:203]
  v_mfma_f32_16x16x32_bf16 v[216:219], v[56:59], v[116:119], v[216:219]
  v_mfma_f32_16x16x32_bf16 v[216:219], v[40:43], v[84:87], v[216:219]
  v_mfma_f32_16x16x32_bf16 v[220:223], v[44:47], v[84:87], v[220:223]
  v_mfma_f32_16x16x32_bf16 v[220:223], v[60:63], v[116:119], v[220:223]
  v_mfma_f32_16x16x32_bf16 v[204:207], v[60:63], v[112:115], v[204:207]
  v_mfma_f32_16x16x32_bf16 v[204:207], v[44:47], v[80:83], v[204:207]
  buffer_load_dwordx4 v[80:83], v13, s[48:51], s80 offen offset:0 sc1
  buffer_load_dwordx4 v[112:115], v13, s[48:51], s78 offen offset:0 sc1
  buffer_load_dwordx4 v[84:87], v13, s[48:51], s80 offen offset:1024 sc1
  buffer_load_dwordx4 v[116:119], v13, s[48:51], s78 offen offset:1024 sc1
  s_waitcnt vmcnt(20)
  v_mfma_f32_16x16x32_bf16 v[224:227], v[32:35], v[88:91], v[224:227]
  v_mfma_f32_16x16x32_bf16 v[224:227], v[48:51], v[120:123], v[224:227]
  v_mfma_f32_16x16x32_bf16 v[240:243], v[48:51], v[124:127], v[240:243]
  v_mfma_f32_16x16x32_bf16 v[240:243], v[32:35], v[92:95], v[240:243]
  v_mfma_f32_16x16x32_bf16 v[244:247], v[36:39], v[92:95], v[244:247]
  v_mfma_f32_16x16x32_bf16 v[244:247], v[52:55], v[124:127], v[244:247]
  v_mfma_f32_16x16x32_bf16 v[228:231], v[52:55], v[120:123], v[228:231]
  v_mfma_f32_16x16x32_bf16 v[228:231], v[36:39], v[88:91], v[228:231]
  ds_read_b64_tr_b16 v[32:33], v7 offset:0
  ds_read_b64_tr_b16 v[34:35], v7 offset:512
  ds_read_b64_tr_b16 v[48:49], v7 offset:4096
  ds_read_b64_tr_b16 v[50:51], v7 offset:4608
  ds_read_b64_tr_b16 v[36:37], v8 offset:0
  ds_read_b64_tr_b16 v[38:39], v8 offset:512
  ds_read_b64_tr_b16 v[52:53], v8 offset:4096
  ds_read_b64_tr_b16 v[54:55], v8 offset:4608
  v_mfma_f32_16x16x32_bf16 v[232:235], v[40:43], v[88:91], v[232:235]
  v_mfma_f32_16x16x32_bf16 v[232:235], v[56:59], v[120:123], v[232:235]
  v_mfma_f32_16x16x32_bf16 v[248:251], v[56:59], v[124:127], v[248:251]
  v_mfma_f32_16x16x32_bf16 v[248:251], v[40:43], v[92:95], v[248:251]
  v_mfma_f32_16x16x32_bf16 v[252:255], v[44:47], v[92:95], v[252:255]
  v_mfma_f32_16x16x32_bf16 v[252:255], v[60:63], v[124:127], v[252:255]
  v_mfma_f32_16x16x32_bf16 v[236:239], v[60:63], v[120:123], v[236:239]
  v_mfma_f32_16x16x32_bf16 v[236:239], v[44:47], v[88:91], v[236:239]
  buffer_load_dwordx4 v[88:91], v14, s[48:51], s80 offen offset:0 sc1
  buffer_load_dwordx4 v[120:123], v14, s[48:51], s78 offen offset:0 sc1
  buffer_load_dwordx4 v[92:95], v14, s[48:51], s80 offen offset:1024 sc1
  buffer_load_dwordx4 v[124:127], v14, s[48:51], s78 offen offset:1024 sc1
  s_add_u32 s80, s80, 16384
  s_add_u32 s78, s78, 16384
  s_cmp_ge_u32 s76, 4
  s_cbranch_scc1 L_hookW
L_hookW_r:
  s_waitcnt vmcnt(20) lgkmcnt(0)
  v_mfma_f32_16x16x32_bf16 v[128:131], v[32:35], v[64:67], v[128:131]
  v_mfma_f32_16x16x32_bf16 v[128:131], v[48:51], v[96:99], v[128:131]
  v_mfma_f32_16x16x32_bf16 v[144:147], v[48:51], v[100:103], v[144:147]
  v_mfma_f32_16x16x32_bf16 v[144:147], v[32:35], v[68:71], v[144:147]
  v_mfma_f32_16x16x32_bf16 v[148:151], v[36:39], v[68:71], v[148:151]
  v_mfma_f32_16x16x32_bf16 v[148:151], v[52:55], v[100:103], v[148:151]
  v_mfma_f32_16x16x32_bf16 v[132:135], v[52:55], v[96:99], v[132:135]
  v_mfma_f32_16x16x32_bf16 v[132:135], v[36:39], v[64:67], v[132:135]
  ds_read_b64_tr_b16 v[40:41], v9 offset:0
  ds_read_b64_tr_b16 v[42:43], v9 offset:512
  ds_read_b64_tr_b16 v[56:57], v9 offset:4096
  ds_read_b64_tr_b16 v[58:59], v9 offset:4608
  ds_read_b64_tr_b16 v[44:45], v10 offset:0
  ds_read_b64_tr_b16 v[46:47], v10 offset:512
  ds_read_b64_tr_b16 v[60:61], v10 offset:4096
  ds_read_b64_tr_b16 v[62:63], v10 offset:4608
  s_waitcnt lgkmcnt(0)
  v_mfma_f32_16x16x32_bf16 v[136:139], v[40:43], v[64:67], v[136:139]
  v_mfma_f32_16x16x32_bf16 v[136:139], v[56:59], v[96:99], v[136:139]
  v_mfma_f32_16x16x32_bf16 v[152:155], v[56:59], v[100:103], v[152:155]
  v_mfma_f32_16x16x32_bf16 v[152:155], v[40:43], v[68:71], v[152:155]
  v_mfma_f32_16x16x32_bf16 v[156:159], v[44:47], v[68:71], v[156:159]
  v_mfma_f32_16x16x32_bf16 v[156:159], v[60:63], v[100:103], v[156:159]
  v_mfma_f32_16x16x32_bf16 v[140:143], v[60:63], v[96:99], v[140:143]
  v_mfma_f32_16x16x32_bf16 v[140:143], v[44:47], v[64:67], v[140:143]
  buffer_load_dwordx4 v[64:67], v11, s[48:51], s80 offen offset:0 sc1
  buffer_load_dwordx4 v[96:99], v11, s[48:51], s78 offen offset:0 sc1
  buffer_load_dwordx4 v[68:71], v11, s[48:51], s80 offen offset:1024 sc1
  buffer_load_dwordx4 v[100:103], v11, s[48:51], s78 offen offset:1024 sc1
  s_waitcnt vmcnt(16)
  v_mfma_f32_16x16x32_bf16 v[160:163], v[32:35], v[72:75], v[160:163]
  v_mfma_f32_16x16x32_bf16 v[160:163], v[48:51], v[104:107], v[160:163]
  v_mfma_f32_16x16x32_bf16 v[176:179], v[48:51], v[108:111], v[176:179]
  v_mfma_f32_16x16x32_bf16 v[176:179], v[32:35], v[76:79], v[176:179]
  v_mfma_f32_16x16x32_bf16 v[180:183], v[36:39], v[76:79], v[180:183]
  v_mfma_f32_16x16x32_bf16 v[180:183], v[52:55], v[108:111], v[180:183]
  v_mfma_f32_16x16x32_bf16 v[164:167], v[52:55], v[104:107], v[164:167]
  v_mfma_f32_16x16x32_bf16 v[164:167], v[36:39], v[72:75], v[164:167]
  s_add_u32 m0, s81, 0
  s_nop 0
  buffer_load_dwordx4 v3, s[36:39], s79 offen offset:0 lds
  buffer_load_dwordx4 v4, s[36:39], s79 offen offset:1024 lds
  buffer_load_dwordx4 v5, s[36:39], s79 offen offset:2048 lds
  buffer_load_dwordx4 v6, s[36:39], s79 offen offset:3072 lds
  s_add_u32 s79, s79, 65536
  v_mfma_f32_16x16x32_bf16 v[168:171], v[40:43], v[72:75], v[168:171]
  v_mfma_f32_16x16x32_bf16 v[168:171], v[56:59], v[104:107], v[168:171]
  v_mfma_f32_16x16x32_bf16 v[184:187], v[56:59], v[108:111], v[184:187]
  v_mfma_f32_16x16x32_bf16 v[184:187], v[40:43], v[76:79], v[184:187]
  v_mfma_f32_16x16x32_bf16 v[188:191], v[44:47], v[76:79], v[188:191]
  v_mfma_f32_16x16x32_bf16 v[188:191], v[60:63], v[108:111], v[188:191]
  v_mfma_f32_16x16x32_bf16 v[172:175], v[60:63], v[104:107], v[172:175]
  v_mfma_f32_16x16x32_bf16 v[172:175], v[44:47], v[72:75], v[172:175]
  buffer_load_dwordx4 v[72:75], v12, s[48:51], s80 offen offset:0 sc1
  buffer_load_dwordx4 v[104:107], v12, s[48:51], s78 offen offset:0 sc1
  buffer_load_dwordx4 v[76:79], v12, s[48:51], s80 offen offset:1024 sc1
  buffer_load_dwordx4 v[108:111], v12, s[48:51], s78 offen offset:1024 sc1
  s_waitcnt vmcnt(16)
  v_mfma_f32_16x16x32_bf16 v[192:195], v[32:35], v[80:83], v[192:195]
  v_mfma_f32_16x16x32_bf16 v[192:195], v[48:51], v[112:115], v[192:195]
  v_mfma_f32_16x16x32_bf16 v[208:211], v[48:51], v[116:119], v[208:211]
  v_mfma_f32_16x16x32_bf16 v[208:211], v[32:35], v[84:87], v[208:211]
  v_mfma_f32_16x16x32_bf16 v[212:215], v[36:39], v[84:87], v[212:215]
  v_mfma_f32_16x16x32_bf16 v[212:215], v[52:55], v[116:119], v[212:215]
  v_mfma_f32_16x16x32_bf16 v[196:199], v[52:55], v[112:115], v[196:199]
  v_mfma_f32_16x16x32_bf16 v[196:199], v[36:39], v[80:83], v[196:199]
  s_add_u32 m0, s81, 4096
  s_nop 0
  buffer_load_dwordx4 v3, s[36:39], s79 offen offset:0 lds
  buffer_load_dwordx4 v4, s[36:39], s79 offen offset:1024 lds
  buffer_load_dwordx4 v5, s[36:39], s79 offen offset:2048 lds
  buffer_load_dwordx4 v6, s[36:39], s79 offen offset:3072 lds
  s_add_u32 s79, s79, 65536
  v_mfma_f32_16x16x32_bf16 v[200:203], v[40:43], v[80:83], v[200:203]
  v_mfma_f32_16x16x32_bf16 v[200:203], v[56:59], v[112:115], v[200:203]
  v_mfma_f32_16x16x32_bf16 v[216:219], v[56:59], v[116:119], v[216:219]
  v_mfma_f32_16x16x32_bf16 v[216:219], v[40:43], v[84:87], v[216:219]
  v_mfma_f32_16x16x32_bf16 v[220:223], v[44:47], v[84:87], v[220:223]
  v_mfma_f32_16x16x32_bf16 v[220:223], v[60:63], v[116:119], v[220:223]
  v_mfma_f32_16x16x32_bf16 v[204:207], v[60:63], v[112:115], v[204:207]
  v_mfma_f32_16x16x32_bf16 v[204:207], v[44:47], v[80:83], v[204:207]
  buffer_load_dwordx4 v[80:83], v13, s[48:51], s80 offen offset:0 sc1
  buffer_load_dwordx4 v[112:115], v13, s[48:51], s78 offen offset:0 sc1
  buffer_load_dwordx4 v[84:87], v13, s[48:51], s80 offen offset:1024 sc1
  buffer_load_dwordx4 v[116:119], v13, s[48:51], s78 offen offset:1024 sc1
  s_waitcnt vmcnt(20)
  v_mfma_f32_16x16x32_bf16 v[224:227], v[32:35], v[88:91], v[224:227]
  v_mfma_f32_16x16x32_bf16 v[224:227], v[48:51], v[120:123], v[224:227]
  v_mfma_f32_16x16x32_bf16 v[240:243], v[48:51], v[124:127], v[240:243]
  v_mfma_f32_16x16x32_bf16 v[240:243], v[32:35], v[92:95], v[240:243]
  v_mfma_f32_16x16x32_bf16 v[244:247], v[36:39], v[92:95], v[244:247]
  v_mfma_f32_16x16x32_bf16 v[244:247], v[52:55], v[124:127], v[244:247]
  v_mfma_f32_16x16x32_bf16 v[228:231], v[52:55], v[120:123], v[228:231]
  v_mfma_f32_16x16x32_bf16 v[228:231], v[36:39], v[88:91], v[228:231]
  ds_read_b64_tr_b16 v[32:33], v7 offset:8192
  ds_read_b64_tr_b16 v[34:35], v7 offset:8704
  ds_read_b64_tr_b16 v[48:49], v7 offset:12288
  ds_read_b64_tr_b16 v[50:51], v7 offset:12800
  ds_read_b64_tr_b16 v[36:37], v8 offset:8192
  ds_read_b64_tr_b16 v[38:39], v8 offset:8704
  ds_read_b64_tr_b16 v[52:53], v8 offset:12288
  ds_read_b64_tr_b16 v[54:55], v8 offset:12800
  v_mfma_f32_16x16x32_bf16 v[232:235], v[40:43], v[88:91], v[232:235]
  v_mfma_f32_16x16x32_bf16 v[232:235], v[56:59], v[120:123], v[232:235]
  v_mfma_f32_16x16x32_bf16 v[248:251], v[56:59], v[124:127], v[248:251]
  v_mfma_f32_16x16x32_bf16 v[248:251], v[40:43], v[92:95], v[248:251]
  v_mfma_f32_16x16x32_bf16 v[252:255], v[44:47], v[92:95], v[252:255]
  v_mfma_f32_16x16x32_bf16 v[252:255], v[60:63], v[124:127], v[252:255]
  v_mfma_f32_16x16x32_bf16 v[236:239], v[60:63], v[120:123], v[236:239]
  v_mfma_f32_16x16x32_bf16 v[236:239], v[44:47], v[88:91], v[236:239]
  buffer_load_dwordx4 v[88:91], v14, s[48:51], s80 offen offset:0 sc1
  buffer_load_dwordx4 v[120:123], v14, s[48:51], s78 offen offset:0 sc1
  buffer_load_dwordx4 v[92:95], v14, s[48:51], s80 offen offset:1024 sc1
  buffer_load_dwordx4 v[124:127], v14, s[48:51], s78 offen offset:1024 sc1
  s_add_u32 s80, s80, 16384
  s_add_u32 s78, s78, 16384
  s_add_u32 s76, s76, 1
  s_branch L_g2loop
L_g2end:
  s_mov_b32 s36, s12
  s_mov_b32 s37, s13
  s_mov_b32 s38, 2097152
  s_lshl_b32 s79, s69, 17
  s_add_u32 s79, s79, 1048576
  s_bitcmp1_b32 s2, 0
  s_cbranch_scc1 L_hold_x
  s_mov_b32 s71, 262144
  v_mov_b32 v15, 155660
L_hold:
  ds_read_b32 v17, v15
  s_waitcnt lgkmcnt(0)
  v_readfirstlane_b32 s70, v17
  s_cmp_ge_u32 s70, 4
  s_cbranch_scc1 L_hold_x
  s_sleep 2
  s_sub_u32 s71, s71, 1
  s_cmp_lg_u32 s71, 0
  s_cbranch_scc1 L_hold
L_hold_x:
  s_lshl_b32 s70, s66, 4
  s_add_u32 s70, s70, s67
  s_lshl_b32 s70, s70, 2
  s_add_u32 s70, s70, s69
  s_lshl_b32 s70, s70, 7
  s_add_u32 s70, s70, 19169296
  v_and_b32 v15, 3, v0
  v_lshlrev_b32 v15, 2, v15
  s_mov_b32 s4, s70
  s_mul_i32 s5, s66, 1179648
  s_add_u32 s5, s5, s81
  s_lshl_b32 s6, s69, 12
  s_add_u32 s6, s6, 73728
  s_sub_u32 s6, s6, s81
  s_waitcnt vmcnt(20) lgkmcnt(4)
  v_mfma_f32_16x16x32_bf16 v[128:131], v[32:35], v[64:67], v[128:131]
  ds_read_b64_tr_b16 v[40:41], v9 offset:0
  v_mfma_f32_16x16x32_bf16 v[128:131], v[48:51], v[96:99], v[128:131]
  ds_read_b64_tr_b16 v[42:43], v9 offset:512
  v_mfma_f32_16x16x32_bf16 v[144:147], v[48:51], v[100:103], v[144:147]
  ds_read_b64_tr_b16 v[56:57], v9 offset:4096
  v_mfma_f32_16x16x32_bf16 v[144:147], v[32:35], v[68:71], v[144:147]
  ds_read_b64_tr_b16 v[58:59], v9 offset:4608
  s_waitcnt lgkmcnt(4)
  v_mfma_f32_16x16x32_bf16 v[148:151], v[36:39], v[68:71], v[148:151]
  ds_read_b64_tr_b16 v[44:45], v10 offset:0
  v_mfma_f32_16x16x32_bf16 v[148:151], v[52:55], v[100:103], v[148:151]
  ds_read_b64_tr_b16 v[46:47], v10 offset:512
  v_mfma_f32_16x16x32_bf16 v[132:135], v[52:55], v[96:99], v[132:135]
  ds_read_b64_tr_b16 v[60:61], v10 offset:4096
  v_mfma_f32_16x16x32_bf16 v[132:135], v[36:39], v[64:67], v[132:135]
  ds_read_b64_tr_b16 v[62:63], v10 offset:4608
  s_waitcnt lgkmcnt(4)
  v_mfma_f32_16x16x32_bf16 v[136:139], v[40:43], v[64:67], v[136:139]
  v_mfma_f32_16x16x32_bf16 v[136:139], v[56:59], v[96:99], v[136:139]
  v_mfma_f32_16x16x32_bf16 v[152:155], v[56:59], v[100:103], v[152:155]
  v_mfma_f32_16x16x32_bf16 v[152:155], v[40:43], v[68:71], v[152:155]
  s_waitcnt lgkmcnt(0)
  v_mfma_f32_16x16x32_bf16 v[156:159], v[44:47], v[68:71], v[156:159]
  buffer_load_dwordx4 v[68:71], v11, s[48:51], s80 offen offset:1024 sc1
  v_mfma_f32_16x16x32_bf16 v[156:159], v[60:63], v[100:103], v[156:159]
  buffer_load_dwordx4 v[100:103], v11, s[48:51], s78 offen offset:1024 sc1
  v_mfma_f32_16x16x32_bf16 v[140:143], v[60:63], v[96:99], v[140:143]
  buffer_load_dwordx4 v[96:99], v11, s[48:51], s78 offen offset:0 sc1
  v_mfma_f32_16x16x32_bf16 v[140:143], v[44:47], v[64:67], v[140:143]
  buffer_load_dwordx4 v[64:67], v11, s[48:51], s80 offen offset:0 sc1
  s_waitcnt vmcnt(16)
  v_mfma_f32_16x16x32_bf16 v[160:163], v[32:35], v[72:75], v[160:163]
  v_mfma_f32_16x16x32_bf16 v[160:163], v[48:51], v[104:107], v[160:163]
  s_add_u32 m0, s81, 0
  s_nop 0
  buffer_load_dwordx4 v3, s[36:39], s79 offen offset:0 lds
  v_mfma_f32_16x16x32_bf16 v[176:179], v[48:51], v[108:111], v[176:179]
  v_mfma_f32_16x16x32_bf16 v[176:179], v[32:35], v[76:79], v[176:179]
  buffer_load_dwordx4 v4, s[36:39], s79 offen offset:1024 lds
  v_mfma_f32_16x16x32_bf16 v[180:183], v[36:39], v[76:79], v[180:183]
  v_mfma_f32_16x16x32_bf16 v[180:183], v[52:55], v[108:111], v[180:183]
  buffer_load_dwordx4 v5, s[36:39], s79 offen offset:2048 lds
  v_mfma_f32_16x16x32_bf16 v[164:167], v[52:55], v[104:107], v[164:167]
  v_mfma_f32_16x16x32_bf16 v[164:167], v[36:39], v[72:75], v[164:167]
  buffer_load_dwordx4 v6, s[36:39], s79 offen offset:3072 lds
  s_add_u32 s79, s79, 65536
  v_mfma_f32_16x16x32_bf16 v[168:171], v[40:43], v[72:75], v[168:171]
  v_mfma_f32_16x16x32_bf16 v[168:171], v[56:59], v[104:107], v[168:171]
  v_mfma_f32_16x16x32_bf16 v[184:187], v[56:59], v[108:111], v[184:187]
  v_mfma_f32_16x16x32_bf16 v[184:187], v[40:43], v[76:79], v[184:187]
  v_mfma_f32_16x16x32_bf16 v[188:191], v[44:47], v[76:79], v[188:191]
  buffer_load_dwordx4 v[76:79], v12, s[48:51], s80 offen offset:1024 sc1
  v_mfma_f32_16x16x32_bf16 v[188:191], v[60:63], v[108:111], v[188:191]
  buffer_load_dwordx4 v[108:111], v12, s[48:51], s78 offen offset:1024 sc1
  v_mfma_f32_16x16x32_bf16 v[172:175], v[60:63], v[104:107], v[172:175]
  buffer_load_dwordx4 v[104:107], v12, s[48:51], s78 offen offset:0 sc1
  v_mfma_f32_16x16x32_bf16 v[172:175], v[44:47], v[72:75], v[172:175]
  buffer_load_dwordx4 v[72:75], v12, s[48:51], s80 offen offset:0 sc1
  buffer_load_dword v29, v15, s[48:51], s4 offen sc1
  s_waitcnt vmcnt(17)
  v_mfma_f32_16x16x32_bf16 v[192:195], v[32:35], v[80:83], v[192:195]
  v_mfma_f32_16x16x32_bf16 v[192:195], v[48:51], v[112:115], v[192:195]
  s_add_u32 m0, s81, 4096
  s_nop 0
  buffer_load_dwordx4 v3, s[36:39], s79 offen offset:0 lds
  v_mfma_f32_16x16x32_bf16 v[208:211], v[48:51], v[116:119], v[208:211]
  v_mfma_f32_16x16x32_bf16 v[208:211], v[32:35], v[84:87], v[208:211]
  buffer_load_dwordx4 v4, s[36:39], s79 offen offset:1024 lds
  v_mfma_f32_16x16x32_bf16 v[212:215], v[36:39], v[84:87], v[212:215]
  v_mfma_f32_16x16x32_bf16 v[212:215], v[52:55], v[116:119], v[212:215]
  buffer_load_dwordx4 v5, s[36:39], s79 offen offset:2048 lds
  v_mfma_f32_16x16x32_bf16 v[196:199], v[52:55], v[112:115], v[196:199]
  v_mfma_f32_16x16x32_bf16 v[196:199], v[36:39], v[80:83], v[196:199]
  buffer_load_dwordx4 v6, s[36:39], s79 offen offset:3072 lds
  s_add_u32 s79, s79, 65536
  v_mfma_f32_16x16x32_bf16 v[200:203], v[40:43], v[80:83], v[200:203]
  v_mfma_f32_16x16x32_bf16 v[200:203], v[56:59], v[112:115], v[200:203]
  v_mfma_f32_16x16x32_bf16 v[216:219], v[56:59], v[116:119], v[216:219]
  v_mfma_f32_16x16x32_bf16 v[216:219], v[40:43], v[84:87], v[216:219]
  v_mfma_f32_16x16x32_bf16 v[220:223], v[44:47], v[84:87], v[220:223]
  buffer_load_dwordx4 v[84:87], v13, s[48:51], s80 offen offset:1024 sc1
  v_mfma_f32_16x16x32_bf16 v[220:223], v[60:63], v[116:119], v[220:223]
  buffer_load_dwordx4 v[116:119], v13, s[48:51], s78 offen offset:1024 sc1
  v_mfma_f32_16x16x32_bf16 v[204:207], v[60:63], v[112:115], v[204:207]
  buffer_load_dwordx4 v[112:115], v13, s[48:51], s78 offen offset:0 sc1
  v_mfma_f32_16x16x32_bf16 v[204:207], v[44:47], v[80:83], v[204:207]
  buffer_load_dwordx4 v[80:83], v13, s[48:51], s80 offen offset:0 sc1
  s_waitcnt vmcnt(21)
  v_mfma_f32_16x16x32_bf16 v[224:227], v[32:35], v[88:91], v[224:227]
  v_mfma_f32_16x16x32_bf16 v[224:227], v[48:51], v[120:123], v[224:227]
  v_mfma_f32_16x16x32_bf16 v[240:243], v[48:51], v[124:127], v[240:243]
  v_mfma_f32_16x16x32_bf16 v[240:243], v[32:35], v[92:95], v[240:243]
  v_mfma_f32_16x16x32_bf16 v[244:247], v[36:39], v[92:95], v[244:247]
  ds_read_b64_tr_b16 v[32:33], v7 offset:8192
  v_mfma_f32_16x16x32_bf16 v[244:247], v[52:55], v[124:127], v[244:247]
  ds_read_b64_tr_b16 v[34:35], v7 offset:8704
  v_mfma_f32_16x16x32_bf16 v[228:231], v[52:55], v[120:123], v[228:231]
  ds_read_b64_tr_b16 v[48:49], v7 offset:12288
  v_mfma_f32_16x16x32_bf16 v[228:231], v[36:39], v[88:91], v[228:231]
  ds_read_b64_tr_b16 v[50:51], v7 offset:12800
  v_mfma_f32_16x16x32_bf16 v[232:235], v[40:43], v[88:91], v[232:235]
  ds_read_b64_tr_b16 v[36:37], v8 offset:8192
  v_mfma_f32_16x16x32_bf16 v[232:235], v[56:59], v[120:123], v[232:235]
  ds_read_b64_tr_b16 v[38:39], v8 offset:8704
  v_mfma_f32_16x16x32_bf16 v[248:251], v[56:59], v[124:127], v[248:251]
  ds_read_b64_tr_b16 v[52:53], v8 offset:12288
  v_mfma_f32_16x16x32_bf16 v[248:251], v[40:43], v[92:95], v[248:251]
  ds_read_b64_tr_b16 v[54:55], v8 offset:12800
  v_mfma_f32_16x16x32_bf16 v[252:255], v[44:47], v[92:95], v[252:255]
  ds_read_b64_tr_b16 v[40:41], v9 offset:8192
  buffer_load_dwordx4 v[92:95], v14, s[48:51], s80 offen offset:1024 sc1
  v_mfma_f32_16x16x32_bf16 v[252:255], v[60:63], v[124:127], v[252:255]
  ds_read_b64_tr_b16 v[42:43], v9 offset:8704
  buffer_load_dwordx4 v[124:127], v14, s[48:51], s78 offen offset:1024 sc1
  v_mfma_f32_16x16x32_bf16 v[236:239], v[60:63], v[120:123], v[236:239]
  ds_read_b64_tr_b16 v[56:57], v9 offset:12288
  buffer_load_dwordx4 v[120:123], v14, s[48:51], s78 offen offset:0 sc1
  v_mfma_f32_16x16x32_bf16 v[236:239], v[44:47], v[88:91], v[236:239]
  ds_read_b64_tr_b16 v[58:59], v9 offset:12800
  buffer_load_dwordx4 v[88:91], v14, s[48:51], s80 offen offset:0 sc1
  s_add_u32 s79, s79, 4293787648
  s_waitcnt vmcnt(21) lgkmcnt(8)
  v_mfma_f32_16x16x32_bf16 v[128:131], v[32:35], v[64:67], v[128:131]
  ds_read_b64_tr_b16 v[44:45], v10 offset:8192
  v_mfma_f32_16x16x32_bf16 v[128:131], v[48:51], v[96:99], v[128:131]
  ds_read_b64_tr_b16 v[46:47], v10 offset:8704
  v_mfma_f32_16x16x32_bf16 v[144:147], v[48:51], v[100:103], v[144:147]
  ds_read_b64_tr_b16 v[60:61], v10 offset:12288
  v_mfma_f32_16x16x32_bf16 v[144:147], v[32:35], v[68:71], v[144:147]
  ds_read_b64_tr_b16 v[62:63], v10 offset:12800
  s_waitcnt lgkmcnt(8)
  v_mfma_f32_16x16x32_bf16 v[148:151], v[36:39], v[68:71], v[148:151]
  v_mfma_f32_16x16x32_bf16 v[148:151], v[52:55], v[100:103], v[148:151]
  v_mfma_f32_16x16x32_bf16 v[132:135], v[52:55], v[96:99], v[132:135]
  v_mfma_f32_16x16x32_bf16 v[132:135], v[36:39], v[64:67], v[132:135]
  s_waitcnt vmcnt(12)
  s_waitcnt lgkmcnt(4)
  v_mfma_f32_16x16x32_bf16 v[136:139], v[40:43], v[64:67], v[136:139]
  v_cmp_eq_u32 vcc, 1, v29
  s_add_u32 s80, s5, 1048576
  v_mfma_f32_16x16x32_bf16 v[136:139], v[56:59], v[96:99], v[136:139]
  s_bitcmp1_b32 vcc_lo, 0
  s_cselect_b32 s82, 1, 0
  v_mfma_f32_16x16x32_bf16 v[152:155], v[56:59], v[100:103], v[152:155]
  s_cselect_b32 s80, s80, 1073741824
  s_add_u32 s78, s80, 8192
  v_mfma_f32_16x16x32_bf16 v[152:155], v[40:43], v[68:71], v[152:155]
  buffer_load_dword v29, v15, s[48:51], s4 offen sc1
  s_waitcnt lgkmcnt(0)
  v_mfma_f32_16x16x32_bf16 v[156:159], v[44:47], v[68:71], v[156:159]
  buffer_load_dwordx4 v[68:71], v11, s[48:51], s80 offen offset:1024 sc1
  v_mfma_f32_16x16x32_bf16 v[156:159], v[60:63], v[100:103], v[156:159]
  buffer_load_dwordx4 v[100:103], v11, s[48:51], s78 offen offset:1024 sc1
  v_mfma_f32_16x16x32_bf16 v[140:143], v[60:63], v[96:99], v[140:143]
  buffer_load_dwordx4 v[96:99], v11, s[48:51], s78 offen offset:0 sc1
  v_mfma_f32_16x16x32_bf16 v[140:143], v[44:47], v[64:67], v[140:143]
  buffer_load_dwordx4 v[64:67], v11, s[48:51], s80 offen offset:0 sc1
  v_mfma_f32_16x16x32_bf16 v[160:163], v[32:35], v[72:75], v[160:163]
  v_mfma_f32_16x16x32_bf16 v[160:163], v[48:51], v[104:107], v[160:163]
  s_add_u32 m0, s81, 8192
  s_nop 0
  buffer_load_dwordx4 v3, s[36:39], s79 offen offset:0 lds
  v_mfma_f32_16x16x32_bf16 v[176:179], v[48:51], v[108:111], v[176:179]
  v_mfma_f32_16x16x32_bf16 v[176:179], v[32:35], v[76:79], v[176:179]
  buffer_load_dwordx4 v4, s[36:39], s79 offen offset:1024 lds
  v_mfma_f32_16x16x32_bf16 v[180:183], v[36:39], v[76:79], v[180:183]
  v_mfma_f32_16x16x32_bf16 v[180:183], v[52:55], v[108:111], v[180:183]
  buffer_load_dwordx4 v5, s[36:39], s79 offen offset:2048 lds
  v_mfma_f32_16x16x32_bf16 v[164:167], v[52:55], v[104:107], v[164:167]
  v_mfma_f32_16x16x32_bf16 v[164:167], v[36:39], v[72:75], v[164:167]
  buffer_load_dwordx4 v6, s[36:39], s79 offen offset:3072 lds
  s_add_u32 s79, s79, 65536
  v_mfma_f32_16x16x32_bf16 v[168:171], v[40:43], v[72:75], v[168:171]
  v_mfma_f32_16x16x32_bf16 v[168:171], v[56:59], v[104:107], v[168:171]
  v_mfma_f32_16x16x32_bf16 v[184:187], v[56:59], v[108:111], v[184:187]
  v_mfma_f32_16x16x32_bf16 v[184:187], v[40:43], v[76:79], v[184:187]
  v_mfma_f32_16x16x32_bf16 v[188:191], v[44:47], v[76:79], v[188:191]
  buffer_load_dwordx4 v[76:79], v12, s[48:51], s80 offen offset:1024 sc1
  v_mfma_f32_16x16x32_bf16 v[188:191], v[60:63], v[108:111], v[188:191]
  buffer_load_dwordx4 v[108:111], v12, s[48:51], s78 offen offset:1024 sc1
  v_mfma_f32_16x16x32_bf16 v[172:175], v[60:63], v[104:107], v[172:175]
  buffer_load_dwordx4 v[104:107], v12, s[48:51], s78 offen offset:0 sc1
  v_mfma_f32_16x16x32_bf16 v[172:175], v[44:47], v[72:75], v[172:175]
  buffer_load_dwordx4 v[72:75], v12, s[48:51], s80 offen offset:0 sc1
  s_cmp_eq_u32 s82, 0
  s_cbranch_scc1 L_sec0
L_sec0_r:
  buffer_load_dword v29, v15, s[48:51], s4 offen sc1
  s_waitcnt vmcnt(18)
  v_mfma_f32_16x16x32_bf16 v[192:195], v[32:35], v[80:83], v[192:195]
  v_mfma_f32_16x16x32_bf16 v[192:195], v[48:51], v[112:115], v[192:195]
  s_add_u32 m0, s81, 12288
  s_nop 0
  buffer_load_dwordx4 v3, s[36:39], s79 offen offset:0 lds
  v_mfma_f32_16x16x32_bf16 v[208:211], v[48:51], v[116:119], v[208:211]
  v_mfma_f32_16x16x32_bf16 v[208:211], v[32:35], v[84:87], v[208:211]
  buffer_load_dwordx4 v4, s[36:39], s79 offen offset:1024 lds
  v_mfma_f32_16x16x32_bf16 v[212:215], v[36:39], v[84:87], v[212:215]
  v_mfma_f32_16x16x32_bf16 v[212:215], v[52:55], v[116:119], v[212:215]
  buffer_load_dwordx4 v5, s[36:39], s79 offen offset:2048 lds
  v_mfma_f32_16x16x32_bf16 v[196:199], v[52:55], v[112:115], v[196:199]
  v_mfma_f32_16x16x32_bf16 v[196:199], v[36:39], v[80:83], v[196:199]
  buffer_load_dwordx4 v6, s[36:39], s79 offen offset:3072 lds
  s_add_u32 s79, s79, 65536
  v_mfma_f32_16x16x32_bf16 v[200:203], v[40:43], v[80:83], v[200:203]
  v_mfma_f32_16x16x32_bf16 v[200:203], v[56:59], v[112:115], v[200:203]
  v_mfma_f32_16x16x32_bf16 v[216:219], v[56:59], v[116:119], v[216:219]
  v_mfma_f32_16x16x32_bf16 v[216:219], v[40:43], v[84:87], v[216:219]
  v_mfma_f32_16x16x32_bf16 v[220:223], v[44:47], v[84:87], v[220:223]
  buffer_load_dwordx4 v[84:87], v13, s[48:51], s80 offen offset:1024 sc1
  v_mfma_f32_16x16x32_bf16 v[220:223], v[60:63], v[116:119], v[220:223]
  buffer_load_dwordx4 v[116:119], v13, s[48:51], s78 offen offset:1024 sc1
  v_mfma_f32_16x16x32_bf16 v[204:207], v[60:63], v[112:115], v[204:207]
  buffer_load_dwordx4 v[112:115], v13, s[48:51], s78 offen offset:0 sc1
  v_mfma_f32_16x16x32_bf16 v[204:207], v[44:47], v[80:83], v[204:207]
  buffer_load_dwordx4 v[80:83], v13, s[48:51], s80 offen offset:0 sc1
  s_waitcnt vmcnt(22)
  v_mfma_f32_16x16x32_bf16 v[224:227], v[32:35], v[88:91], v[224:227]
  v_mfma_f32_16x16x32_bf16 v[224:227], v[48:51], v[120:123], v[224:227]
  v_mfma_f32_16x16x32_bf16 v[240:243], v[48:51], v[124:127], v[240:243]
  v_mfma_f32_16x16x32_bf16 v[240:243], v[32:35], v[92:95], v[240:243]
  v_mfma_f32_16x16x32_bf16 v[244:247], v[36:39], v[92:95], v[244:247]
  ds_read_b64_tr_b16 v[32:33], v7 offset:0
  v_mfma_f32_16x16x32_bf16 v[244:247], v[52:55], v[124:127], v[244:247]
  ds_read_b64_tr_b16 v[34:35], v7 offset:512
  v_mfma_f32_16x16x32_bf16 v[228:231], v[52:55], v[120:123], v[228:231]
  ds_read_b64_tr_b16 v[48:49], v7 offset:4096
  v_mfma_f32_16x16x32_bf16 v[228:231], v[36:39], v[88:91], v[228:231]
  ds_read_b64_tr_b16 v[50:51], v7 offset:4608
  v_mfma_f32_16x16x32_bf16 v[232:235], v[40:43], v[88:91], v[232:235]
  ds_read_b64_tr_b16 v[36:37], v8 offset:0
  v_mfma_f32_16x16x32_bf16 v[232:235], v[56:59], v[120:123], v[232:235]
  ds_read_b64_tr_b16 v[38:39], v8 offset:512
  v_mfma_f32_16x16x32_bf16 v[248:251], v[56:59], v[124:127], v[248:251]
  ds_read_b64_tr_b16 v[52:53], v8 offset:4096
  v_mfma_f32_16x16x32_bf16 v[248:251], v[40:43], v[92:95], v[248:251]
  ds_read_b64_tr_b16 v[54:55], v8 offset:4608
  v_mfma_f32_16x16x32_bf16 v[252:255], v[44:47], v[92:95], v[252:255]
  ds_read_b64_tr_b16 v[40:41], v9 offset:0
  buffer_load_dwordx4 v[92:95], v14, s[48:51], s80 offen offset:1024 sc1
  v_mfma_f32_16x16x32_bf16 v[252:255], v[60:63], v[124:127], v[252:255]
  ds_read_b64_tr_b16 v[42:43], v9 offset:512
  buffer_load_dwordx4 v[124:127], v14, s[48:51], s78 offen offset:1024 sc1
  v_mfma_f32_16x16x32_bf16 v[236:239], v[60:63], v[120:123], v[236:239]
  ds_read_b64_tr_b16 v[56:57], v9 offset:4096
  buffer_load_dwordx4 v[120:123], v14, s[48:51], s78 offen offset:0 sc1
  v_mfma_f32_16x16x32_bf16 v[236:239], v[44:47], v[88:91], v[236:239]
  ds_read_b64_tr_b16 v[58:59], v9 offset:4608
  buffer_load_dwordx4 v[88:91], v14, s[48:51], s80 offen offset:0 sc1
  s_mov_b32 s32, s22
  s_mov_b32 s33, s23
  s_mov_b32 s34, 2048
  s_mov_b32 s35, 0x20000
  s_mov_b32 s40, s26
  s_mov_b32 s41, s27
  s_mov_b32 s42, 4194304
  s_mov_b32 s43, 0x20000
  ds_read_b64_tr_b16 v[44:45], v10 offset:0
  ds_read_b64_tr_b16 v[46:47], v10 offset:512
  ds_read_b64_tr_b16 v[60:61], v10 offset:4096
  ds_read_b64_tr_b16 v[62:63], v10 offset:4608
  s_cmp_eq_u32 s82, 0
  s_cbranch_scc1 L_blk0
L_join0:
  v_pk_mul_f32 v[128:129], v[128:129], v[16:17] op_sel_hi:[1,0]
  v_pk_mul_f32 v[130:131], v[130:131], v[16:17] op_sel_hi:[1,0]
  v_pk_mul_f32 v[144:145], v[144:145], v[18:19] op_sel_hi:[1,0]
  v_pk_mul_f32 v[146:147], v[146:147], v[18:19] op_sel_hi:[1,0]
  v_pk_mul_f32 v[132:133], v[132:133], v[16:17] op_sel_hi:[1,0]
  v_pk_mul_f32 v[134:135], v[134:135], v[16:17] op_sel_hi:[1,0]
  v_pk_mul_f32 v[148:149], v[148:149], v[18:19] op_sel_hi:[1,0]
  v_pk_mul_f32 v[150:151], v[150:151], v[18:19] op_sel_hi:[1,0]
  v_pk_mul_f32 v[136:137], v[136:137], v[16:17] op_sel_hi:[1,0]
  v_pk_mul_f32 v[138:139], v[138:139], v[16:17] op_sel_hi:[1,0]
  v_pk_mul_f32 v[152:153], v[152:153], v[18:19] op_sel_hi:[1,0]
  v_pk_mul_f32 v[154:155], v[154:155], v[18:19] op_sel_hi:[1,0]
  v_pk_mul_f32 v[140:141], v[140:141], v[16:17] op_sel_hi:[1,0]
  v_pk_mul_f32 v[142:143], v[142:143], v[16:17] op_sel_hi:[1,0]
  v_pk_mul_f32 v[156:157], v[156:157], v[18:19] op_sel_hi:[1,0]
  v_pk_mul_f32 v[158:159], v[158:159], v[18:19] op_sel_hi:[1,0]
  s_nop 0
  s_waitcnt vmcnt(12) lgkmcnt(12)
  v_mfma_f32_16x16x32_bf16 v[128:131], v[32:35], v[64:67], v[128:131]
  v_mul_f32 v160, v20, v160
  v_mul_f32 v161, v20, v161
  v_mfma_f32_16x16x32_bf16 v[128:131], v[48:51], v[96:99], v[128:131]
  v_mul_f32 v162, v20, v162
  v_mul_f32 v163, v20, v163
  v_mfma_f32_16x16x32_bf16 v[144:147], v[48:51], v[100:103], v[144:147]
  v_mul_f32 v176, v22, v176
  v_mul_f32 v177, v22, v177
  v_mfma_f32_16x16x32_bf16 v[144:147], v[32:35], v[68:71], v[144:147]
  v_mul_f32 v178, v22, v178
  v_mul_f32 v179, v22, v179
  s_waitcnt lgkmcnt(8)
  v_mfma_f32_16x16x32_bf16 v[148:151], v[36:39], v[68:71], v[148:151]
  v_mul_f32 v164, v20, v164
  v_mul_f32 v165, v20, v165
  v_mfma_f32_16x16x32_bf16 v[148:151], v[52:55], v[100:103], v[148:151]
  v_mul_f32 v166, v20, v166
  v_mul_f32 v167, v20, v167
  v_mfma_f32_16x16x32_bf16 v[132:135], v[52:55], v[96:99], v[132:135]
  v_mul_f32 v180, v22, v180
  v_mul_f32 v181, v22, v181
  v_mfma_f32_16x16x32_bf16 v[132:135], v[36:39], v[64:67], v[132:135]
  v_mul_f32 v182, v22, v182
  v_mul_f32 v183, v22, v183
  s_waitcnt lgkmcnt(4)
  v_mfma_f32_16x16x32_bf16 v[136:139], v[40:43], v[64:67], v[136:139]
  v_mul_f32 v168, v20, v168
  v_mul_f32 v169, v20, v169
  v_mfma_f32_16x16x32_bf16 v[136:139], v[56:59], v[96:99], v[136:139]
  v_mul_f32 v170, v20, v170
  v_mul_f32 v171, v20, v171
  v_mfma_f32_16x16x32_bf16 v[152:155], v[56:59], v[100:103], v[152:155]
  v_mul_f32 v184, v22, v184
  v_mul_f32 v185, v22, v185
  s_waitcnt vmcnt(12)
  v_cmp_eq_u32 vcc, 1, v29
  s_add_u32 s80, s5, 917504
  s_bitcmp1_b32 vcc_lo, 1
  s_cselect_b32 s82, 1, 0
  s_cselect_b32 s80, s80, 1073741824
  s_add_u32 s78, s80, 8192
  buffer_load_dword v29, v15, s[48:51], s4 offen sc1
  v_mfma_f32_16x16x32_bf16 v[152:155], v[40:43], v[68:71], v[152:155]
  v_mul_f32 v186, v22, v186
  v_mul_f32 v187, v22, v187
  s_waitcnt lgkmcnt(0)
  v_mfma_f32_16x16x32_bf16 v[156:159], v[44:47], v[68:71], v[156:159]
  buffer_load_dwordx4 v[68:71], v11, s[48:51], s80 offen offset:1024 sc1
  v_mul_f32 v172, v20, v172
  v_mul_f32 v173, v20, v173
  v_mfma_f32_16x16x32_bf16 v[156:159], v[60:63], v[100:103], v[156:159]
  buffer_load_dwordx4 v[100:103], v11, s[48:51], s78 offen offset:1024 sc1
  v_mul_f32 v174, v20, v174
  v_mul_f32 v175, v20, v175
  v_mfma_f32_16x16x32_bf16 v[140:143], v[60:63], v[96:99], v[140:143]
  buffer_load_dwordx4 v[96:99], v11, s[48:51], s78 offen offset:0 sc1
  v_mul_f32 v188, v22, v188
  v_mul_f32 v189, v22, v189
  v_mfma_f32_16x16x32_bf16 v[140:143], v[44:47], v[64:67], v[140:143]
  buffer_load_dwordx4 v[64:67], v11, s[48:51], s80 offen offset:0 sc1
  v_mul_f32 v190, v22, v190
  v_mul_f32 v191, v22, v191
  s_waitcnt vmcnt(13)
  v_mfma_f32_16x16x32_bf16 v[160:163], v[32:35], v[72:75], v[160:163]
  v_mul_f32 v192, v24, v192
  v_mul_f32 v193, v24, v193
  v_mfma_f32_16x16x32_bf16 v[160:163], v[48:51], v[104:107], v[160:163]
  v_mul_f32 v194, v24, v194
  v_mul_f32 v195, v24, v195
  v_mfma_f32_16x16x32_bf16 v[176:179], v[48:51], v[108:111], v[176:179]
  v_mul_f32 v208, v26, v208
  v_mul_f32 v209, v26, v209
  v_mfma_f32_16x16x32_bf16 v[176:179], v[32:35], v[76:79], v[176:179]
  v_mul_f32 v210, v26, v210
  v_mul_f32 v211, v26, v211
  v_mfma_f32_16x16x32_bf16 v[180:183], v[36:39], v[76:79], v[180:183]
  v_mul_f32 v196, v24, v196
  v_mul_f32 v197, v24, v197
  v_mfma_f32_16x16x32_bf16 v[180:183], v[52:55], v[108:111], v[180:183]
  v_mul_f32 v198, v24, v198
  v_mul_f32 v199, v24, v199
  v_mfma_f32_16x16x32_bf16 v[164:167], v[52:55], v[104:107], v[164:167]
  v_mul_f32 v212, v26, v212
  v_mul_f32 v213, v26, v213
  v_mfma_f32_16x16x32_bf16 v[164:167], v[36:39], v[72:75], v[164:167]
  v_mul_f32 v214, v26, v214
  v_mul_f32 v215, v26, v215
  v_mfma_f32_16x16x32_bf16 v[168:171], v[40:43], v[72:75], v[168:171]
  v_mul_f32 v200, v24, v200
  v_mul_f32 v201, v24, v201
  v_mfma_f32_16x16x32_bf16 v[168:171], v[56:59], v[104:107], v[168:171]
  v_mul_f32 v202, v24, v202
  v_mul_f32 v203, v24, v203
  v_mfma_f32_16x16x32_bf16 v[184:187], v[56:59], v[108:111], v[184:187]
  v_mul_f32 v216, v26, v216
  v_mul_f32 v217, v26, v217
  v_mfma_f32_16x16x32_bf16 v[184:187], v[40:43], v[76:79], v[184:187]
  v_mul_f32 v218, v26, v218
  v_mul_f32 v219, v26, v219
  v_mfma_f32_16x16x32_bf16 v[188:191], v[44:47], v[76:79], v[188:191]
  buffer_load_dwordx4 v[76:79], v12, s[48:51], s80 offen offset:1024 sc1
  v_mul_f32 v204, v24, v204
  v_mul_f32 v205, v24, v205
  v_mfma_f32_16x16x32_bf16 v[188:191], v[60:63], v[108:111], v[188:191]
  buffer_load_dwordx4 v[108:111], v12, s[48:51], s78 offen offset:1024 sc1
  v_mul_f32 v206, v24, v206
  v_mul_f32 v207, v24, v207
  v_mfma_f32_16x16x32_bf16 v[172:175], v[60:63], v[104:107], v[172:175]
  buffer_load_dwordx4 v[104:107], v12, s[48:51], s78 offen offset:0 sc1
  v_mul_f32 v220, v26, v220
  v_mul_f32 v221, v26, v221
  v_mfma_f32_16x16x32_bf16 v[172:175], v[44:47], v[72:75], v[172:175]
  buffer_load_dwordx4 v[72:75], v12, s[48:51], s80 offen offset:0 sc1
  v_mul_f32 v222, v26, v222
  v_mul_f32 v223, v26, v223
  s_cmp_eq_u32 s82, 0
  s_cbranch_scc1 L_sec1
L_sec1_r:
  buffer_load_dword v29, v15, s[48:51], s4 offen sc1
  s_waitcnt vmcnt(14)
  v_mfma_f32_16x16x32_bf16 v[192:195], v[32:35], v[80:83], v[192:195]
  v_mul_f32 v224, v28, v224
  v_mul_f32 v225, v28, v225
  v_mfma_f32_16x16x32_bf16 v[192:195], v[48:51], v[112:115], v[192:195]
  v_mul_f32 v226, v28, v226
  v_mul_f32 v227, v28, v227
  v_mfma_f32_16x16x32_bf16 v[208:211], v[48:51], v[116:119], v[208:211]
  v_mul_f32 v240, v30, v240
  v_mul_f32 v241, v30, v241
  v_mfma_f32_16x16x32_bf16 v[208:211], v[32:35], v[84:87], v[208:211]
  v_mul_f32 v242, v30, v242
  v_mul_f32 v243, v30, v243
  v_mfma_f32_16x16x32_bf16 v[212:215], v[36:39], v[84:87], v[212:215]
  v_mul_f32 v228, v28, v228
  v_mul_f32 v229, v28, v229
  v_mfma_f32_16x16x32_bf16 v[212:215], v[52:55], v[116:119], v[212:215]
  v_mul_f32 v230, v28, v230
  v_mul_f32 v231, v28, v231
  v_mfma_f32_16x16x32_bf16 v[196:199], v[52:55], v[112:115], v[196:199]
  v_mul_f32 v244, v30, v244
  v_mul_f32 v245, v30, v245
  v_mfma_f32_16x16x32_bf16 v[196:199], v[36:39], v[80:83], v[196:199]
  v_mul_f32 v246, v30, v246
  v_mul_f32 v247, v30, v247
  v_mfma_f32_16x16x32_bf16 v[200:203], v[40:43], v[80:83], v[200:203]
  v_mul_f32 v232, v28, v232
  v_mul_f32 v233, v28, v233
  v_mfma_f32_16x16x32_bf16 v[200:203], v[56:59], v[112:115], v[200:203]
  v_mul_f32 v234, v28, v234
  v_mul_f32 v235, v28, v235
  v_mfma_f32_16x16x32_bf16 v[216:219], v[56:59], v[116:119], v[216:219]
  v_mul_f32 v248, v30, v248
  v_mul_f32 v249, v30, v249
  v_mfma_f32_16x16x32_bf16 v[216:219], v[40:43], v[84:87], v[216:219]
  v_mul_f32 v250, v30, v250
  v_mul_f32 v251, v30, v251
  v_mfma_f32_16x16x32_bf16 v[220:223], v[44:47], v[84:87], v[220:223]
  buffer_load_dwordx4 v[84:87], v13, s[48:51], s80 offen offset:1024 sc1
  v_mul_f32 v236, v28, v236
  v_mul_f32 v237, v28, v237
  v_mfma_f32_16x16x32_bf16 v[220:223], v[60:63], v[116:119], v[220:223]
  buffer_load_dwordx4 v[116:119], v13, s[48:51], s78 offen offset:1024 sc1
  v_mul_f32 v238, v28, v238
  v_mul_f32 v239, v28, v239
  v_mfma_f32_16x16x32_bf16 v[204:207], v[60:63], v[112:115], v[204:207]
  buffer_load_dwordx4 v[112:115], v13, s[48:51], s78 offen offset:0 sc1
  v_mul_f32 v252, v30, v252
  v_mul_f32 v253, v30, v253
  v_mfma_f32_16x16x32_bf16 v[204:207], v[44:47], v[80:83], v[204:207]
  buffer_load_dwordx4 v[80:83], v13, s[48:51], s80 offen offset:0 sc1
  v_mul_f32 v254, v30, v254
  v_mul_f32 v255, v30, v255
  s_waitcnt vmcnt(14)
  v_mfma_f32_16x16x32_bf16 v[224:227], v[32:35], v[88:91], v[224:227]
  v_mfma_f32_16x16x32_bf16 v[224:227], v[48:51], v[120:123], v[224:227]
  v_mfma_f32_16x16x32_bf16 v[240:243], v[48:51], v[124:127], v[240:243]
  v_mfma_f32_16x16x32_bf16 v[240:243], v[32:35], v[92:95], v[240:243]
  v_mfma_f32_16x16x32_bf16 v[244:247], v[36:39], v[92:95], v[244:247]
  ds_read_b64_tr_b16 v[32:33], v7 offset:8192
  v_mfma_f32_16x16x32_bf16 v[244:247], v[52:55], v[124:127], v[244:247]
  ds_read_b64_tr_b16 v[34:35], v7 offset:8704
  v_mfma_f32_16x16x32_bf16 v[228:231], v[52:55], v[120:123], v[228:231]
  ds_read_b64_tr_b16 v[48:49], v7 offset:12288
  v_mfma_f32_16x16x32_bf16 v[228:231], v[36:39], v[88:91], v[228:231]
  ds_read_b64_tr_b16 v[50:51], v7 offset:12800
  v_mfma_f32_16x16x32_bf16 v[232:235], v[40:43], v[88:91], v[232:235]
  ds_read_b64_tr_b16 v[36:37], v8 offset:8192
  v_mfma_f32_16x16x32_bf16 v[232:235], v[56:59], v[120:123], v[232:235]
  ds_read_b64_tr_b16 v[38:39], v8 offset:8704
  v_mfma_f32_16x16x32_bf16 v[248:251], v[56:59], v[124:127], v[248:251]
  ds_read_b64_tr_b16 v[52:53], v8 offset:12288
  v_mfma_f32_16x16x32_bf16 v[248:251], v[40:43], v[92:95], v[248:251]
  ds_read_b64_tr_b16 v[54:55], v8 offset:12800
  v_mfma_f32_16x16x32_bf16 v[252:255], v[44:47], v[92:95], v[252:255]
  ds_read_b64_tr_b16 v[40:41], v9 offset:8192
  buffer_load_dwordx4 v[92:95], v14, s[48:51], s80 offen offset:1024 sc1
  v_mfma_f32_16x16x32_bf16 v[252:255], v[60:63], v[124:127], v[252:255]
  ds_read_b64_tr_b16 v[42:43], v9 offset:8704
  buffer_load_dwordx4 v[124:127], v14, s[48:51], s78 offen offset:1024 sc1
  v_mfma_f32_16x16x32_bf16 v[236:239], v[60:63], v[120:123], v[236:239]
  ds_read_b64_tr_b16 v[56:57], v9 offset:12288
  buffer_load_dwordx4 v[120:123], v14, s[48:51], s78 offen offset:0 sc1
  v_mfma_f32_16x16x32_bf16 v[236:239], v[44:47], v[88:91], v[236:239]
  ds_read_b64_tr_b16 v[58:59], v9 offset:12800
  buffer_load_dwordx4 v[88:91], v14, s[48:51], s80 offen offset:0 sc1
  s_cmp_eq_u32 s82, 0
  s_cbranch_scc1 L_blk1
L_join1:
  s_waitcnt vmcnt(12) lgkmcnt(8)
  v_mfma_f32_16x16x32_bf16 v[128:131], v[32:35], v[64:67], v[128:131]
  ds_read_b64_tr_b16 v[44:45], v10 offset:8192
  v_mfma_f32_16x16x32_bf16 v[128:131], v[48:51], v[96:99], v[128:131]
  ds_read_b64_tr_b16 v[46:47], v10 offset:8704
  v_mfma_f32_16x16x32_bf16 v[144:147], v[48:51], v[100:103], v[144:147]
  ds_read_b64_tr_b16 v[60:61], v10 offset:12288
  v_mfma_f32_16x16x32_bf16 v[144:147], v[32:35], v[68:71], v[144:147]
  ds_read_b64_tr_b16 v[62:63], v10 offset:12800
  s_waitcnt lgkmcnt(8)
  v_mfma_f32_16x16x32_bf16 v[148:151], v[36:39], v[68:71], v[148:151]
  v_mfma_f32_16x16x32_bf16 v[148:151], v[52:55], v[100:103], v[148:151]
  v_mfma_f32_16x16x32_bf16 v[132:135], v[52:55], v[96:99], v[132:135]
  v_mfma_f32_16x16x32_bf16 v[132:135], v[36:39], v[64:67], v[132:135]
  s_waitcnt vmcnt(8)
  s_waitcnt lgkmcnt(4)
  v_mfma_f32_16x16x32_bf16 v[136:139], v[40:43], v[64:67], v[136:139]
  v_cmp_eq_u32 vcc, 1, v29
  s_add_u32 s80, s5, 983040
  v_mfma_f32_16x16x32_bf16 v[136:139], v[56:59], v[96:99], v[136:139]
  s_bitcmp1_b32 vcc_lo, 2
  s_cselect_b32 s82, 1, 0
  v_mfma_f32_16x16x32_bf16 v[152:155], v[56:59], v[100:103], v[152:155]
  s_cselect_b32 s80, s80, 1073741824
  s_add_u32 s78, s80, 8192
  v_mfma_f32_16x16x32_bf16 v[152:155], v[40:43], v[68:71], v[152:155]
  buffer_load_dword v29, v15, s[48:51], s4 offen sc1
  s_waitcnt lgkmcnt(0)
  v_mfma_f32_16x16x32_bf16 v[156:159], v[44:47], v[68:71], v[156:159]
  buffer_load_dwordx4 v[68:71], v11, s[48:51], s80 offen offset:1024 sc1
  v_mfma_f32_16x16x32_bf16 v[156:159], v[60:63], v[100:103], v[156:159]
  buffer_load_dwordx4 v[100:103], v11, s[48:51], s78 offen offset:1024 sc1
  v_mfma_f32_16x16x32_bf16 v[140:143], v[60:63], v[96:99], v[140:143]
  buffer_load_dwordx4 v[96:99], v11, s[48:51], s78 offen offset:0 sc1
  v_mfma_f32_16x16x32_bf16 v[140:143], v[44:47], v[64:67], v[140:143]
  buffer_load_dwordx4 v[64:67], v11, s[48:51], s80 offen offset:0 sc1
  s_waitcnt vmcnt(13)
  v_mfma_f32_16x16x32_bf16 v[160:163], v[32:35], v[72:75], v[160:163]
  s_lshl_b32 s70, s67, 7
  v_mfma_f32_16x16x32_bf16 v[160:163], v[48:51], v[104:107], v[160:163]
  v_lshlrev_b32 v16, 3, v2
  v_mfma_f32_16x16x32_bf16 v[176:179], v[48:51], v[108:111], v[176:179]
  v_lshl_add_u32 v3, v0, 4, s81
  v_mfma_f32_16x16x32_bf16 v[176:179], v[32:35], v[76:79], v[176:179]
  v_add_u32 v4, s6, v3
  v_mfma_f32_16x16x32_bf16 v[180:183], v[36:39], v[76:79], v[180:183]
  v_add_u32 v7, s6, v7
  v_mfma_f32_16x16x32_bf16 v[180:183], v[52:55], v[108:111], v[180:183]
  v_add_u32 v8, s6, v8
  v_mfma_f32_16x16x32_bf16 v[164:167], v[52:55], v[104:107], v[164:167]
  v_add_u32 v9, s6, v9
  v_mfma_f32_16x16x32_bf16 v[164:167], v[36:39], v[72:75], v[164:167]
  v_add_u32 v10, s6, v10
  v_mfma_f32_16x16x32_bf16 v[168:171], v[40:43], v[72:75], v[168:171]
  buffer_load_dwordx2 v[18:19], v16, s[32:35], s70 offen offset:0
  v_mfma_f32_16x16x32_bf16 v[168:171], v[56:59], v[104:107], v[168:171]
  buffer_load_dwordx2 v[20:21], v16, s[32:35], s70 offen offset:32
  v_mfma_f32_16x16x32_bf16 v[184:187], v[56:59], v[108:111], v[184:187]
  buffer_load_dwordx2 v[22:23], v16, s[32:35], s70 offen offset:64
  v_mfma_f32_16x16x32_bf16 v[184:187], v[40:43], v[76:79], v[184:187]
  buffer_load_dwordx2 v[24:25], v16, s[32:35], s70 offen offset:96
  v_mfma_f32_16x16x32_bf16 v[188:191], v[44:47], v[76:79], v[188:191]
  buffer_load_dwordx4 v[76:79], v12, s[48:51], s80 offen offset:1024 sc1
  v_mfma_f32_16x16x32_bf16 v[188:191], v[60:63], v[108:111], v[188:191]
  buffer_load_dwordx4 v[108:111], v12, s[48:51], s78 offen offset:1024 sc1
  v_mfma_f32_16x16x32_bf16 v[172:175], v[60:63], v[104:107], v[172:175]
  buffer_load_dwordx4 v[104:107], v12, s[48:51], s78 offen offset:0 sc1
  v_mfma_f32_16x16x32_bf16 v[172:175], v[44:47], v[72:75], v[172:175]
  buffer_load_dwordx4 v[72:75], v12, s[48:51], s80 offen offset:0 sc1
  s_cmp_eq_u32 s82, 0
  s_cbranch_scc1 L_sec2
L_sec2_r:
  buffer_load_dword v29, v15, s[48:51], s4 offen sc1
  s_waitcnt vmcnt(18)
  v_mfma_f32_16x16x32_bf16 v[192:195], v[32:35], v[80:83], v[192:195]
  v_mov_b32 v17, 155660
  v_mfma_f32_16x16x32_bf16 v[192:195], v[48:51], v[112:115], v[192:195]
  v_mfma_f32_16x16x32_bf16 v[208:211], v[48:51], v[116:119], v[208:211]
  ds_read_b32 v31, v17
  v_mfma_f32_16x16x32_bf16 v[208:211], v[32:35], v[84:87], v[208:211]
  v_mfma_f32_16x16x32_bf16 v[212:215], v[36:39], v[84:87], v[212:215]
  v_mfma_f32_16x16x32_bf16 v[212:215], v[52:55], v[116:119], v[212:215]
  v_mfma_f32_16x16x32_bf16 v[196:199], v[52:55], v[112:115], v[196:199]
  v_mfma_f32_16x16x32_bf16 v[196:199], v[36:39], v[80:83], v[196:199]
  v_mfma_f32_16x16x32_bf16 v[200:203], v[40:43], v[80:83], v[200:203]
  v_mfma_f32_16x16x32_bf16 v[200:203], v[56:59], v[112:115], v[200:203]
  v_mfma_f32_16x16x32_bf16 v[216:219], v[56:59], v[116:119], v[216:219]
  s_waitcnt lgkmcnt(0)
  v_cmp_gt_u32 vcc, 4, v31
  v_mfma_f32_16x16x32_bf16 v[216:219], v[40:43], v[84:87], v[216:219]
  s_cbranch_vccnz L_wa0
L_wa_r:
  v_mfma_f32_16x16x32_bf16 v[220:223], v[44:47], v[84:87], v[220:223]
  buffer_load_dwordx4 v[84:87], v13, s[48:51], s80 offen offset:1024 sc1
  v_mfma_f32_16x16x32_bf16 v[220:223], v[60:63], v[116:119], v[220:223]
  buffer_load_dwordx4 v[116:119], v13, s[48:51], s78 offen offset:1024 sc1
  v_mfma_f32_16x16x32_bf16 v[204:207], v[60:63], v[112:115], v[204:207]
  buffer_load_dwordx4 v[112:115], v13, s[48:51], s78 offen offset:0 sc1
  v_mfma_f32_16x16x32_bf16 v[204:207], v[44:47], v[80:83], v[204:207]
  buffer_load_dwordx4 v[80:83], v13, s[48:51], s80 offen offset:0 sc1
  s_waitcnt vmcnt(18)
  v_mfma_f32_16x16x32_bf16 v[224:227], v[32:35], v[88:91], v[224:227]
  v_mfma_f32_16x16x32_bf16 v[224:227], v[48:51], v[120:123], v[224:227]
  v_mfma_f32_16x16x32_bf16 v[240:243], v[48:51], v[124:127], v[240:243]
  v_mfma_f32_16x16x32_bf16 v[240:243], v[32:35], v[92:95], v[240:243]
  v_mfma_f32_16x16x32_bf16 v[244:247], v[36:39], v[92:95], v[244:247]
  ds_read_b64_tr_b16 v[32:33], v7 offset:0
  v_mfma_f32_16x16x32_bf16 v[244:247], v[52:55], v[124:127], v[244:247]
  ds_read_b64_tr_b16 v[34:35], v7 offset:512
  v_mfma_f32_16x16x32_bf16 v[228:231], v[52:55], v[120:123], v[228:231]
  ds_read_b64_tr_b16 v[48:49], v7 offset:49152
  v_mfma_f32_16x16x32_bf16 v[228:231], v[36:39], v[88:91], v[228:231]
  ds_read_b64_tr_b16 v[50:51], v7 offset:49664
  v_mfma_f32_16x16x32_bf16 v[232:235], v[40:43], v[88:91], v[232:235]
  ds_read_b64_tr_b16 v[36:37], v8 offset:0
  v_mfma_f32_16x16x32_bf16 v[232:235], v[56:59], v[120:123], v[232:235]
  ds_read_b64_tr_b16 v[38:39], v8 offset:512
  v_mfma_f32_16x16x32_bf16 v[248:251], v[56:59], v[124:127], v[248:251]
  ds_read_b64_tr_b16 v[52:53], v8 offset:49152
  v_mfma_f32_16x16x32_bf16 v[248:251], v[40:43], v[92:95], v[248:251]
  ds_read_b64_tr_b16 v[54:55], v8 offset:49664
  v_mfma_f32_16x16x32_bf16 v[252:255], v[44:47], v[92:95], v[252:255]
  ds_read_b64_tr_b16 v[40:41], v9 offset:0
  buffer_load_dwordx4 v[92:95], v14, s[48:51], s80 offen offset:1024 sc1
  v_mfma_f32_16x16x32_bf16 v[252:255], v[60:63], v[124:127], v[252:255]
  ds_read_b64_tr_b16 v[42:43], v9 offset:512
  buffer_load_dwordx4 v[124:127], v14, s[48:51], s78 offen offset:1024 sc1
  v_mfma_f32_16x16x32_bf16 v[236:239], v[60:63], v[120:123], v[236:239]
  ds_read_b64_tr_b16 v[56:57], v9 offset:49152
  buffer_load_dwordx4 v[120:123], v14, s[48:51], s78 offen offset:0 sc1
  v_mfma_f32_16x16x32_bf16 v[236:239], v[44:47], v[88:91], v[236:239]
  ds_read_b64_tr_b16 v[58:59], v9 offset:49664
  buffer_load_dwordx4 v[88:91], v14, s[48:51], s80 offen offset:0 sc1
  s_cmp_eq_u32 s82, 0
  s_cbranch_scc1 L_blk2
L_join2:
  s_waitcnt vmcnt(12) lgkmcnt(8)
  v_mfma_f32_16x16x32_bf16 v[128:131], v[32:35], v[64:67], v[128:131]
  ds_read_b64_tr_b16 v[44:45], v10 offset:0
  v_mfma_f32_16x16x32_bf16 v[128:131], v[48:51], v[96:99], v[128:131]
  ds_read_b64_tr_b16 v[46:47], v10 offset:512
  v_mfma_f32_16x16x32_bf16 v[144:147], v[48:51], v[100:103], v[144:147]
  ds_read_b64_tr_b16 v[60:61], v10 offset:49152
  v_mfma_f32_16x16x32_bf16 v[144:147], v[32:35], v[68:71], v[144:147]
  ds_read_b64_tr_b16 v[62:63], v10 offset:49664
  s_waitcnt lgkmcnt(8)
  v_mfma_f32_16x16x32_bf16 v[148:151], v[36:39], v[68:71], v[148:151]
  v_add_u32 v7, 16384, v7
  v_add_u32 v8, 16384, v8
  v_mfma_f32_16x16x32_bf16 v[148:151], v[52:55], v[100:103], v[148:151]
  v_add_u32 v9, 16384, v9
  v_add_u32 v10, 16384, v10
  v_mfma_f32_16x16x32_bf16 v[132:135], v[52:55], v[96:99], v[132:135]
  v_mfma_f32_16x16x32_bf16 v[132:135], v[36:39], v[64:67], v[132:135]
  s_waitcnt vmcnt(8)
  s_waitcnt lgkmcnt(4)
  v_mfma_f32_16x16x32_bf16 v[136:139], v[40:43], v[64:67], v[136:139]
  v_cmp_eq_u32 vcc, 1, v29
  s_add_u32 s80, s5, 1114112
  v_mfma_f32_16x16x32_bf16 v[136:139], v[56:59], v[96:99], v[136:139]
  s_bitcmp1_b32 vcc_lo, 3
  s_cselect_b32 s82, 1, 0
  v_mfma_f32_16x16x32_bf16 v[152:155], v[56:59], v[100:103], v[152:155]
  s_cselect_b32 s80, s80, 1073741824
  s_add_u32 s78, s80, 8192
  v_mfma_f32_16x16x32_bf16 v[152:155], v[40:43], v[68:71], v[152:155]
  buffer_load_dword v29, v15, s[48:51], s4 offen sc1
  s_waitcnt lgkmcnt(0)
  v_mfma_f32_16x16x32_bf16 v[156:159], v[44:47], v[68:71], v[156:159]
  buffer_load_dwordx4 v[68:71], v11, s[48:51], s80 offen offset:1024 sc1
  v_mfma_f32_16x16x32_bf16 v[156:159], v[60:63], v[100:103], v[156:159]
  buffer_load_dwordx4 v[100:103], v11, s[48:51], s78 offen offset:1024 sc1
  v_mfma_f32_16x16x32_bf16 v[140:143], v[60:63], v[96:99], v[140:143]
  buffer_load_dwordx4 v[96:99], v11, s[48:51], s78 offen offset:0 sc1
  v_mfma_f32_16x16x32_bf16 v[140:143], v[44:47], v[64:67], v[140:143]
  buffer_load_dwordx4 v[64:67], v11, s[48:51], s80 offen offset:0 sc1
  s_waitcnt vmcnt(13)
  v_mfma_f32_16x16x32_bf16 v[160:163], v[32:35], v[72:75], v[160:163]
  s_sub_u32 s71, s69, 1
  s_and_b32 s71, s71, 3
  v_mfma_f32_16x16x32_bf16 v[160:163], v[48:51], v[104:107], v[160:163]
  s_lshl_b32 s71, s71, 14
  v_lshl_add_u32 v5, v0, 4, s71
  v_mfma_f32_16x16x32_bf16 v[176:179], v[48:51], v[108:111], v[176:179]
  s_sub_u32 s71, s69, 2
  s_and_b32 s71, s71, 3
  v_mfma_f32_16x16x32_bf16 v[176:179], v[32:35], v[76:79], v[176:179]
  s_lshl_b32 s71, s71, 14
  v_lshl_add_u32 v6, v0, 4, s71
  v_mfma_f32_16x16x32_bf16 v[180:183], v[36:39], v[76:79], v[180:183]
  s_sub_u32 s71, s69, 3
  s_and_b32 s71, s71, 3
  v_mfma_f32_16x16x32_bf16 v[180:183], v[52:55], v[108:111], v[180:183]
  s_lshl_b32 s71, s71, 12
  s_add_u32 s71, s71, 73728
  v_mfma_f32_16x16x32_bf16 v[164:167], v[52:55], v[104:107], v[164:167]
  v_lshl_add_u32 v16, v0, 4, s71
  v_mfma_f32_16x16x32_bf16 v[164:167], v[36:39], v[72:75], v[164:167]
  v_mfma_f32_16x16x32_bf16 v[168:171], v[40:43], v[72:75], v[168:171]
  v_lshlrev_b32 v26, 16, v18
  v_and_b32 v27, 0xffff0000, v18
  v_mfma_f32_16x16x32_bf16 v[168:171], v[56:59], v[104:107], v[168:171]
  v_fmac_f32 v224, v26, v28
  v_fmac_f32 v225, v27, v28
  v_mfma_f32_16x16x32_bf16 v[184:187], v[56:59], v[108:111], v[184:187]
  v_fmac_f32 v240, v26, v30
  v_fmac_f32 v241, v27, v30
  v_mfma_f32_16x16x32_bf16 v[184:187], v[40:43], v[76:79], v[184:187]
  v_lshlrev_b32 v26, 16, v19
  v_and_b32 v27, 0xffff0000, v19
  v_mfma_f32_16x16x32_bf16 v[188:191], v[44:47], v[76:79], v[188:191]
  buffer_load_dwordx4 v[76:79], v12, s[48:51], s80 offen offset:1024 sc1
  v_fmac_f32 v226, v26, v28
  v_fmac_f32 v227, v27, v28
  v_mfma_f32_16x16x32_bf16 v[188:191], v[60:63], v[108:111], v[188:191]
  buffer_load_dwordx4 v[108:111], v12, s[48:51], s78 offen offset:1024 sc1
  v_fmac_f32 v242, v26, v30
  v_fmac_f32 v243, v27, v30
  v_mfma_f32_16x16x32_bf16 v[172:175], v[60:63], v[104:107], v[172:175]
  buffer_load_dwordx4 v[104:107], v12, s[48:51], s78 offen offset:0 sc1
  v_lshlrev_b32 v26, 16, v20
  v_and_b32 v27, 0xffff0000, v20
  v_mfma_f32_16x16x32_bf16 v[172:175], v[44:47], v[72:75], v[172:175]
  buffer_load_dwordx4 v[72:75], v12, s[48:51], s80 offen offset:0 sc1
  v_fmac_f32 v228, v26, v28
  v_fmac_f32 v229, v27, v28
  s_cmp_eq_u32 s82, 0
  s_cbranch_scc1 L_sec3
L_sec3_r:
  buffer_load_dword v29, v15, s[48:51], s4 offen sc1
  s_waitcnt vmcnt(14)
  v_mfma_f32_16x16x32_bf16 v[192:195], v[32:35], v[80:83], v[192:195]
  v_fmac_f32 v244, v26, v30
  v_fmac_f32 v245, v27, v30
  v_mfma_f32_16x16x32_bf16 v[192:195], v[48:51], v[112:115], v[192:195]
  v_lshlrev_b32 v26, 16, v21
  v_and_b32 v27, 0xffff0000, v21
  v_mfma_f32_16x16x32_bf16 v[208:211], v[48:51], v[116:119], v[208:211]
  v_fmac_f32 v230, v26, v28
  v_fmac_f32 v231, v27, v28
  v_mfma_f32_16x16x32_bf16 v[208:211], v[32:35], v[84:87], v[208:211]
  v_fmac_f32 v246, v26, v30
  v_fmac_f32 v247, v27, v30
  v_mfma_f32_16x16x32_bf16 v[212:215], v[36:39], v[84:87], v[212:215]
  v_lshlrev_b32 v26, 16, v22
  v_and_b32 v27, 0xffff0000, v22
  v_mfma_f32_16x16x32_bf16 v[212:215], v[52:55], v[116:119], v[212:215]
  v_fmac_f32 v232, v26, v28
  v_fmac_f32 v233, v27, v28
  v_mfma_f32_16x16x32_bf16 v[196:199], v[52:55], v[112:115], v[196:199]
  v_fmac_f32 v248, v26, v30
  v_fmac_f32 v249, v27, v30
  v_mfma_f32_16x16x32_bf16 v[196:199], v[36:39], v[80:83], v[196:199]
  v_lshlrev_b32 v26, 16, v23
  v_and_b32 v27, 0xffff0000, v23
  v_mfma_f32_16x16x32_bf16 v[200:203], v[40:43], v[80:83], v[200:203]
  v_fmac_f32 v234, v26, v28
  v_fmac_f32 v235, v27, v28
  v_mfma_f32_16x16x32_bf16 v[200:203], v[56:59], v[112:115], v[200:203]
  v_fmac_f32 v250, v26, v30
  v_fmac_f32 v251, v27, v30
  v_mfma_f32_16x16x32_bf16 v[216:219], v[56:59], v[116:119], v[216:219]
  v_lshlrev_b32 v26, 16, v24
  v_and_b32 v27, 0xffff0000, v24
  v_mfma_f32_16x16x32_bf16 v[216:219], v[40:43], v[84:87], v[216:219]
  v_fmac_f32 v236, v26, v28
  v_fmac_f32 v237, v27, v28
  v_mfma_f32_16x16x32_bf16 v[220:223], v[44:47], v[84:87], v[220:223]
  buffer_load_dwordx4 v[84:87], v13, s[48:51], s80 offen offset:1024 sc1
  v_fmac_f32 v252, v26, v30
  v_fmac_f32 v253, v27, v30
  v_mfma_f32_16x16x32_bf16 v[220:223], v[60:63], v[116:119], v[220:223]
  buffer_load_dwordx4 v[116:119], v13, s[48:51], s78 offen offset:1024 sc1
  v_lshlrev_b32 v26, 16, v25
  v_and_b32 v27, 0xffff0000, v25
  v_mfma_f32_16x16x32_bf16 v[204:207], v[60:63], v[112:115], v[204:207]
  buffer_load_dwordx4 v[112:115], v13, s[48:51], s78 offen offset:0 sc1
  v_fmac_f32 v238, v26, v28
  v_fmac_f32 v239, v27, v28
  v_mfma_f32_16x16x32_bf16 v[204:207], v[44:47], v[80:83], v[204:207]
  buffer_load_dwordx4 v[80:83], v13, s[48:51], s80 offen offset:0 sc1
  v_fmac_f32 v254, v26, v30
  v_fmac_f32 v255, v27, v30
  s_waitcnt vmcnt(14)
  v_mfma_f32_16x16x32_bf16 v[224:227], v[32:35], v[88:91], v[224:227]
  v_mfma_f32_16x16x32_bf16 v[224:227], v[48:51], v[120:123], v[224:227]
  v_mfma_f32_16x16x32_bf16 v[240:243], v[48:51], v[124:127], v[240:243]
  v_mfma_f32_16x16x32_bf16 v[240:243], v[32:35], v[92:95], v[240:243]
  v_mfma_f32_16x16x32_bf16 v[244:247], v[36:39], v[92:95], v[244:247]
  ds_read_b64_tr_b16 v[32:33], v7 offset:49152
  v_mfma_f32_16x16x32_bf16 v[244:247], v[52:55], v[124:127], v[244:247]
  ds_read_b64_tr_b16 v[34:35], v7 offset:49664
  v_mfma_f32_16x16x32_bf16 v[228:231], v[52:55], v[120:123], v[228:231]
  ds_read_b64_tr_b16 v[48:49], v7 offset:0
  v_mfma_f32_16x16x32_bf16 v[228:231], v[36:39], v[88:91], v[228:231]
  ds_read_b64_tr_b16 v[50:51], v7 offset:512
  v_mfma_f32_16x16x32_bf16 v[232:235], v[40:43], v[88:91], v[232:235]
  ds_read_b64_tr_b16 v[36:37], v8 offset:49152
  v_mfma_f32_16x16x32_bf16 v[232:235], v[56:59], v[120:123], v[232:235]
  ds_read_b64_tr_b16 v[38:39], v8 offset:49664
  v_mfma_f32_16x16x32_bf16 v[248:251], v[56:59], v[124:127], v[248:251]
  ds_read_b64_tr_b16 v[52:53], v8 offset:0
  v_mfma_f32_16x16x32_bf16 v[248:251], v[40:43], v[92:95], v[248:251]
  ds_read_b64_tr_b16 v[54:55], v8 offset:512
  v_mfma_f32_16x16x32_bf16 v[252:255], v[44:47], v[92:95], v[252:255]
  ds_read_b64_tr_b16 v[40:41], v9 offset:49152
  buffer_load_dwordx4 v[92:95], v14, s[48:51], s80 offen offset:1024 sc1
  v_mfma_f32_16x16x32_bf16 v[252:255], v[60:63], v[124:127], v[252:255]
  ds_read_b64_tr_b16 v[42:43], v9 offset:49664
  buffer_load_dwordx4 v[124:127], v14, s[48:51], s78 offen offset:1024 sc1
  v_mfma_f32_16x16x32_bf16 v[236:239], v[60:63], v[120:123], v[236:239]
  ds_read_b64_tr_b16 v[56:57], v9 offset:0
  buffer_load_dwordx4 v[120:123], v14, s[48:51], s78 offen offset:0 sc1
  v_mfma_f32_16x16x32_bf16 v[236:239], v[44:47], v[88:91], v[236:239]
  ds_read_b64_tr_b16 v[58:59], v9 offset:512
  buffer_load_dwordx4 v[88:91], v14, s[48:51], s80 offen offset:0 sc1
  s_cmp_eq_u32 s82, 0
  s_cbranch_scc1 L_blk3
L_join3:
  s_waitcnt vmcnt(12) lgkmcnt(8)
  v_mfma_f32_16x16x32_bf16 v[128:131], v[32:35], v[64:67], v[128:131]
  ds_read_b64_tr_b16 v[44:45], v10 offset:49152
  s_lshl_b32 s72, s69, 12
  s_add_u32 s72, s72, 106496
  v_mfma_f32_16x16x32_bf16 v[128:131], v[48:51], v[96:99], v[128:131]
  ds_read_b64_tr_b16 v[46:47], v10 offset:49664
  v_lshrrev_b32 v15, 3, v0
  v_and_b32 v17, 7, v0
  v_mfma_f32_16x16x32_bf16 v[144:147], v[48:51], v[100:103], v[144:147]
  ds_read_b64_tr_b16 v[60:61], v10 offset:0
  v_xor_b32 v26, v15, v17
  v_lshlrev_b32 v26, 4, v26
  v_mfma_f32_16x16x32_bf16 v[144:147], v[32:35], v[68:71], v[144:147]
  ds_read_b64_tr_b16 v[62:63], v10 offset:512
  v_lshl_add_u32 v26, v15, 7, v26
  v_add_u32 v26, s72, v26
  s_waitcnt lgkmcnt(8)
  v_mfma_f32_16x16x32_bf16 v[148:151], v[36:39], v[68:71], v[148:151]
  v_lshlrev_b32 v27, 4, v17
  v_lshl_add_u32 v27, v15, 11, v27
  v_mfma_f32_16x16x32_bf16 v[148:151], v[52:55], v[100:103], v[148:151]
  v_and_b32 v15, 7, v1
  v_lshrrev_b32 v17, 1, v2
  v_mfma_f32_16x16x32_bf16 v[132:135], v[52:55], v[96:99], v[132:135]
  v_xor_b32 v15, v15, v17
  v_lshlrev_b32 v15, 4, v15
  v_mfma_f32_16x16x32_bf16 v[132:135], v[36:39], v[64:67], v[132:135]
  v_and_b32 v17, 1, v2
  v_lshl_add_u32 v15, v17, 3, v15
  s_waitcnt lgkmcnt(4)
  v_mfma_f32_16x16x32_bf16 v[136:139], v[40:43], v[64:67], v[136:139]
  v_lshl_add_u32 v15, v1, 7, v15
  v_add_u32 v11, s72, v15
  v_mfma_f32_16x16x32_bf16 v[136:139], v[56:59], v[96:99], v[136:139]
  v_xor_b32 v12, 32, v11
  v_xor_b32 v13, 64, v11
  v_mfma_f32_16x16x32_bf16 v[152:155], v[56:59], v[100:103], v[152:155]
  v_xor_b32 v14, 96, v11
  s_lshl_b32 s70, s67, 7
  v_mfma_f32_16x16x32_bf16 v[152:155], v[40:43], v[68:71], v[152:155]
  s_lshl_b32 s71, s66, 18
  s_add_u32 s70, s70, s71
  s_waitcnt lgkmcnt(0)
  v_mfma_f32_16x16x32_bf16 v[156:159], v[44:47], v[68:71], v[156:159]
  s_lshl_b32 s71, s69, 16
  s_add_u32 s70, s70, s71
  v_mfma_f32_16x16x32_bf16 v[156:159], v[60:63], v[100:103], v[156:159]
  v_mfma_f32_16x16x32_bf16 v[140:143], v[60:63], v[96:99], v[140:143]
  v_mfma_f32_16x16x32_bf16 v[140:143], v[44:47], v[64:67], v[140:143]
  s_waitcnt vmcnt(8)
  v_mfma_f32_16x16x32_bf16 v[160:163], v[32:35], v[72:75], v[160:163]
  v_mfma_f32_16x16x32_bf16 v[160:163], v[48:51], v[104:107], v[160:163]
  ds_write_b128 v3, v[128:131] offset:0
  v_mfma_f32_16x16x32_bf16 v[176:179], v[48:51], v[108:111], v[176:179]
  v_mfma_f32_16x16x32_bf16 v[176:179], v[32:35], v[76:79], v[176:179]
  ds_write_b128 v3, v[144:147] offset:4096
  v_mfma_f32_16x16x32_bf16 v[180:183], v[36:39], v[76:79], v[180:183]
  v_mfma_f32_16x16x32_bf16 v[180:183], v[52:55], v[108:111], v[180:183]
  ds_write_b128 v3, v[132:135] offset:1024
  v_mfma_f32_16x16x32_bf16 v[164:167], v[52:55], v[104:107], v[164:167]
  v_mfma_f32_16x16x32_bf16 v[164:167], v[36:39], v[72:75], v[164:167]
  ds_write_b128 v3, v[148:151] offset:5120
  v_mfma_f32_16x16x32_bf16 v[168:171], v[40:43], v[72:75], v[168:171]
  v_mfma_f32_16x16x32_bf16 v[168:171], v[56:59], v[104:107], v[168:171]
  ds_write_b128 v3, v[136:139] offset:2048
  v_mfma_f32_16x16x32_bf16 v[184:187], v[56:59], v[108:111], v[184:187]
  v_mfma_f32_16x16x32_bf16 v[184:187], v[40:43], v[76:79], v[184:187]
  ds_write_b128 v3, v[152:155] offset:6144
  v_mfma_f32_16x16x32_bf16 v[188:191], v[44:47], v[76:79], v[188:191]
  v_mfma_f32_16x16x32_bf16 v[188:191], v[60:63], v[108:111], v[188:191]
  ds_write_b128 v3, v[140:143] offset:3072
  v_mfma_f32_16x16x32_bf16 v[172:175], v[60:63], v[104:107], v[172:175]
  v_mfma_f32_16x16x32_bf16 v[172:175], v[44:47], v[72:75], v[172:175]
  ds_write_b128 v3, v[156:159] offset:7168
  s_waitcnt vmcnt(4)
  v_mfma_f32_16x16x32_bf16 v[192:195], v[32:35], v[80:83], v[192:195]
  v_mfma_f32_16x16x32_bf16 v[192:195], v[48:51], v[112:115], v[192:195]
  ds_write_b128 v3, v[160:163] offset:8192
  v_mfma_f32_16x16x32_bf16 v[208:211], v[48:51], v[116:119], v[208:211]
  v_mfma_f32_16x16x32_bf16 v[208:211], v[32:35], v[84:87], v[208:211]
  ds_write_b128 v3, v[176:179] offset:12288
  v_mfma_f32_16x16x32_bf16 v[212:215], v[36:39], v[84:87], v[212:215]
  v_mfma_f32_16x16x32_bf16 v[212:215], v[52:55], v[116:119], v[212:215]
  ds_write_b128 v3, v[164:167] offset:9216
  v_mfma_f32_16x16x32_bf16 v[196:199], v[52:55], v[112:115], v[196:199]
  v_mfma_f32_16x16x32_bf16 v[196:199], v[36:39], v[80:83], v[196:199]
  ds_write_b128 v3, v[180:183] offset:13312
  v_mfma_f32_16x16x32_bf16 v[200:203], v[40:43], v[80:83], v[200:203]
  v_mfma_f32_16x16x32_bf16 v[200:203], v[56:59], v[112:115], v[200:203]
  ds_write_b128 v3, v[168:171] offset:10240
  v_mfma_f32_16x16x32_bf16 v[216:219], v[56:59], v[116:119], v[216:219]
  v_mfma_f32_16x16x32_bf16 v[216:219], v[40:43], v[84:87], v[216:219]
  ds_write_b128 v3, v[184:187] offset:14336
  v_mfma_f32_16x16x32_bf16 v[220:223], v[44:47], v[84:87], v[220:223]
  v_mfma_f32_16x16x32_bf16 v[220:223], v[60:63], v[116:119], v[220:223]
  ds_write_b128 v3, v[172:175] offset:11264
  v_mfma_f32_16x16x32_bf16 v[204:207], v[60:63], v[112:115], v[204:207]
  v_mfma_f32_16x16x32_bf16 v[204:207], v[44:47], v[80:83], v[204:207]
  ds_write_b128 v3, v[188:191] offset:15360
  s_waitcnt vmcnt(0)
  v_mfma_f32_16x16x32_bf16 v[224:227], v[32:35], v[88:91], v[224:227]
  v_mfma_f32_16x16x32_bf16 v[224:227], v[48:51], v[120:123], v[224:227]
  ds_write_b128 v4, v[192:195] offset:0
  v_mfma_f32_16x16x32_bf16 v[240:243], v[48:51], v[124:127], v[240:243]
  v_mfma_f32_16x16x32_bf16 v[240:243], v[32:35], v[92:95], v[240:243]
  ds_write_b128 v4, v[208:211] offset:16384
  v_mfma_f32_16x16x32_bf16 v[244:247], v[36:39], v[92:95], v[244:247]
  v_mfma_f32_16x16x32_bf16 v[244:247], v[52:55], v[124:127], v[244:247]
  ds_write_b128 v4, v[196:199] offset:1024
  v_mfma_f32_16x16x32_bf16 v[228:231], v[52:55], v[120:123], v[228:231]
  v_mfma_f32_16x16x32_bf16 v[228:231], v[36:39], v[88:91], v[228:231]
  ds_write_b128 v4, v[212:215] offset:17408
  v_mfma_f32_16x16x32_bf16 v[232:235], v[40:43], v[88:91], v[232:235]
  v_mfma_f32_16x16x32_bf16 v[232:235], v[56:59], v[120:123], v[232:235]
  ds_write_b128 v4, v[200:203] offset:2048
  v_mfma_f32_16x16x32_bf16 v[248:251], v[56:59], v[124:127], v[248:251]
  v_mfma_f32_16x16x32_bf16 v[248:251], v[40:43], v[92:95], v[248:251]
  ds_write_b128 v4, v[216:219] offset:18432
  v_mfma_f32_16x16x32_bf16 v[252:255], v[44:47], v[92:95], v[252:255]
  v_mfma_f32_16x16x32_bf16 v[252:255], v[60:63], v[124:127], v[252:255]
  ds_write_b128 v4, v[204:207] offset:3072
  v_mfma_f32_16x16x32_bf16 v[236:239], v[60:63], v[120:123], v[236:239]
  v_mfma_f32_16x16x32_bf16 v[236:239], v[44:47], v[88:91], v[236:239]
  ds_write_b128 v4, v[220:223] offset:19456
  s_waitcnt lgkmcnt(0)
  s_barrier
  ds_read_b128 v[128:131], v5 offset:0
  ds_read_b128 v[160:163], v6 offset:8192
  ds_read_b128 v[192:195], v16 offset:0
  ds_read_b128 v[132:135], v5 offset:1024
  ds_read_b128 v[164:167], v6 offset:9216
  ds_read_b128 v[196:199], v16 offset:1024
  ds_read_b128 v[136:139], v5 offset:2048
  ds_read_b128 v[168:171], v6 offset:10240
  ds_read_b128 v[200:203], v16 offset:2048
  ds_read_b128 v[140:143], v5 offset:3072
  ds_read_b128 v[172:175], v6 offset:11264
  ds_read_b128 v[204:207], v16 offset:3072
  s_waitcnt lgkmcnt(9)
  ds_read_b128 v[144:147], v5 offset:4096
  ds_read_b128 v[176:179], v6 offset:12288
  ds_read_b128 v[208:211], v16 offset:16384
  v_pk_add_f32 v[128:129], v[128:129], v[160:161]
  v_pk_add_f32 v[130:131], v[130:131], v[162:163]
  v_pk_add_f32 v[224:225], v[224:225], v[192:193]
  v_pk_add_f32 v[226:227], v[226:227], v[194:195]
  v_pk_add_f32 v[224:225], v[224:225], v[128:129]
  v_pk_add_f32 v[226:227], v[226:227], v[130:131]
  v_cvt_pk_bf16_f32 v64, v224, v225
  v_cvt_pk_bf16_f32 v65, v226, v227
  ds_write_b64 v11, v[64:65] offset:0
  s_waitcnt lgkmcnt(10)
  ds_read_b128 v[148:151], v5 offset:5120
  ds_read_b128 v[180:183], v6 offset:13312
  ds_read_b128 v[212:215], v16 offset:17408
  v_pk_add_f32 v[132:133], v[132:133], v[164:165]
  v_pk_add_f32 v[134:135], v[134:135], v[166:167]
  v_pk_add_f32 v[228:229], v[228:229], v[196:197]
  v_pk_add_f32 v[230:231], v[230:231], v[198:199]
  v_pk_add_f32 v[228:229], v[228:229], v[132:133]
  v_pk_add_f32 v[230:231], v[230:231], v[134:135]
  v_cvt_pk_bf16_f32 v66, v228, v229
  v_cvt_pk_bf16_f32 v67, v230, v231
  ds_write_b64 v12, v[66:67] offset:0
  s_waitcnt lgkmcnt(11)
  ds_read_b128 v[152:155], v5 offset:6144
  ds_read_b128 v[184:187], v6 offset:14336
  ds_read_b128 v[216:219], v16 offset:18432
  v_pk_add_f32 v[136:137], v[136:137], v[168:169]
  v_pk_add_f32 v[138:139], v[138:139], v[170:171]
  v_pk_add_f32 v[232:233], v[232:233], v[200:201]
  v_pk_add_f32 v[234:235], v[234:235], v[202:203]
  v_pk_add_f32 v[232:233], v[232:233], v[136:137]
  v_pk_add_f32 v[234:235], v[234:235], v[138:139]
  v_cvt_pk_bf16_f32 v68, v232, v233
  v_cvt_pk_bf16_f32 v69, v234, v235
  ds_write_b64 v13, v[68:69] offset:0
  s_waitcnt lgkmcnt(12)
  ds_read_b128 v[156:159], v5 offset:7168
  ds_read_b128 v[188:191], v6 offset:15360
  ds_read_b128 v[220:223], v16 offset:19456
  v_pk_add_f32 v[140:141], v[140:141], v[172:173]
  v_pk_add_f32 v[142:143], v[142:143], v[174:175]
  v_pk_add_f32 v[236:237], v[236:237], v[204:205]
  v_pk_add_f32 v[238:239], v[238:239], v[206:207]
  v_pk_add_f32 v[236:237], v[236:237], v[140:141]
  v_pk_add_f32 v[238:239], v[238:239], v[142:143]
  v_cvt_pk_bf16_f32 v70, v236, v237
  v_cvt_pk_bf16_f32 v71, v238, v239
  ds_write_b64 v14, v[70:71] offset:0
  ds_read_b128 v[96:99], v26 offset:0
  ds_read_b128 v[100:103], v26 offset:1024
  s_waitcnt lgkmcnt(14)
  v_pk_add_f32 v[144:145], v[144:145], v[176:177]
  v_pk_add_f32 v[146:147], v[146:147], v[178:179]
  v_pk_add_f32 v[240:241], v[240:241], v[208:209]
  v_pk_add_f32 v[242:243], v[242:243], v[210:211]
  v_pk_add_f32 v[240:241], v[240:241], v[144:145]
  v_pk_add_f32 v[242:243], v[242:243], v[146:147]
  v_cvt_pk_bf16_f32 v72, v240, v241
  v_cvt_pk_bf16_f32 v73, v242, v243
  ds_write_b64 v11, v[72:73] offset:2048
  s_waitcnt lgkmcnt(12)
  v_pk_add_f32 v[148:149], v[148:149], v[180:181]
  v_pk_add_f32 v[150:151], v[150:151], v[182:183]
  v_pk_add_f32 v[244:245], v[244:245], v[212:213]
  v_pk_add_f32 v[246:247], v[246:247], v[214:215]
  v_pk_add_f32 v[244:245], v[244:245], v[148:149]
  v_pk_add_f32 v[246:247], v[246:247], v[150:151]
  v_cvt_pk_bf16_f32 v74, v244, v245
  v_cvt_pk_bf16_f32 v75, v246, v247
  ds_write_b64 v12, v[74:75] offset:2048
  s_waitcnt lgkmcnt(9)
  v_pk_add_f32 v[152:153], v[152:153], v[184:185]
  v_pk_add_f32 v[154:155], v[154:155], v[186:187]
  v_pk_add_f32 v[248:249], v[248:249], v[216:217]
  v_pk_add_f32 v[250:251], v[250:251], v[218:219]
  v_pk_add_f32 v[248:249], v[248:249], v[152:153]
  v_pk_add_f32 v[250:251], v[250:251], v[154:155]
  v_cvt_pk_bf16_f32 v76, v248, v249
  v_cvt_pk_bf16_f32 v77, v250, v251
  ds_write_b64 v13, v[76:77] offset:2048
  s_waitcnt lgkmcnt(6)
  v_pk_add_f32 v[156:157], v[156:157], v[188:189]
  v_pk_add_f32 v[158:159], v[158:159], v[190:191]
  v_pk_add_f32 v[252:253], v[252:253], v[220:221]
  v_pk_add_f32 v[254:255], v[254:255], v[222:223]
  v_pk_add_f32 v[252:253], v[252:253], v[156:157]
  v_pk_add_f32 v[254:255], v[254:255], v[158:159]
  v_cvt_pk_bf16_f32 v78, v252, v253
  v_cvt_pk_bf16_f32 v79, v254, v255
  ds_write_b64 v14, v[78:79] offset:2048
  ds_read_b128 v[104:107], v26 offset:2048
  ds_read_b128 v[108:111], v26 offset:3072
  s_waitcnt lgkmcnt(7)
  buffer_store_dwordx4 v[96:99], v27, s[40:43], s70 offen sc1
  s_add_u32 s70, s70, 16384
  s_waitcnt lgkmcnt(6)
  buffer_store_dwordx4 v[100:103], v27, s[40:43], s70 offen sc1
  s_add_u32 s70, s70, 16384
  s_waitcnt lgkmcnt(1)
  buffer_store_dwordx4 v[104:107], v27, s[40:43], s70 offen sc1
  s_add_u32 s70, s70, 16384
  s_waitcnt lgkmcnt(0)
  buffer_store_dwordx4 v[108:111], v27, s[40:43], s70 offen sc1
  s_endpgm
L_sec0:
  s_waitcnt vmcnt(12)
  v_cmp_eq_u32 vcc, 1, v29
  s_add_u32 s80, s5, 1048576
  s_bitcmp1_b32 vcc_lo, 0
  s_cselect_b32 s82, 1, 0
  s_cselect_b32 s80, s80, 1073741824
  s_add_u32 s78, s80, 8192
  s_cmp_eq_u32 s82, 0
  s_cbranch_scc1 L_sec0_r
  buffer_load_dwordx4 v[64:67], v11, s[48:51], s80 offen offset:0 sc1
  buffer_load_dwordx4 v[96:99], v11, s[48:51], s78 offen offset:0 sc1
  buffer_load_dwordx4 v[68:71], v11, s[48:51], s80 offen offset:1024 sc1
  buffer_load_dwordx4 v[100:103], v11, s[48:51], s78 offen offset:1024 sc1
  buffer_load_dwordx4 v[72:75], v12, s[48:51], s80 offen offset:0 sc1
  buffer_load_dwordx4 v[104:107], v12, s[48:51], s78 offen offset:0 sc1
  buffer_load_dwordx4 v[76:79], v12, s[48:51], s80 offen offset:1024 sc1
  buffer_load_dwordx4 v[108:111], v12, s[48:51], s78 offen offset:1024 sc1
  s_branch L_sec0_r
L_blk0:
  s_mov_b32 s75, 262144
  s_waitcnt vmcnt(12)
  s_branch L_blk0b
L_blk0a:
  s_sleep 2
  buffer_load_dword v29, v15, s[48:51], s4 offen sc1
  s_waitcnt vmcnt(0)
  s_sub_u32 s75, s75, 1
  s_cbranch_scc0 L_blk0b
  v_mov_b32 v29, 1
L_blk0b:
  v_cmp_eq_u32 vcc, 1, v29
  s_add_u32 s80, s5, 1048576
  s_bitcmp1_b32 vcc_lo, 0
  s_cselect_b32 s82, 1, 0
  s_cselect_b32 s80, s80, 1073741824
  s_add_u32 s78, s80, 8192
  s_cmp_eq_u32 s82, 0
  s_cbranch_scc1 L_blk0a
  buffer_load_dwordx4 v[64:67], v11, s[48:51], s80 offen offset:0 sc1
  buffer_load_dwordx4 v[96:99], v11, s[48:51], s78 offen offset:0 sc1
  buffer_load_dwordx4 v[68:71], v11, s[48:51], s80 offen offset:1024 sc1
  buffer_load_dwordx4 v[100:103], v11, s[48:51], s78 offen offset:1024 sc1
  buffer_load_dwordx4 v[72:75], v12, s[48:51], s80 offen offset:0 sc1
  buffer_load_dwordx4 v[104:107], v12, s[48:51], s78 offen offset:0 sc1
  buffer_load_dwordx4 v[76:79], v12, s[48:51], s80 offen offset:1024 sc1
  buffer_load_dwordx4 v[108:111], v12, s[48:51], s78 offen offset:1024 sc1
  buffer_load_dwordx4 v[80:83], v13, s[48:51], s80 offen offset:0 sc1
  buffer_load_dwordx4 v[112:115], v13, s[48:51], s78 offen offset:0 sc1
  buffer_load_dwordx4 v[84:87], v13, s[48:51], s80 offen offset:1024 sc1
  buffer_load_dwordx4 v[116:119], v13, s[48:51], s78 offen offset:1024 sc1
  buffer_load_dwordx4 v[88:91], v14, s[48:51], s80 offen offset:0 sc1
  buffer_load_dwordx4 v[120:123], v14, s[48:51], s78 offen offset:0 sc1
  buffer_load_dwordx4 v[92:95], v14, s[48:51], s80 offen offset:1024 sc1
  buffer_load_dwordx4 v[124:127], v14, s[48:51], s78 offen offset:1024 sc1
  s_branch L_join0
L_sec1:
  s_waitcnt vmcnt(8)
  v_cmp_eq_u32 vcc, 1, v29
  s_add_u32 s80, s5, 917504
  s_bitcmp1_b32 vcc_lo, 1
  s_cselect_b32 s82, 1, 0
  s_cselect_b32 s80, s80, 1073741824
  s_add_u32 s78, s80, 8192
  s_cmp_eq_u32 s82, 0
  s_cbranch_scc1 L_sec1_r
  buffer_load_dwordx4 v[64:67], v11, s[48:51], s80 offen offset:0 sc1
  buffer_load_dwordx4 v[96:99], v11, s[48:51], s78 offen offset:0 sc1
  buffer_load_dwordx4 v[68:71], v11, s[48:51], s80 offen offset:1024 sc1
  buffer_load_dwordx4 v[100:103], v11, s[48:51], s78 offen offset:1024 sc1
  buffer_load_dwordx4 v[72:75], v12, s[48:51], s80 offen offset:0 sc1
  buffer_load_dwordx4 v[104:107], v12, s[48:51], s78 offen offset:0 sc1
  buffer_load_dwordx4 v[76:79], v12, s[48:51], s80 offen offset:1024 sc1
  buffer_load_dwordx4 v[108:111], v12, s[48:51], s78 offen offset:1024 sc1
  s_branch L_sec1_r
L_blk1:
  s_mov_b32 s75, 262144
  s_waitcnt vmcnt(8)
  s_branch L_blk1b
L_blk1a:
  s_sleep 2
  buffer_load_dword v29, v15, s[48:51], s4 offen sc1
  s_waitcnt vmcnt(0)
  s_sub_u32 s75, s75, 1
  s_cbranch_scc0 L_blk1b
  v_mov_b32 v29, 1
L_blk1b:
  v_cmp_eq_u32 vcc, 1, v29
  s_add_u32 s80, s5, 917504
  s_bitcmp1_b32 vcc_lo, 1
  s_cselect_b32 s82, 1, 0
  s_cselect_b32 s80, s80, 1073741824
  s_add_u32 s78, s80, 8192
  s_cmp_eq_u32 s82, 0
  s_cbranch_scc1 L_blk1a
  buffer_load_dwordx4 v[64:67], v11, s[48:51], s80 offen offset:0 sc1
  buffer_load_dwordx4 v[96:99], v11, s[48:51], s78 offen offset:0 sc1
  buffer_load_dwordx4 v[68:71], v11, s[48:51], s80 offen offset:1024 sc1
  buffer_load_dwordx4 v[100:103], v11, s[48:51], s78 offen offset:1024 sc1
  buffer_load_dwordx4 v[72:75], v12, s[48:51], s80 offen offset:0 sc1
  buffer_load_dwordx4 v[104:107], v12, s[48:51], s78 offen offset:0 sc1
  buffer_load_dwordx4 v[76:79], v12, s[48:51], s80 offen offset:1024 sc1
  buffer_load_dwordx4 v[108:111], v12, s[48:51], s78 offen offset:1024 sc1
  buffer_load_dwordx4 v[80:83], v13, s[48:51], s80 offen offset:0 sc1
  buffer_load_dwordx4 v[112:115], v13, s[48:51], s78 offen offset:0 sc1
  buffer_load_dwordx4 v[84:87], v13, s[48:51], s80 offen offset:1024 sc1
  buffer_load_dwordx4 v[116:119], v13, s[48:51], s78 offen offset:1024 sc1
  buffer_load_dwordx4 v[88:91], v14, s[48:51], s80 offen offset:0 sc1
  buffer_load_dwordx4 v[120:123], v14, s[48:51], s78 offen offset:0 sc1
  buffer_load_dwordx4 v[92:95], v14, s[48:51], s80 offen offset:1024 sc1
  buffer_load_dwordx4 v[124:127], v14, s[48:51], s78 offen offset:1024 sc1
  s_branch L_join1
L_sec2:
  s_waitcnt vmcnt(12)
  v_cmp_eq_u32 vcc, 1, v29
  s_add_u32 s80, s5, 983040
  s_bitcmp1_b32 vcc_lo, 2
  s_cselect_b32 s82, 1, 0
  s_cselect_b32 s80, s80, 1073741824
  s_add_u32 s78, s80, 8192
  s_cmp_eq_u32 s82, 0
  s_cbranch_scc1 L_sec2_r
  buffer_load_dwordx4 v[64:67], v11, s[48:51], s80 offen offset:0 sc1
  buffer_load_dwordx4 v[96:99], v11, s[48:51], s78 offen offset:0 sc1
  buffer_load_dwordx4 v[68:71], v11, s[48:51], s80 offen offset:1024 sc1
  buffer_load_dwordx4 v[100:103], v11, s[48:51], s78 offen offset:1024 sc1
  buffer_load_dwordx4 v[72:75], v12, s[48:51], s80 offen offset:0 sc1
  buffer_load_dwordx4 v[104:107], v12, s[48:51], s78 offen offset:0 sc1
  buffer_load_dwordx4 v[76:79], v12, s[48:51], s80 offen offset:1024 sc1
  buffer_load_dwordx4 v[108:111], v12, s[48:51], s78 offen offset:1024 sc1
  s_branch L_sec2_r
L_blk2:
  s_mov_b32 s75, 262144
  s_waitcnt vmcnt(8)
  s_branch L_blk2b
L_blk2a:
  s_sleep 2
  buffer_load_dword v29, v15, s[48:51], s4 offen sc1
  s_waitcnt vmcnt(0)
  s_sub_u32 s75, s75, 1
  s_cbranch_scc0 L_blk2b
  v_mov_b32 v29, 1
L_blk2b:
  v_cmp_eq_u32 vcc, 1, v29
  s_add_u32 s80, s5, 983040
  s_bitcmp1_b32 vcc_lo, 2
  s_cselect_b32 s82, 1, 0
  s_cselect_b32 s80, s80, 1073741824
  s_add_u32 s78, s80, 8192
  s_cmp_eq_u32 s82, 0
  s_cbranch_scc1 L_blk2a
  buffer_load_dwordx4 v[64:67], v11, s[48:51], s80 offen offset:0 sc1
  buffer_load_dwordx4 v[96:99], v11, s[48:51], s78 offen offset:0 sc1
  buffer_load_dwordx4 v[68:71], v11, s[48:51], s80 offen offset:1024 sc1
  buffer_load_dwordx4 v[100:103], v11, s[48:51], s78 offen offset:1024 sc1
  buffer_load_dwordx4 v[72:75], v12, s[48:51], s80 offen offset:0 sc1
  buffer_load_dwordx4 v[104:107], v12, s[48:51], s78 offen offset:0 sc1
  buffer_load_dwordx4 v[76:79], v12, s[48:51], s80 offen offset:1024 sc1
  buffer_load_dwordx4 v[108:111], v12, s[48:51], s78 offen offset:1024 sc1
  buffer_load_dwordx4 v[80:83], v13, s[48:51], s80 offen offset:0 sc1
  buffer_load_dwordx4 v[112:115], v13, s[48:51], s78 offen offset:0 sc1
  buffer_load_dwordx4 v[84:87], v13, s[48:51], s80 offen offset:1024 sc1
  buffer_load_dwordx4 v[116:119], v13, s[48:51], s78 offen offset:1024 sc1
  buffer_load_dwordx4 v[88:91], v14, s[48:51], s80 offen offset:0 sc1
  buffer_load_dwordx4 v[120:123], v14, s[48:51], s78 offen offset:0 sc1
  buffer_load_dwordx4 v[92:95], v14, s[48:51], s80 offen offset:1024 sc1
  buffer_load_dwordx4 v[124:127], v14, s[48:51], s78 offen offset:1024 sc1
  s_branch L_join2
L_sec3:
  s_waitcnt vmcnt(8)
  v_cmp_eq_u32 vcc, 1, v29
  s_add_u32 s80, s5, 1114112
  s_bitcmp1_b32 vcc_lo, 3
  s_cselect_b32 s82, 1, 0
  s_cselect_b32 s80, s80, 1073741824
  s_add_u32 s78, s80, 8192
  s_cmp_eq_u32 s82, 0
  s_cbranch_scc1 L_sec3_r
  buffer_load_dwordx4 v[64:67], v11, s[48:51], s80 offen offset:0 sc1
  buffer_load_dwordx4 v[96:99], v11, s[48:51], s78 offen offset:0 sc1
  buffer_load_dwordx4 v[68:71], v11, s[48:51], s80 offen offset:1024 sc1
  buffer_load_dwordx4 v[100:103], v11, s[48:51], s78 offen offset:1024 sc1
  buffer_load_dwordx4 v[72:75], v12, s[48:51], s80 offen offset:0 sc1
  buffer_load_dwordx4 v[104:107], v12, s[48:51], s78 offen offset:0 sc1
  buffer_load_dwordx4 v[76:79], v12, s[48:51], s80 offen offset:1024 sc1
  buffer_load_dwordx4 v[108:111], v12, s[48:51], s78 offen offset:1024 sc1
  s_branch L_sec3_r
L_blk3:
  s_mov_b32 s75, 262144
  s_waitcnt vmcnt(8)
  s_branch L_blk3b
L_blk3a:
  s_sleep 2
  buffer_load_dword v29, v15, s[48:51], s4 offen sc1
  s_waitcnt vmcnt(0)
  s_sub_u32 s75, s75, 1
  s_cbranch_scc0 L_blk3b
  v_mov_b32 v29, 1
L_blk3b:
  v_cmp_eq_u32 vcc, 1, v29
  s_add_u32 s80, s5, 1114112
  s_bitcmp1_b32 vcc_lo, 3
  s_cselect_b32 s82, 1, 0
  s_cselect_b32 s80, s80, 1073741824
  s_add_u32 s78, s80, 8192
  s_cmp_eq_u32 s82, 0
  s_cbranch_scc1 L_blk3a
  buffer_load_dwordx4 v[64:67], v11, s[48:51], s80 offen offset:0 sc1
  buffer_load_dwordx4 v[96:99], v11, s[48:51], s78 offen offset:0 sc1
  buffer_load_dwordx4 v[68:71], v11, s[48:51], s80 offen offset:1024 sc1
  buffer_load_dwordx4 v[100:103], v11, s[48:51], s78 offen offset:1024 sc1
  buffer_load_dwordx4 v[72:75], v12, s[48:51], s80 offen offset:0 sc1
  buffer_load_dwordx4 v[104:107], v12, s[48:51], s78 offen offset:0 sc1
  buffer_load_dwordx4 v[76:79], v12, s[48:51], s80 offen offset:1024 sc1
  buffer_load_dwordx4 v[108:111], v12, s[48:51], s78 offen offset:1024 sc1
  buffer_load_dwordx4 v[80:83], v13, s[48:51], s80 offen offset:0 sc1
  buffer_load_dwordx4 v[112:115], v13, s[48:51], s78 offen offset:0 sc1
  buffer_load_dwordx4 v[84:87], v13, s[48:51], s80 offen offset:1024 sc1
  buffer_load_dwordx4 v[116:119], v13, s[48:51], s78 offen offset:1024 sc1
  buffer_load_dwordx4 v[88:91], v14, s[48:51], s80 offen offset:0 sc1
  buffer_load_dwordx4 v[120:123], v14, s[48:51], s78 offen offset:0 sc1
  buffer_load_dwordx4 v[92:95], v14, s[48:51], s80 offen offset:1024 sc1
  buffer_load_dwordx4 v[124:127], v14, s[48:51], s78 offen offset:1024 sc1
  s_branch L_join3
L_wa0:
  s_mov_b32 s71, 262144
  v_mov_b32 v31, 155660
L_wa:
  ds_read_b32 v17, v31
  s_waitcnt lgkmcnt(0)
  v_readfirstlane_b32 s70, v17
  s_cmp_ge_u32 s70, 4
  s_cbranch_scc1 L_wa_x
  s_sleep 2
  s_sub_u32 s71, s71, 1
  s_cmp_lg_u32 s71, 0
  s_cbranch_scc1 L_wa
L_wa_x:
  s_branch L_wa_r
L_hookF:
  v_lshlrev_b32 v15, 9, v0
  buffer_load_dword v19, v15, s[56:59], s77 offen
  s_branch L_hookF_r
L_hookW:
  s_cmp_eq_u32 s76, 5
  s_cbranch_scc1 L_g2end
  s_mov_b32 s71, 262144
  v_mov_b32 v15, 155648
L_wq:
  ds_read_b32 v17, v15
  s_waitcnt lgkmcnt(0)
  v_readfirstlane_b32 s70, v17
  s_cmp_ge_u32 s70, 4
  s_cbranch_scc1 L_wq_x
  s_sleep 2
  s_sub_u32 s71, s71, 1
  s_cmp_lg_u32 s71, 0
  s_cbranch_scc1 L_wq
L_wq_x:
  s_mov_b32 s32, s12
  s_mov_b32 s33, s13
  s_mov_b32 s34, 2097152
  s_mov_b32 s35, 0x20000
  s_lshl_b32 s70, s69, 12
  s_add_u32 m0, s70, 73728
  s_lshl_b32 s70, s69, 17
  s_add_u32 s70, s70, 524288
  buffer_load_dwordx4 v3, s[32:35], s70 offen offset:0 lds
  buffer_load_dwordx4 v4, s[32:35], s70 offen offset:1024 lds
  buffer_load_dwordx4 v5, s[32:35], s70 offen offset:2048 lds
  buffer_load_dwordx4 v6, s[32:35], s70 offen offset:3072 lds
  s_branch L_hookW_r
L_a1m0:
  s_add_u32 m0, s80, 28672
  s_nop 0
  buffer_load_dwordx4 v3, s[36:39], s81 offen offset:0 lds
  buffer_load_dwordx4 v4, s[36:39], s81 offen offset:1024 lds
  buffer_load_dwordx4 v5, s[36:39], s81 offen offset:2048 lds
  buffer_load_dwordx4 v6, s[36:39], s81 offen offset:3072 lds
  s_bfe_u32 s77, s101, 0x10002
  s_lshr_b32 s78, s101, 3
  s_lshl_b32 s78, s78, 2
  s_and_b32 s70, s101, 3
  s_add_u32 s78, s78, s70
  s_lshl_b32 s78, s78, 4
  s_lshl_b32 s70, s64, 7
  s_add_u32 s78, s78, s70
  s_cmp_eq_u32 s77, 0
  s_cselect_b32 s40, s8, s10
  s_cselect_b32 s41, s9, s11
  s_mov_b32 s42, 65536
  s_mov_b32 s43, 0x20000
  v_lshlrev_b32 v15, 4, v0
  s_lshl_b32 s79, s69, 13
  s_add_u32 s79, s79, 122880
  s_lshl_b32 s70, s69, 7
  v_lshl_add_u32 v17, v2, 4, s70
  v_add_u32 v12, 156160, v17
  v_lshrrev_b32 v16, 3, v0
  v_add_u32 v16, s78, v16
  v_and_b32 v17, 7, v0
  v_xor_b32 v17, v17, v2
  v_lshl_add_u32 v17, v17, 4, s70
  v_lshl_add_u32 v140, v16, 11, v17
  v_xor_b32 v16, 64, v140
  v_add_u32 v141, 15360, v16
  v_lshrrev_b32 v16, 1, v1
  v_xor_b32 v16, v16, v2
  v_lshlrev_b32 v16, 4, v16
  v_lshl_add_u32 v16, v1, 7, v16
  v_add_u32 v142, s79, v16
  v_xor_b32 v143, 64, v142
  v_lshrrev_b32 v16, 4, v0
  v_and_b32 v16, 2, v16
  v_xor_b32 v16, v16, v0
  s_lshl_b32 s70, s69, 12
  v_lshl_add_u32 v13, v16, 4, s70
  v_lshrrev_b32 v16, 2, v1
  v_lshl_add_u32 v16, v2, 3, v16
  v_and_b32 v17, 3, v1
  v_lshlrev_b32 v17, 3, v17
  v_lshl_add_u32 v16, v16, 6, v17
  v_and_b32 v17, 1, v2
  v_lshl_add_u32 v16, v17, 5, v16
  v_add_u32 v24, s79, v16
  v_xor_b32 v25, 32, v24
  v_mov_b32 v128, 0
  v_mov_b32 v129, 0
  v_mov_b32 v130, 0
  v_mov_b32 v131, 0
  v_mov_b32 v132, 0
  v_mov_b32 v133, 0
  v_mov_b32 v134, 0
  v_mov_b32 v135, 0
  v_mov_b32 v136, 0
  v_mov_b32 v137, 0
  v_mov_b32 v138, 0
  v_mov_b32 v139, 0
  s_add_u32 m0, s80, 32768
  s_nop 0
  buffer_load_dwordx4 v7, s[36:39], s81 offen offset:0 lds
  buffer_load_dwordx4 v8, s[36:39], s81 offen offset:1024 lds
  buffer_load_dwordx4 v9, s[36:39], s81 offen offset:2048 lds
  s_add_u32 s81, s81, 458752
  s_waitcnt vmcnt(7)
  s_barrier
  s_add_u32 m0, s18, 57344
  s_nop 0
  buffer_load_dwordx4 v148, s[56:59], s14 offen offset:0 lds
  buffer_load_dwordx4 v149, s[56:59], s14 offen offset:1024 lds
  s_add_u32 s14, s14, 131072
  s_add_u32 m0, s15, 106496
  s_nop 0
  buffer_load_dwordx4 v144, s[32:35], s82 offen offset:0 lds
  buffer_load_dwordx4 v145, s[32:35], s82 offen offset:1024 lds
  buffer_load_dwordx4 v146, s[32:35], s82 offen offset:2048 lds
  buffer_load_dwordx4 v147, s[32:35], s82 offen offset:3072 lds
  s_add_u32 s82, s82, 128
  s_add_u32 m0, s79, 0
  s_mov_b32 s70, 0
  buffer_load_dwordx4 v13, s[40:43], s70 offen offset:0 lds
  buffer_load_dwordx4 v13, s[40:43], s70 offen offset:1024 lds
  s_waitcnt vmcnt(8)
  s_barrier
  s_add_u32 m0, s80, 0
  s_nop 0
  buffer_load_dwordx4 v3, s[36:39], s81 offen offset:0 lds
  buffer_load_dwordx4 v4, s[36:39], s81 offen offset:1024 lds
  buffer_load_dwordx4 v5, s[36:39], s81 offen offset:2048 lds
  buffer_load_dwordx4 v6, s[36:39], s81 offen offset:3072 lds
  s_add_u32 m0, s80, 4096
  s_nop 0
  buffer_load_dwordx4 v7, s[36:39], s81 offen offset:0 lds
  buffer_load_dwordx4 v8, s[36:39], s81 offen offset:1024 lds
  buffer_load_dwordx4 v9, s[36:39], s81 offen offset:2048 lds
  s_add_u32 s81, s81, 458752
  s_waitcnt lgkmcnt(0)
  s_add_u32 m0, s79, 4096
  s_mov_b32 s70, 2048
  buffer_load_dwordx4 v13, s[40:43], s70 offen offset:0 lds
  buffer_load_dwordx4 v13, s[40:43], s70 offen offset:1024 lds
  s_waitcnt vmcnt(11)
  s_barrier
  s_add_u32 m0, s18, 65536
  s_nop 0
  buffer_load_dwordx4 v148, s[56:59], s14 offen offset:0 lds
  buffer_load_dwordx4 v149, s[56:59], s14 offen offset:1024 lds
  s_add_u32 s14, s14, 131072
  s_add_u32 m0, s15, 73728
  s_nop 0
  buffer_load_dwordx4 v144, s[32:35], s82 offen offset:0 lds
  buffer_load_dwordx4 v145, s[32:35], s82 offen offset:1024 lds
  buffer_load_dwordx4 v146, s[32:35], s82 offen offset:2048 lds
  buffer_load_dwordx4 v147, s[32:35], s82 offen offset:3072 lds
  s_add_u32 s82, s82, 128
  s_add_u32 m0, s79, 6144
  s_movk_i32 s70, 0
  buffer_load_dwordx4 v140, s[32:35], s70 offen offset:0 lds
  buffer_load_dwordx4 v141, s[32:35], s70 offen offset:1024 lds
  s_waitcnt vmcnt(10)
  s_barrier
  s_add_u32 m0, s80, 28672
  s_nop 0
  buffer_load_dwordx4 v3, s[36:39], s81 offen offset:0 lds
  buffer_load_dwordx4 v4, s[36:39], s81 offen offset:1024 lds
  buffer_load_dwordx4 v5, s[36:39], s81 offen offset:2048 lds
  buffer_load_dwordx4 v6, s[36:39], s81 offen offset:3072 lds
  s_add_u32 m0, s80, 32768
  s_nop 0
  buffer_load_dwordx4 v7, s[36:39], s81 offen offset:0 lds
  buffer_load_dwordx4 v8, s[36:39], s81 offen offset:1024 lds
  buffer_load_dwordx4 v9, s[36:39], s81 offen offset:2048 lds
  s_add_u32 s81, s81, 458752
  s_add_u32 m0, s79, 2048
  s_mov_b32 s70, 16384
  buffer_load_dwordx4 v13, s[40:43], s70 offen offset:0 lds
  buffer_load_dwordx4 v13, s[40:43], s70 offen offset:1024 lds
  s_waitcnt vmcnt(11)
  s_barrier
  s_waitcnt vmcnt(9)
  s_add_u32 m0, s18, 57344
  s_nop 0
  buffer_load_dwordx4 v148, s[56:59], s14 offen offset:0 lds
  ds_read_b64_tr_b16 v[96:97], v24 offset:0
  ds_read_b64_tr_b16 v[98:99], v24 offset:256
  buffer_load_dwordx4 v149, s[56:59], s14 offen offset:1024 lds
  ds_read_b64_tr_b16 v[100:101], v25 offset:0
  ds_read_b64_tr_b16 v[102:103], v25 offset:256
  s_add_u32 s14, s14, 131072
  s_add_u32 m0, s15, 90112
  s_nop 0
  buffer_load_dwordx4 v144, s[32:35], s82 offen offset:0 lds
  ds_read_b64_tr_b16 v[104:105], v24 offset:4096
  ds_read_b64_tr_b16 v[106:107], v24 offset:4352
  buffer_load_dwordx4 v145, s[32:35], s82 offen offset:1024 lds
  ds_read_b64_tr_b16 v[108:109], v25 offset:4096
  ds_read_b64_tr_b16 v[110:111], v25 offset:4352
  buffer_load_dwordx4 v146, s[32:35], s82 offen offset:2048 lds
  ds_read_b128 v[32:35], v142 offset:6144
  ds_read_b128 v[36:39], v143 offset:6144
  buffer_load_dwordx4 v147, s[32:35], s82 offen offset:3072 lds
  s_cmp_lg_u32 s77, 0
  s_cbranch_scc1 L_ko_2
  ds_read_b128 v[64:67], v12 offset:0
  ds_read_b128 v[68:71], v12 offset:64
L_ko_2:
  s_add_u32 s82, s82, 128
  s_waitcnt lgkmcnt(0)
  s_add_u32 m0, s79, 4096
  s_mov_b32 s70, 18432
  buffer_load_dwordx4 v13, s[40:43], s70 offen offset:0 lds
  buffer_load_dwordx4 v13, s[40:43], s70 offen offset:1024 lds
  s_waitcnt vmcnt(10)
  s_barrier
  s_add_u32 m0, s80, 0
  s_nop 0
  buffer_load_dwordx4 v3, s[36:39], s81 offen offset:0 lds
  buffer_load_dwordx4 v4, s[36:39], s81 offen offset:1024 lds
  buffer_load_dwordx4 v5, s[36:39], s81 offen offset:2048 lds
  buffer_load_dwordx4 v6, s[36:39], s81 offen offset:3072 lds
  s_waitcnt lgkmcnt(0)
  s_cmp_lg_u32 s77, 0
  s_cbranch_scc1 L_kv_3
  v_mfma_f32_16x16x32_bf16 v[128:131], v[96:99], v[32:35], v[128:131]
  v_mfma_f32_16x16x32_bf16 v[128:131], v[104:107], v[36:39], v[128:131]
  v_mfma_f32_16x16x32_bf16 v[132:135], v[100:103], v[32:35], v[132:135]
  v_mfma_f32_16x16x32_bf16 v[132:135], v[108:111], v[36:39], v[132:135]
  v_mfma_f32_16x16x32_bf16 v[136:139], v[64:67], v[32:35], v[136:139]
  v_mfma_f32_16x16x32_bf16 v[136:139], v[68:71], v[36:39], v[136:139]
  s_branch L_kd_4
L_kv_3:
  v_mfma_f32_16x16x32_bf16 v[128:131], v[32:35], v[96:99], v[128:131]
  v_mfma_f32_16x16x32_bf16 v[128:131], v[36:39], v[104:107], v[128:131]
  v_mfma_f32_16x16x32_bf16 v[132:135], v[32:35], v[100:103], v[132:135]
  v_mfma_f32_16x16x32_bf16 v[132:135], v[36:39], v[108:111], v[132:135]
L_kd_4:
  s_add_u32 m0, s80, 4096
  s_nop 0
  buffer_load_dwordx4 v7, s[36:39], s81 offen offset:0 lds
  buffer_load_dwordx4 v8, s[36:39], s81 offen offset:1024 lds
  buffer_load_dwordx4 v9, s[36:39], s81 offen offset:2048 lds
  s_add_u32 s81, s81, 458752
  s_add_u32 m0, s79, 6144
  s_movk_i32 s70, 512
  buffer_load_dwordx4 v140, s[32:35], s70 offen offset:0 lds
  buffer_load_dwordx4 v141, s[32:35], s70 offen offset:1024 lds
  s_waitcnt vmcnt(11)
  s_barrier
  s_add_u32 m0, s18, 65536
  s_nop 0
  buffer_load_dwordx4 v148, s[56:59], s14 offen offset:0 lds
  buffer_load_dwordx4 v149, s[56:59], s14 offen offset:1024 lds
  s_add_u32 s14, s14, 131072
  s_add_u32 m0, s15, 106496
  s_nop 0
  buffer_load_dwordx4 v144, s[32:35], s82 offen offset:0 lds
  buffer_load_dwordx4 v145, s[32:35], s82 offen offset:1024 lds
  buffer_load_dwordx4 v146, s[32:35], s82 offen offset:2048 lds
  buffer_load_dwordx4 v147, s[32:35], s82 offen offset:3072 lds
  s_add_u32 s82, s82, 128
  s_add_u32 m0, s79, 0
  s_mov_b32 s70, 32768
  buffer_load_dwordx4 v13, s[40:43], s70 offen offset:0 lds
  buffer_load_dwordx4 v13, s[40:43], s70 offen offset:1024 lds
  s_waitcnt vmcnt(10)
  s_barrier
  s_waitcnt vmcnt(8)
  s_add_u32 m0, s80, 28672
  s_nop 0
  buffer_load_dwordx4 v3, s[36:39], s81 offen offset:0 lds
  ds_read_b64_tr_b16 v[96:97], v24 offset:2048
  ds_read_b64_tr_b16 v[98:99], v24 offset:2304
  buffer_load_dwordx4 v4, s[36:39], s81 offen offset:1024 lds
  ds_read_b64_tr_b16 v[100:101], v25 offset:2048
  ds_read_b64_tr_b16 v[102:103], v25 offset:2304
  buffer_load_dwordx4 v5, s[36:39], s81 offen offset:2048 lds
  ds_read_b64_tr_b16 v[104:105], v24 offset:4096
  ds_read_b64_tr_b16 v[106:107], v24 offset:4352
  buffer_load_dwordx4 v6, s[36:39], s81 offen offset:3072 lds
  ds_read_b64_tr_b16 v[108:109], v25 offset:4096
  ds_read_b64_tr_b16 v[110:111], v25 offset:4352
  s_add_u32 m0, s80, 32768
  s_nop 0
  buffer_load_dwordx4 v7, s[36:39], s81 offen offset:0 lds
  ds_read_b128 v[32:35], v142 offset:6144
  ds_read_b128 v[36:39], v143 offset:6144
  buffer_load_dwordx4 v8, s[36:39], s81 offen offset:1024 lds
  s_cmp_lg_u32 s77, 0
  s_cbranch_scc1 L_ko_5
  ds_read_b128 v[64:67], v12 offset:512
  ds_read_b128 v[68:71], v12 offset:576
L_ko_5:
  buffer_load_dwordx4 v9, s[36:39], s81 offen offset:2048 lds
  s_add_u32 s81, s81, 458752
  s_waitcnt lgkmcnt(0)
  s_add_u32 m0, s79, 4096
  s_mov_b32 s70, 34816
  buffer_load_dwordx4 v13, s[40:43], s70 offen offset:0 lds
  buffer_load_dwordx4 v13, s[40:43], s70 offen offset:1024 lds
  s_waitcnt vmcnt(11)
  s_barrier
  s_add_u32 m0, s18, 57344
  s_nop 0
  buffer_load_dwordx4 v148, s[56:59], s14 offen offset:0 lds
  buffer_load_dwordx4 v149, s[56:59], s14 offen offset:1024 lds
  s_add_u32 s14, s14, 131072
  s_waitcnt lgkmcnt(0)
  s_cmp_lg_u32 s77, 0
  s_cbranch_scc1 L_kv_6
  v_mfma_f32_16x16x32_bf16 v[128:131], v[96:99], v[32:35], v[128:131]
  v_mfma_f32_16x16x32_bf16 v[128:131], v[104:107], v[36:39], v[128:131]
  v_mfma_f32_16x16x32_bf16 v[132:135], v[100:103], v[32:35], v[132:135]
  v_mfma_f32_16x16x32_bf16 v[132:135], v[108:111], v[36:39], v[132:135]
  v_mfma_f32_16x16x32_bf16 v[136:139], v[64:67], v[32:35], v[136:139]
  v_mfma_f32_16x16x32_bf16 v[136:139], v[68:71], v[36:39], v[136:139]
  s_branch L_kd_7
L_kv_6:
  v_mfma_f32_16x16x32_bf16 v[128:131], v[32:35], v[96:99], v[128:131]
  v_mfma_f32_16x16x32_bf16 v[128:131], v[36:39], v[104:107], v[128:131]
  v_mfma_f32_16x16x32_bf16 v[132:135], v[32:35], v[100:103], v[132:135]
  v_mfma_f32_16x16x32_bf16 v[132:135], v[36:39], v[108:111], v[132:135]
L_kd_7:
  s_add_u32 m0, s15, 73728
  s_nop 0
  buffer_load_dwordx4 v144, s[32:35], s82 offen offset:0 lds
  buffer_load_dwordx4 v145, s[32:35], s82 offen offset:1024 lds
  buffer_load_dwordx4 v146, s[32:35], s82 offen offset:2048 lds
  buffer_load_dwordx4 v147, s[32:35], s82 offen offset:3072 lds
  s_add_u32 s82, s82, 128
  s_add_u32 m0, s79, 6144
  s_movk_i32 s70, 1024
  buffer_load_dwordx4 v140, s[32:35], s70 offen offset:0 lds
  buffer_load_dwordx4 v141, s[32:35], s70 offen offset:1024 lds
  s_waitcnt vmcnt(10)
  s_barrier
  s_add_u32 m0, s80, 0
  s_nop 0
  buffer_load_dwordx4 v3, s[36:39], s81 offen offset:0 lds
  buffer_load_dwordx4 v4, s[36:39], s81 offen offset:1024 lds
  buffer_load_dwordx4 v5, s[36:39], s81 offen offset:2048 lds
  buffer_load_dwordx4 v6, s[36:39], s81 offen offset:3072 lds
  s_add_u32 m0, s80, 4096
  s_nop 0
  buffer_load_dwordx4 v7, s[36:39], s81 offen offset:0 lds
  buffer_load_dwordx4 v8, s[36:39], s81 offen offset:1024 lds
  buffer_load_dwordx4 v9, s[36:39], s81 offen offset:2048 lds
  s_add_u32 s81, s81, 458752
  s_add_u32 m0, s79, 2048
  s_mov_b32 s70, 49152
  buffer_load_dwordx4 v13, s[40:43], s70 offen offset:0 lds
  buffer_load_dwordx4 v13, s[40:43], s70 offen offset:1024 lds
  s_waitcnt vmcnt(11)
  s_barrier
  s_waitcnt vmcnt(9)
  s_add_u32 m0, s18, 65536
  s_nop 0
  buffer_load_dwordx4 v148, s[56:59], s14 offen offset:0 lds
  ds_read_b64_tr_b16 v[96:97], v24 offset:0
  ds_read_b64_tr_b16 v[98:99], v24 offset:256
  buffer_load_dwordx4 v149, s[56:59], s14 offen offset:1024 lds
  ds_read_b64_tr_b16 v[100:101], v25 offset:0
  ds_read_b64_tr_b16 v[102:103], v25 offset:256
  s_add_u32 s14, s14, 131072
  s_add_u32 m0, s15, 90112
  s_nop 0
  buffer_load_dwordx4 v144, s[32:35], s82 offen offset:0 lds
  ds_read_b64_tr_b16 v[104:105], v24 offset:4096
  ds_read_b64_tr_b16 v[106:107], v24 offset:4352
  buffer_load_dwordx4 v145, s[32:35], s82 offen offset:1024 lds
  ds_read_b64_tr_b16 v[108:109], v25 offset:4096
  ds_read_b64_tr_b16 v[110:111], v25 offset:4352
  buffer_load_dwordx4 v146, s[32:35], s82 offen offset:2048 lds
  ds_read_b128 v[32:35], v142 offset:6144
  ds_read_b128 v[36:39], v143 offset:6144
  buffer_load_dwordx4 v147, s[32:35], s82 offen offset:3072 lds
  s_cmp_lg_u32 s77, 0
  s_cbranch_scc1 L_ko_8
  ds_read_b128 v[64:67], v12 offset:1024
  ds_read_b128 v[68:71], v12 offset:1088
L_ko_8:
  s_add_u32 s82, s82, 128
  s_waitcnt lgkmcnt(0)
  s_add_u32 m0, s79, 4096
  s_mov_b32 s70, 51200
  buffer_load_dwordx4 v13, s[40:43], s70 offen offset:0 lds
  buffer_load_dwordx4 v13, s[40:43], s70 offen offset:1024 lds
  s_waitcnt vmcnt(10)
  s_barrier
  s_add_u32 m0, s80, 28672
  s_nop 0
  buffer_load_dwordx4 v3, s[36:39], s81 offen offset:0 lds
  buffer_load_dwordx4 v4, s[36:39], s81 offen offset:1024 lds
  buffer_load_dwordx4 v5, s[36:39], s81 offen offset:2048 lds
  buffer_load_dwordx4 v6, s[36:39], s81 offen offset:3072 lds
  s_waitcnt lgkmcnt(0)
  s_cmp_lg_u32 s77, 0
  s_cbranch_scc1 L_kv_9
  v_mfma_f32_16x16x32_bf16 v[128:131], v[96:99], v[32:35], v[128:131]
  v_mfma_f32_16x16x32_bf16 v[128:131], v[104:107], v[36:39], v[128:131]
  v_mfma_f32_16x16x32_bf16 v[132:135], v[100:103], v[32:35], v[132:135]
  v_mfma_f32_16x16x32_bf16 v[132:135], v[108:111], v[36:39], v[132:135]
  v_mfma_f32_16x16x32_bf16 v[136:139], v[64:67], v[32:35], v[136:139]
  v_mfma_f32_16x16x32_bf16 v[136:139], v[68:71], v[36:39], v[136:139]
  s_branch L_kd_10
L_kv_9:
  v_mfma_f32_16x16x32_bf16 v[128:131], v[32:35], v[96:99], v[128:131]
  v_mfma_f32_16x16x32_bf16 v[128:131], v[36:39], v[104:107], v[128:131]
  v_mfma_f32_16x16x32_bf16 v[132:135], v[32:35], v[100:103], v[132:135]
  v_mfma_f32_16x16x32_bf16 v[132:135], v[36:39], v[108:111], v[132:135]
L_kd_10:
  s_add_u32 m0, s80, 32768
  s_nop 0
  buffer_load_dwordx4 v7, s[36:39], s81 offen offset:0 lds
  buffer_load_dwordx4 v8, s[36:39], s81 offen offset:1024 lds
  buffer_load_dwordx4 v9, s[36:39], s81 offen offset:2048 lds
  s_add_u32 s81, s81, 458752
  s_add_u32 m0, s79, 6144
  s_movk_i32 s70, 1536
  buffer_load_dwordx4 v140, s[32:35], s70 offen offset:0 lds
  buffer_load_dwordx4 v141, s[32:35], s70 offen offset:1024 lds
  s_waitcnt vmcnt(11)
  s_barrier
  s_add_u32 m0, s18, 57344
  s_nop 0
  buffer_load_dwordx4 v148, s[56:59], s14 offen offset:0 lds
  buffer_load_dwordx4 v149, s[56:59], s14 offen offset:1024 lds
  s_add_u32 s14, s14, 131072
  s_add_u32 m0, s15, 106496
  s_nop 0
  buffer_load_dwordx4 v144, s[32:35], s82 offen offset:0 lds
  buffer_load_dwordx4 v145, s[32:35], s82 offen offset:1024 lds
  buffer_load_dwordx4 v146, s[32:35], s82 offen offset:2048 lds
  buffer_load_dwordx4 v147, s[32:35], s82 offen offset:3072 lds
  s_add_u32 s82, s82, 128
  s_waitcnt vmcnt(8)
  s_barrier
  s_waitcnt vmcnt(6)
  s_add_u32 m0, s80, 0
  s_nop 0
  buffer_load_dwordx4 v3, s[36:39], s81 offen offset:0 lds
  ds_read_b64_tr_b16 v[96:97], v24 offset:2048
  ds_read_b64_tr_b16 v[98:99], v24 offset:2304
  buffer_load_dwordx4 v4, s[36:39], s81 offen offset:1024 lds
  ds_read_b64_tr_b16 v[100:101], v25 offset:2048
  ds_read_b64_tr_b16 v[102:103], v25 offset:2304
  buffer_load_dwordx4 v5, s[36:39], s81 offen offset:2048 lds
  ds_read_b64_tr_b16 v[104:105], v24 offset:4096
  ds_read_b64_tr_b16 v[106:107], v24 offset:4352
  buffer_load_dwordx4 v6, s[36:39], s81 offen offset:3072 lds
  ds_read_b64_tr_b16 v[108:109], v25 offset:4096
  ds_read_b64_tr_b16 v[110:111], v25 offset:4352
  s_add_u32 m0, s80, 4096
  s_nop 0
  buffer_load_dwordx4 v7, s[36:39], s81 offen offset:0 lds
  ds_read_b128 v[32:35], v142 offset:6144
  ds_read_b128 v[36:39], v143 offset:6144
  buffer_load_dwordx4 v8, s[36:39], s81 offen offset:1024 lds
  s_cmp_lg_u32 s77, 0
  s_cbranch_scc1 L_ko_11
  ds_read_b128 v[64:67], v12 offset:1536
  ds_read_b128 v[68:71], v12 offset:1600
L_ko_11:
  buffer_load_dwordx4 v9, s[36:39], s81 offen offset:2048 lds
  s_add_u32 s81, s81, 458752
  s_waitcnt vmcnt(7)
  s_barrier
  s_add_u32 m0, s18, 65536
  s_nop 0
  buffer_load_dwordx4 v148, s[56:59], s14 offen offset:0 lds
  buffer_load_dwordx4 v149, s[56:59], s14 offen offset:1024 lds
  s_add_u32 s14, s14, 131072
  s_waitcnt lgkmcnt(0)
  s_cmp_lg_u32 s77, 0
  s_cbranch_scc1 L_kv_12
  v_mfma_f32_16x16x32_bf16 v[128:131], v[96:99], v[32:35], v[128:131]
  v_mfma_f32_16x16x32_bf16 v[128:131], v[104:107], v[36:39], v[128:131]
  v_mfma_f32_16x16x32_bf16 v[132:135], v[100:103], v[32:35], v[132:135]
  v_mfma_f32_16x16x32_bf16 v[132:135], v[108:111], v[36:39], v[132:135]
  v_mfma_f32_16x16x32_bf16 v[136:139], v[64:67], v[32:35], v[136:139]
  v_mfma_f32_16x16x32_bf16 v[136:139], v[68:71], v[36:39], v[136:139]
  s_branch L_kd_13
L_kv_12:
  v_mfma_f32_16x16x32_bf16 v[128:131], v[32:35], v[96:99], v[128:131]
  v_mfma_f32_16x16x32_bf16 v[128:131], v[36:39], v[104:107], v[128:131]
  v_mfma_f32_16x16x32_bf16 v[132:135], v[32:35], v[100:103], v[132:135]
  v_mfma_f32_16x16x32_bf16 v[132:135], v[36:39], v[108:111], v[132:135]
L_kd_13:
  s_add_u32 m0, s15, 73728
  s_nop 0
  buffer_load_dwordx4 v144, s[32:35], s82 offen offset:0 lds
  buffer_load_dwordx4 v145, s[32:35], s82 offen offset:1024 lds
  buffer_load_dwordx4 v146, s[32:35], s82 offen offset:2048 lds
  buffer_load_dwordx4 v147, s[32:35], s82 offen offset:3072 lds
  s_add_u32 s82, s82, 128
  s_waitcnt vmcnt(6)
  s_barrier
  v_add_u32 v16, s79, v15
  s_nop 5
  s_add_u32 m0, s80, 28672
  s_nop 0
  buffer_load_dwordx4 v3, s[36:39], s81 offen offset:0 lds
  ds_write_b128 v16, v[128:131] offset:0
  buffer_load_dwordx4 v4, s[36:39], s81 offen offset:1024 lds
  ds_write_b128 v16, v[132:135] offset:1024
  buffer_load_dwordx4 v5, s[36:39], s81 offen offset:2048 lds
  s_cmp_lg_u32 s77, 0
  s_cbranch_scc1 L_ko_14
  ds_write_b32 v16, v136 offset:2048
L_ko_14:
  buffer_load_dwordx4 v6, s[36:39], s81 offen offset:3072 lds
  s_add_u32 m0, s80, 32768
  s_nop 0
  buffer_load_dwordx4 v7, s[36:39], s81 offen offset:0 lds
  buffer_load_dwordx4 v8, s[36:39], s81 offen offset:1024 lds
  buffer_load_dwordx4 v9, s[36:39], s81 offen offset:2048 lds
  s_add_u32 s81, s81, 458752
  s_waitcnt lgkmcnt(0)
  s_waitcnt vmcnt(7)
  s_barrier
  s_add_u32 m0, s18, 57344
  s_nop 0
  buffer_load_dwordx4 v148, s[56:59], s14 offen offset:0 lds
  buffer_load_dwordx4 v149, s[56:59], s14 offen offset:1024 lds
  s_add_u32 s14, s14, 131072
  s_add_u32 m0, s15, 90112
  s_nop 0
  buffer_load_dwordx4 v144, s[32:35], s82 offen offset:0 lds
  buffer_load_dwordx4 v145, s[32:35], s82 offen offset:1024 lds
  buffer_load_dwordx4 v146, s[32:35], s82 offen offset:2048 lds
  buffer_load_dwordx4 v147, s[32:35], s82 offen offset:3072 lds
  s_add_u32 s82, s82, 128
  s_waitcnt vmcnt(6)
  s_barrier
  s_add_u32 m0, s80, 0
  s_nop 0
  buffer_load_dwordx4 v3, s[36:39], s81 offen offset:0 lds
  buffer_load_dwordx4 v4, s[36:39], s81 offen offset:1024 lds
  buffer_load_dwordx4 v5, s[36:39], s81 offen offset:2048 lds
  buffer_load_dwordx4 v6, s[36:39], s81 offen offset:3072 lds
  s_add_u32 m0, s80, 4096
  s_nop 0
  buffer_load_dwordx4 v7, s[36:39], s81 offen offset:0 lds
  buffer_load_dwordx4 v8, s[36:39], s81 offen offset:1024 lds
  buffer_load_dwordx4 v9, s[36:39], s81 offen offset:2048 lds
  s_add_u32 s81, s81, 458752
  s_waitcnt vmcnt(7)
  s_barrier
  s_add_u32 m0, s18, 65536
  s_nop 0
  buffer_load_dwordx4 v148, s[56:59], s14 offen offset:0 lds
  buffer_load_dwordx4 v149, s[56:59], s14 offen offset:1024 lds
  s_add_u32 s14, s14, 131072
  s_add_u32 m0, s15, 106496
  s_nop 0
  buffer_load_dwordx4 v144, s[32:35], s82 offen offset:0 lds
  buffer_load_dwordx4 v145, s[32:35], s82 offen offset:1024 lds
  buffer_load_dwordx4 v146, s[32:35], s82 offen offset:2048 lds
  buffer_load_dwordx4 v147, s[32:35], s82 offen offset:3072 lds
  s_add_u32 s82, s82, 128
  s_waitcnt vmcnt(6)
  s_barrier
  s_add_u32 m0, s80, 28672
  s_nop 0
  buffer_load_dwordx4 v3, s[36:39], s81 offen offset:0 lds
  buffer_load_dwordx4 v4, s[36:39], s81 offen offset:1024 lds
  buffer_load_dwordx4 v5, s[36:39], s81 offen offset:2048 lds
  buffer_load_dwordx4 v6, s[36:39], s81 offen offset:3072 lds
  s_add_u32 m0, s80, 32768
  s_nop 0
  buffer_load_dwordx4 v7, s[36:39], s81 offen offset:0 lds
  buffer_load_dwordx4 v8, s[36:39], s81 offen offset:1024 lds
  buffer_load_dwordx4 v9, s[36:39], s81 offen offset:2048 lds
  s_add_u32 s81, s81, 458752
  s_waitcnt vmcnt(7)
  s_barrier
  s_add_u32 m0, s18, 57344
  s_nop 0
  buffer_load_dwordx4 v148, s[56:59], s14 offen offset:0 lds
  buffer_load_dwordx4 v149, s[56:59], s14 offen offset:1024 lds
  s_add_u32 s14, s14, 131072
  s_add_u32 m0, s15, 73728
  s_nop 0
  buffer_load_dwordx4 v144, s[32:35], s82 offen offset:0 lds
  buffer_load_dwordx4 v145, s[32:35], s82 offen offset:1024 lds
  buffer_load_dwordx4 v146, s[32:35], s82 offen offset:2048 lds
  buffer_load_dwordx4 v147, s[32:35], s82 offen offset:3072 lds
  s_add_u32 s82, s82, 128
  s_waitcnt vmcnt(6)
  s_barrier
  s_add_u32 m0, s80, 0
  s_nop 0
  buffer_load_dwordx4 v3, s[36:39], s81 offen offset:0 lds
  buffer_load_dwordx4 v4, s[36:39], s81 offen offset:1024 lds
  buffer_load_dwordx4 v5, s[36:39], s81 offen offset:2048 lds
  buffer_load_dwordx4 v6, s[36:39], s81 offen offset:3072 lds
  s_setprio 0
  v_lshrrev_b32 v22, 3, v0
  v_lshlrev_b32 v22, 11, v22
  v_and_b32 v23, 1, v2
  v_lshlrev_b32 v23, 2, v23
  v_and_b32 v24, 7, v0
  v_xor_b32 v23, v23, v24
  v_lshl_add_u32 v22, v23, 4, v22
  s_lshl_b32 s70, s67, 7
  v_add_u32 v22, s70, v22
  v_xor_b32 v23, 0, v22
  v_add_u32 v244, 0, v23
  v_xor_b32 v23, 32, v22
  v_add_u32 v245, 15360, v23
  v_xor_b32 v23, 0, v22
  v_add_u32 v246, 30720, v23
  v_xor_b32 v23, 32, v22
  v_add_u32 v247, 46080, v23
  s_setprio 1
  s_add_u32 m0, s80, 4096
  s_nop 0
  buffer_load_dwordx4 v7, s[36:39], s81 offen offset:0 lds
  buffer_load_dwordx4 v8, s[36:39], s81 offen offset:1024 lds
  buffer_load_dwordx4 v9, s[36:39], s81 offen offset:2048 lds
  s_add_u32 s81, s81, 458752
  s_waitcnt vmcnt(7)
  s_barrier
  s_add_u32 m0, s18, 65536
  s_nop 0
  buffer_load_dwordx4 v148, s[56:59], s14 offen offset:0 lds
  buffer_load_dwordx4 v149, s[56:59], s14 offen offset:1024 lds
  s_add_u32 s14, s14, 131072
  s_setprio 0
  s_lshl_b32 s70, s69, 12
  s_add_u32 s71, s70, 73728
  v_lshl_add_u32 v30, v0, 4, s71
  v_add_u32 v248, 90112, v15
  v_mov_b32 v249, 155648
  v_and_b32 v22, 2, v1
  v_mov_b32 v23, 0x3f803f80
  v_cmp_eq_u32 vcc, 0, v22
  v_lshl_add_u32 v251, v0, 2, v249
  v_sub_u32 v252, 1, v0
  v_max_i32 v252, 0, v252
  v_cndmask_b32 v168, 0, v23, vcc
  v_cndmask_b32 v169, 0, v23, vcc
  v_xor_b32 v172, v168, v23
  v_xor_b32 v173, v168, v23
  v_mov_b64 v[170:171], v[168:169]
  v_mov_b64 v[174:175], v[172:173]
  v_and_b32 v22, 1, v1
  v_mul_u32_u24 v22, 0xaaaa, v22
  v_or_b32 v255, 0x4444, v22
  s_setprio 1
  s_add_u32 m0, s15, 90112
  s_nop 0
  buffer_load_dwordx4 v144, s[32:35], s82 offen offset:0 lds
  buffer_load_dwordx4 v145, s[32:35], s82 offen offset:1024 lds
  buffer_load_dwordx4 v146, s[32:35], s82 offen offset:2048 lds
  buffer_load_dwordx4 v147, s[32:35], s82 offen offset:3072 lds
  s_add_u32 s82, s82, 128
  s_waitcnt vmcnt(6)
  s_barrier
  s_add_u32 m0, s80, 28672
  s_nop 0
  buffer_load_dwordx4 v3, s[36:39], s81 offen offset:0 lds
  buffer_load_dwordx4 v4, s[36:39], s81 offen offset:1024 lds
  buffer_load_dwordx4 v5, s[36:39], s81 offen offset:2048 lds
  buffer_load_dwordx4 v6, s[36:39], s81 offen offset:3072 lds
  s_setprio 0
  v_and_b32 v22, 1, v2
  v_lshlrev_b32 v22, 9, v22
  v_lshrrev_b32 v23, 1, v2
  v_lshl_add_u32 v22, v23, 8, v22
  v_lshl_add_u32 v31, v1, 4, v22
  v_mov_b32 v240, v15
  v_mov_b32 v241, v15
  v_mov_b32 v242, v15
  v_mov_b32 v243, v15
  v_mov_b64 v[128:129], 0
  v_mov_b64 v[130:131], 0
  v_mov_b64 v[132:133], 0
  v_mov_b64 v[134:135], 0
  v_mov_b64 v[192:193], 0
  v_mov_b64 v[194:195], 0
  v_mov_b64 v[196:197], 0
  v_mov_b64 v[198:199], 0
  v_mov_b64 v[200:201], 0
  v_mov_b64 v[202:203], 0
  v_mov_b64 v[204:205], 0
  v_mov_b64 v[206:207], 0
  s_setprio 1
  s_add_u32 m0, s80, 32768
  s_nop 0
  buffer_load_dwordx4 v7, s[36:39], s81 offen offset:0 lds
  buffer_load_dwordx4 v8, s[36:39], s81 offen offset:1024 lds
  buffer_load_dwordx4 v9, s[36:39], s81 offen offset:2048 lds
  s_add_u32 s81, s81, 458752
  s_waitcnt vmcnt(7)
  s_barrier
  s_add_u32 m0, s18, 57344
  s_nop 0
  buffer_load_dwordx4 v148, s[56:59], s14 offen offset:0 lds
  buffer_load_dwordx4 v149, s[56:59], s14 offen offset:1024 lds
  s_add_u32 s14, s14, 131072
  s_setprio 0
  v_mov_b64 v[48:49], 0
  v_mov_b64 v[50:51], 0
  v_mov_b64 v[52:53], 0
  v_mov_b64 v[54:55], 0
  v_mov_b64 v[56:57], 0
  v_mov_b64 v[58:59], 0
  v_mov_b64 v[60:61], 0
  v_mov_b64 v[62:63], 0
  v_mov_b64 v[64:65], 0
  v_mov_b64 v[66:67], 0
  v_mov_b64 v[68:69], 0
  v_mov_b64 v[70:71], 0
  v_mov_b64 v[72:73], 0
  v_mov_b64 v[74:75], 0
  v_mov_b64 v[76:77], 0
  v_mov_b64 v[78:79], 0
  v_mov_b64 v[80:81], 0
  v_mov_b64 v[82:83], 0
  v_mov_b64 v[84:85], 0
  v_mov_b64 v[86:87], 0
  s_setprio 1
  s_add_u32 m0, s15, 106496
  s_nop 0
  buffer_load_dwordx4 v144, s[32:35], s82 offen offset:0 lds
  buffer_load_dwordx4 v145, s[32:35], s82 offen offset:1024 lds
  buffer_load_dwordx4 v146, s[32:35], s82 offen offset:2048 lds
  buffer_load_dwordx4 v147, s[32:35], s82 offen offset:3072 lds
  s_add_u32 s82, s82, 128
  s_waitcnt vmcnt(6)
  s_barrier
  s_add_u32 m0, s80, 0
  s_nop 0
  buffer_load_dwordx4 v3, s[36:39], s81 offen offset:0 lds
  buffer_load_dwordx4 v4, s[36:39], s81 offen offset:1024 lds
  buffer_load_dwordx4 v5, s[36:39], s81 offen offset:2048 lds
  buffer_load_dwordx4 v6, s[36:39], s81 offen offset:3072 lds
  s_add_u32 m0, s80, 4096
  s_nop 0
  buffer_load_dwordx4 v7, s[36:39], s81 offen offset:0 lds
  buffer_load_dwordx4 v8, s[36:39], s81 offen offset:1024 lds
  buffer_load_dwordx4 v9, s[36:39], s81 offen offset:2048 lds
  s_add_u32 s81, s81, 458752
  s_waitcnt vmcnt(7)
  s_barrier
  s_add_u32 m0, s18, 65536
  s_nop 0
  buffer_load_dwordx4 v148, s[56:59], s14 offen offset:0 lds
  buffer_load_dwordx4 v149, s[56:59], s14 offen offset:1024 lds
  s_add_u32 s14, s14, 131072
  s_add_u32 m0, s15, 73728
  s_nop 0
  buffer_load_dwordx4 v144, s[32:35], s82 offen offset:0 lds
  buffer_load_dwordx4 v145, s[32:35], s82 offen offset:1024 lds
  buffer_load_dwordx4 v146, s[32:35], s82 offen offset:2048 lds
  buffer_load_dwordx4 v147, s[32:35], s82 offen offset:3072 lds
  s_add_u32 s82, s82, 128
  s_waitcnt vmcnt(6)
  s_barrier
  s_add_u32 m0, s80, 28672
  s_nop 0
  buffer_load_dwordx4 v3, s[36:39], s81 offen offset:0 lds
  buffer_load_dwordx4 v4, s[36:39], s81 offen offset:1024 lds
  buffer_load_dwordx4 v5, s[36:39], s81 offen offset:2048 lds
  buffer_load_dwordx4 v6, s[36:39], s81 offen offset:3072 lds
  s_add_u32 m0, s80, 32768
  s_nop 0
  buffer_load_dwordx4 v7, s[36:39], s81 offen offset:0 lds
  buffer_load_dwordx4 v8, s[36:39], s81 offen offset:1024 lds
  buffer_load_dwordx4 v9, s[36:39], s81 offen offset:2048 lds
  s_add_u32 s81, s81, 458752
  s_lshl_b32 s71, s64, 9
  s_lshl_b32 s72, s69, 7
  s_add_u32 s71, s71, s72
  s_add_u32 s71, s71, 19136512
  v_lshlrev_b32 v22, 2, v1
  buffer_load_dword v253, v22, s[48:51], s71 offen offset:0 sc1
  buffer_load_dword v254, v22, s[48:51], s71 offen offset:64 sc1
  s_add_u32 s60, s30, 18874368
  s_addc_u32 s61, s31, 0
  s_mov_b32 s62, 0x40000
  s_mov_b32 s63, 0x20000
  s_lshl_b32 s76, s69, 12
  s_add_u32 m0, s76, 122880
  s_add_u32 s70, s76, 0
  buffer_load_dwordx4 v15, s[60:63], s70 offen offset:0 sc1 lds
  buffer_load_dwordx4 v15, s[60:63], s70 offen offset:1024 sc1 lds
  buffer_load_dwordx4 v15, s[60:63], s70 offen offset:2048 sc1 lds
  buffer_load_dwordx4 v15, s[60:63], s70 offen offset:3072 sc1 lds
  s_waitcnt vmcnt(13)
  s_branch L_a1done
L_a1m2:
  s_add_u32 m0, s80, 28672
  s_nop 0
  buffer_load_dwordx4 v3, s[36:39], s81 offen offset:0 lds
  buffer_load_dwordx4 v4, s[36:39], s81 offen offset:1024 lds
  buffer_load_dwordx4 v5, s[36:39], s81 offen offset:2048 lds
  buffer_load_dwordx4 v6, s[36:39], s81 offen offset:3072 lds
  s_lshl_b32 s79, s69, 13
  s_add_u32 s79, s79, 122880
  s_lshl_b32 s70, s69, 7
  v_lshl_add_u32 v17, v2, 4, s70
  v_add_u32 v12, 156160, v17
  v_lshrrev_b32 v16, 3, v0
  v_add_u32 v16, s78, v16
  v_and_b32 v17, 7, v0
  v_xor_b32 v17, v17, v2
  v_lshl_add_u32 v17, v17, 4, s70
  v_lshl_add_u32 v140, v16, 11, v17
  v_xor_b32 v16, 64, v140
  v_add_u32 v141, 15360, v16
  v_lshrrev_b32 v16, 1, v1
  v_xor_b32 v16, v16, v2
  v_lshlrev_b32 v16, 4, v16
  v_lshl_add_u32 v16, v1, 7, v16
  v_add_u32 v142, s79, v16
  v_xor_b32 v143, 64, v142
  v_lshrrev_b32 v16, 4, v0
  v_and_b32 v16, 2, v16
  v_xor_b32 v16, v16, v0
  s_lshl_b32 s70, s69, 12
  v_lshl_add_u32 v13, v16, 4, s70
  v_lshrrev_b32 v16, 2, v1
  v_lshl_add_u32 v16, v2, 3, v16
  v_and_b32 v17, 3, v1
  v_lshlrev_b32 v17, 3, v17
  v_lshl_add_u32 v16, v16, 6, v17
  v_and_b32 v17, 1, v2
  v_lshl_add_u32 v16, v17, 5, v16
  v_add_u32 v24, s79, v16
  v_xor_b32 v25, 32, v24
  v_mov_b32 v128, 0
  v_mov_b32 v129, 0
  v_mov_b32 v130, 0
  v_mov_b32 v131, 0
  v_mov_b32 v132, 0
  v_mov_b32 v133, 0
  v_mov_b32 v134, 0
  v_mov_b32 v135, 0
  v_mov_b32 v136, 0
  v_mov_b32 v137, 0
  v_mov_b32 v138, 0
  v_mov_b32 v139, 0
  s_add_u32 m0, s80, 32768
  s_nop 0
  buffer_load_dwordx4 v7, s[36:39], s81 offen offset:0 lds
  buffer_load_dwordx4 v8, s[36:39], s81 offen offset:1024 lds
  buffer_load_dwordx4 v9, s[36:39], s81 offen offset:2048 lds
  s_add_u32 s81, s81, 458752
  s_cmp_lg_u32 s83, 7
  s_cbranch_scc1 L_np_15
  s_mov_b32 exec_lo, 0x3fff3fff
  s_mov_b32 exec_hi, 0x3fff3fff
  buffer_load_dword v250, v152, s[36:39], s19 offen
  s_mov_b64 exec, 0xffff
  buffer_load_dword v250, v153, s[56:59], s22 offen
  s_mov_b64 exec, -1
  s_add_u32 s19, s19, 1835008
  s_add_u32 s22, s22, 524288
  buffer_load_dword v250, v150, s[32:35], s76 offen offset:512
  s_add_u32 s76, s76, 65536
  buffer_load_dword v250, v150, s[32:35], s76 offen offset:512
  s_add_u32 s76, s76, 65536
L_np_15:
  s_cmp_lg_u32 s83, 7
  s_cbranch_scc1 L_pw_17
  s_waitcnt vmcnt(11)
  s_branch L_pw_16
L_pw_17:
  s_waitcnt vmcnt(7)
L_pw_16:
  s_barrier
  s_add_u32 m0, s18, 57344
  s_nop 0
  buffer_load_dwordx4 v148, s[56:59], s14 offen offset:0 lds
  buffer_load_dwordx4 v149, s[56:59], s14 offen offset:1024 lds
  s_add_u32 s14, s14, 131072
  s_add_u32 m0, s15, 106496
  s_nop 0
  buffer_load_dwordx4 v144, s[32:35], s82 offen offset:0 lds
  buffer_load_dwordx4 v145, s[32:35], s82 offen offset:1024 lds
  buffer_load_dwordx4 v146, s[32:35], s82 offen offset:2048 lds
  buffer_load_dwordx4 v147, s[32:35], s82 offen offset:3072 lds
  s_add_u32 s82, s82, 128
  s_add_u32 m0, s79, 0
  s_mov_b32 s70, 0
  buffer_load_dwordx4 v13, s[40:43], s70 offen offset:0 lds
  buffer_load_dwordx4 v13, s[40:43], s70 offen offset:1024 lds
  s_cmp_lg_u32 s83, 0
  s_cbranch_scc1 L_np_18
  s_mov_b32 exec_lo, 0x3fff3fff
  s_mov_b32 exec_hi, 0x3fff3fff
  buffer_load_dword v250, v152, s[36:39], s19 offen
  s_mov_b64 exec, 0xffff
  buffer_load_dword v250, v153, s[56:59], s22 offen
  s_mov_b64 exec, -1
  s_add_u32 s19, s19, 1835008
  s_add_u32 s22, s22, 524288
  buffer_load_dword v250, v150, s[32:35], s76 offen offset:768
  s_add_u32 s76, s76, 65536
  buffer_load_dword v250, v150, s[32:35], s76 offen offset:768
  s_add_u32 s76, s76, 65536
L_np_18:
  s_cmp_lg_u32 s83, 0
  s_cbranch_scc1 L_pw_20
  s_waitcnt vmcnt(12)
  s_branch L_pw_19
L_pw_20:
  s_cmp_lg_u32 s83, 7
  s_cbranch_scc1 L_pw_21
  s_waitcnt vmcnt(12)
  s_branch L_pw_19
L_pw_21:
  s_waitcnt vmcnt(8)
L_pw_19:
  s_barrier
  s_add_u32 m0, s80, 0
  s_nop 0
  buffer_load_dwordx4 v3, s[36:39], s81 offen offset:0 lds
  buffer_load_dwordx4 v4, s[36:39], s81 offen offset:1024 lds
  buffer_load_dwordx4 v5, s[36:39], s81 offen offset:2048 lds
  buffer_load_dwordx4 v6, s[36:39], s81 offen offset:3072 lds
  s_add_u32 m0, s80, 4096
  s_nop 0
  buffer_load_dwordx4 v7, s[36:39], s81 offen offset:0 lds
  buffer_load_dwordx4 v8, s[36:39], s81 offen offset:1024 lds
  buffer_load_dwordx4 v9, s[36:39], s81 offen offset:2048 lds
  s_add_u32 s81, s81, 458752
  s_waitcnt lgkmcnt(0)
  s_add_u32 m0, s79, 4096
  s_mov_b32 s70, 2048
  buffer_load_dwordx4 v13, s[40:43], s70 offen offset:0 lds
  buffer_load_dwordx4 v13, s[40:43], s70 offen offset:1024 lds
  s_and_b32 s70, s2, 0xc1
  s_cbranch_scc1 L_noclr
  s_lshl_b32 s70, s2, 11
  s_add_u32 s70, s70, 19169280
  s_lshl_b32 s71, s2, 4
  s_add_u32 s71, s71, 19152896
  v_lshrrev_b32 v16, 1, v0
  v_and_b32 v17, 1, v0
  v_lshlrev_b32 v17, 4, v17
  v_lshl_add_u32 v16, v16, 7, v17
  buffer_store_dwordx4 v[128:131], v15, s[48:51], s70 offen offset:0 sc1
  buffer_store_dwordx4 v[128:131], v15, s[48:51], s70 offen offset:1024 sc1
  buffer_store_dwordx4 v[128:131], v15, s[48:51], s70 offen offset:2048 sc1
  buffer_store_dwordx4 v[128:131], v15, s[48:51], s70 offen offset:3072 sc1
  s_mov_b64 exec, 3
  buffer_store_dwordx4 v[128:131], v16, s[48:51], s71 offen sc1
  s_mov_b64 exec, -1
L_noclr:
  s_cmp_lg_u32 s83, 1
  s_cbranch_scc1 L_np_22
  s_mov_b32 exec_lo, 0x3fff3fff
  s_mov_b32 exec_hi, 0x3fff3fff
  buffer_load_dword v250, v152, s[36:39], s19 offen
  s_mov_b64 exec, 0xffff
  buffer_load_dword v250, v153, s[56:59], s22 offen
  s_mov_b64 exec, -1
  s_add_u32 s19, s19, 1835008
  s_add_u32 s22, s22, 524288
  buffer_load_dword v250, v150, s[32:35], s76 offen offset:1024
  s_add_u32 s76, s76, 65536
  buffer_load_dword v250, v150, s[32:35], s76 offen offset:1024
  s_add_u32 s76, s76, 65536
L_np_22:
  s_cmp_lg_u32 s83, 0
  s_cbranch_scc1 L_pw_24
  s_waitcnt vmcnt(15)
  s_branch L_pw_23
L_pw_24:
  s_cmp_lg_u32 s83, 1
  s_cbranch_scc1 L_pw_25
  s_waitcnt vmcnt(15)
  s_branch L_pw_23
L_pw_25:
  s_waitcnt vmcnt(11)
L_pw_23:
  s_barrier
  s_add_u32 m0, s18, 65536
  s_nop 0
  buffer_load_dwordx4 v148, s[56:59], s14 offen offset:0 lds
  buffer_load_dwordx4 v149, s[56:59], s14 offen offset:1024 lds
  s_add_u32 s14, s14, 131072
  s_add_u32 m0, s15, 73728
  s_nop 0
  buffer_load_dwordx4 v144, s[32:35], s82 offen offset:0 lds
  buffer_load_dwordx4 v145, s[32:35], s82 offen offset:1024 lds
  buffer_load_dwordx4 v146, s[32:35], s82 offen offset:2048 lds
  buffer_load_dwordx4 v147, s[32:35], s82 offen offset:3072 lds
  s_add_u32 s82, s82, 128
  s_add_u32 m0, s79, 6144
  s_movk_i32 s70, 0
  buffer_load_dwordx4 v140, s[32:35], s70 offen offset:0 lds
  buffer_load_dwordx4 v141, s[32:35], s70 offen offset:1024 lds
  s_cmp_lg_u32 s83, 2
  s_cbranch_scc1 L_np_26
  s_mov_b32 exec_lo, 0x3fff3fff
  s_mov_b32 exec_hi, 0x3fff3fff
  buffer_load_dword v250, v152, s[36:39], s19 offen
  s_mov_b64 exec, 0xffff
  buffer_load_dword v250, v153, s[56:59], s22 offen
  s_mov_b64 exec, -1
  s_add_u32 s19, s19, 1835008
  s_add_u32 s22, s22, 524288
  buffer_load_dword v250, v150, s[32:35], s76 offen offset:1280
  s_add_u32 s76, s76, 65536
  buffer_load_dword v250, v150, s[32:35], s76 offen offset:1280
  s_add_u32 s76, s76, 65536
L_np_26:
  s_cmp_lg_u32 s83, 1
  s_cbranch_scc1 L_pw_28
  s_waitcnt vmcnt(14)
  s_branch L_pw_27
L_pw_28:
  s_cmp_lg_u32 s83, 2
  s_cbranch_scc1 L_pw_29
  s_waitcnt vmcnt(14)
  s_branch L_pw_27
L_pw_29:
  s_waitcnt vmcnt(10)
L_pw_27:
  s_barrier
  s_add_u32 m0, s80, 28672
  s_nop 0
  buffer_load_dwordx4 v3, s[36:39], s81 offen offset:0 lds
  buffer_load_dwordx4 v4, s[36:39], s81 offen offset:1024 lds
  buffer_load_dwordx4 v5, s[36:39], s81 offen offset:2048 lds
  buffer_load_dwordx4 v6, s[36:39], s81 offen offset:3072 lds
  s_add_u32 m0, s80, 32768
  s_nop 0
  buffer_load_dwordx4 v7, s[36:39], s81 offen offset:0 lds
  buffer_load_dwordx4 v8, s[36:39], s81 offen offset:1024 lds
  buffer_load_dwordx4 v9, s[36:39], s81 offen offset:2048 lds
  s_add_u32 s81, s81, 458752
  s_add_u32 m0, s79, 2048
  s_mov_b32 s70, 16384
  buffer_load_dwordx4 v13, s[40:43], s70 offen offset:0 lds
  buffer_load_dwordx4 v13, s[40:43], s70 offen offset:1024 lds
  s_cmp_lg_u32 s83, 3
  s_cbranch_scc1 L_np_30
  s_mov_b32 exec_lo, 0x3fff3fff
  s_mov_b32 exec_hi, 0x3fff3fff
  buffer_load_dword v250, v152, s[36:39], s19 offen
  s_mov_b64 exec, 0xffff
  buffer_load_dword v250, v153, s[56:59], s22 offen
  s_mov_b64 exec, -1
  s_add_u32 s19, s19, 1835008
  s_add_u32 s22, s22, 524288
  buffer_load_dword v250, v150, s[32:35], s76 offen offset:1536
  s_add_u32 s76, s76, 65536
  buffer_load_dword v250, v150, s[32:35], s76 offen offset:1536
  s_add_u32 s76, s76, 65536
L_np_30:
  s_cmp_lg_u32 s83, 2
  s_cbranch_scc1 L_pw_32
  s_waitcnt vmcnt(15)
  s_branch L_pw_31
L_pw_32:
  s_cmp_lg_u32 s83, 3
  s_cbranch_scc1 L_pw_33
  s_waitcnt vmcnt(15)
  s_branch L_pw_31
L_pw_33:
  s_waitcnt vmcnt(11)
L_pw_31:
  s_barrier
  s_cmp_lg_u32 s83, 2
  s_cbranch_scc1 L_pw_35
  s_waitcnt vmcnt(13)
  s_branch L_pw_34
L_pw_35:
  s_cmp_lg_u32 s83, 3
  s_cbranch_scc1 L_pw_36
  s_waitcnt vmcnt(13)
  s_branch L_pw_34
L_pw_36:
  s_waitcnt vmcnt(9)
L_pw_34:
  s_add_u32 m0, s18, 57344
  s_nop 0
  buffer_load_dwordx4 v148, s[56:59], s14 offen offset:0 lds
  ds_read_b64_tr_b16 v[96:97], v24 offset:0
  ds_read_b64_tr_b16 v[98:99], v24 offset:256
  buffer_load_dwordx4 v149, s[56:59], s14 offen offset:1024 lds
  ds_read_b64_tr_b16 v[100:101], v25 offset:0
  ds_read_b64_tr_b16 v[102:103], v25 offset:256
  s_add_u32 s14, s14, 131072
  s_add_u32 m0, s15, 90112
  s_nop 0
  buffer_load_dwordx4 v144, s[32:35], s82 offen offset:0 lds
  ds_read_b64_tr_b16 v[104:105], v24 offset:4096
  ds_read_b64_tr_b16 v[106:107], v24 offset:4352
  buffer_load_dwordx4 v145, s[32:35], s82 offen offset:1024 lds
  ds_read_b64_tr_b16 v[108:109], v25 offset:4096
  ds_read_b64_tr_b16 v[110:111], v25 offset:4352
  buffer_load_dwordx4 v146, s[32:35], s82 offen offset:2048 lds
  ds_read_b128 v[32:35], v142 offset:6144
  ds_read_b128 v[36:39], v143 offset:6144
  buffer_load_dwordx4 v147, s[32:35], s82 offen offset:3072 lds
  s_cmp_lg_u32 s77, 0
  s_cbranch_scc1 L_ko_37
  ds_read_b128 v[64:67], v12 offset:0
  ds_read_b128 v[68:71], v12 offset:64
L_ko_37:
  s_add_u32 s82, s82, 128
  s_waitcnt lgkmcnt(0)
  s_add_u32 m0, s79, 4096
  s_mov_b32 s70, 18432
  buffer_load_dwordx4 v13, s[40:43], s70 offen offset:0 lds
  buffer_load_dwordx4 v13, s[40:43], s70 offen offset:1024 lds
  s_cmp_lg_u32 s83, 4
  s_cbranch_scc1 L_np_38
  s_mov_b32 exec_lo, 0x3fff3fff
  s_mov_b32 exec_hi, 0x3fff3fff
  buffer_load_dword v250, v152, s[36:39], s19 offen
  s_mov_b64 exec, 0xffff
  buffer_load_dword v250, v153, s[56:59], s22 offen
  s_mov_b64 exec, -1
  s_add_u32 s19, s19, 1835008
  s_add_u32 s22, s22, 524288
  buffer_load_dword v250, v150, s[32:35], s76 offen offset:1792
  s_add_u32 s76, s76, 65536
  buffer_load_dword v250, v150, s[32:35], s76 offen offset:1792
  s_add_u32 s76, s76, 65536
L_np_38:
  s_cmp_lg_u32 s83, 3
  s_cbranch_scc1 L_pw_40
  s_waitcnt vmcnt(14)
  s_branch L_pw_39
L_pw_40:
  s_cmp_lg_u32 s83, 4
  s_cbranch_scc1 L_pw_41
  s_waitcnt vmcnt(14)
  s_branch L_pw_39
L_pw_41:
  s_waitcnt vmcnt(10)
L_pw_39:
  s_barrier
  s_add_u32 m0, s80, 0
  s_nop 0
  buffer_load_dwordx4 v3, s[36:39], s81 offen offset:0 lds
  buffer_load_dwordx4 v4, s[36:39], s81 offen offset:1024 lds
  buffer_load_dwordx4 v5, s[36:39], s81 offen offset:2048 lds
  buffer_load_dwordx4 v6, s[36:39], s81 offen offset:3072 lds
  s_waitcnt lgkmcnt(0)
  s_cmp_lg_u32 s77, 0
  s_cbranch_scc1 L_kv_42
  v_mfma_f32_16x16x32_bf16 v[128:131], v[96:99], v[32:35], v[128:131]
  v_mfma_f32_16x16x32_bf16 v[128:131], v[104:107], v[36:39], v[128:131]
  v_mfma_f32_16x16x32_bf16 v[132:135], v[100:103], v[32:35], v[132:135]
  v_mfma_f32_16x16x32_bf16 v[132:135], v[108:111], v[36:39], v[132:135]
  v_mfma_f32_16x16x32_bf16 v[136:139], v[64:67], v[32:35], v[136:139]
  v_mfma_f32_16x16x32_bf16 v[136:139], v[68:71], v[36:39], v[136:139]
  s_branch L_kd_43
L_kv_42:
  v_mfma_f32_16x16x32_bf16 v[128:131], v[32:35], v[96:99], v[128:131]
  v_mfma_f32_16x16x32_bf16 v[128:131], v[36:39], v[104:107], v[128:131]
  v_mfma_f32_16x16x32_bf16 v[132:135], v[32:35], v[100:103], v[132:135]
  v_mfma_f32_16x16x32_bf16 v[132:135], v[36:39], v[108:111], v[132:135]
L_kd_43:
  s_add_u32 m0, s80, 4096
  s_nop 0
  buffer_load_dwordx4 v7, s[36:39], s81 offen offset:0 lds
  buffer_load_dwordx4 v8, s[36:39], s81 offen offset:1024 lds
  buffer_load_dwordx4 v9, s[36:39], s81 offen offset:2048 lds
  s_add_u32 s81, s81, 458752
  s_add_u32 m0, s79, 6144
  s_movk_i32 s70, 512
  buffer_load_dwordx4 v140, s[32:35], s70 offen offset:0 lds
  buffer_load_dwordx4 v141, s[32:35], s70 offen offset:1024 lds
  s_cmp_lg_u32 s83, 5
  s_cbranch_scc1 L_np_44
  s_mov_b32 exec_lo, 0x3fff3fff
  s_mov_b32 exec_hi, 0x3fff3fff
  buffer_load_dword v250, v152, s[36:39], s19 offen
  s_mov_b64 exec, 0xffff
  buffer_load_dword v250, v153, s[56:59], s22 offen
  s_mov_b64 exec, -1
  s_add_u32 s19, s19, 1835008
  s_add_u32 s22, s22, 524288
L_np_44:
  s_cmp_lg_u32 s83, 4
  s_cbranch_scc1 L_pw_46
  s_waitcnt vmcnt(15)
  s_branch L_pw_45
L_pw_46:
  s_cmp_lg_u32 s83, 5
  s_cbranch_scc1 L_pw_47
  s_waitcnt vmcnt(13)
  s_branch L_pw_45
L_pw_47:
  s_waitcnt vmcnt(11)
L_pw_45:
  s_barrier
  s_and_b32 s70, s2, 0xc1
  s_cbranch_scc1 L_noclr2
  s_waitcnt vmcnt(0)
  s_lshl_b32 s70, s2, 1
  v_mov_b32 v16, 1
  v_mov_b32 v17, 0
  s_mov_b64 exec, 1
  buffer_store_dword v16, v17, s[52:55], s70 offen sc1
  s_mov_b64 exec, -1
L_noclr2:
  s_add_u32 m0, s18, 65536
  s_nop 0
  buffer_load_dwordx4 v148, s[56:59], s14 offen offset:0 lds
  buffer_load_dwordx4 v149, s[56:59], s14 offen offset:1024 lds
  s_add_u32 s14, s14, 131072
  s_add_u32 m0, s15, 106496
  s_nop 0
  buffer_load_dwordx4 v144, s[32:35], s82 offen offset:0 lds
  buffer_load_dwordx4 v145, s[32:35], s82 offen offset:1024 lds
  buffer_load_dwordx4 v146, s[32:35], s82 offen offset:2048 lds
  buffer_load_dwordx4 v147, s[32:35], s82 offen offset:3072 lds
  s_add_u32 s82, s82, 128
  s_add_u32 m0, s79, 0
  s_mov_b32 s70, 32768
  buffer_load_dwordx4 v13, s[40:43], s70 offen offset:0 lds
  buffer_load_dwordx4 v13, s[40:43], s70 offen offset:1024 lds
  s_cmp_lg_u32 s83, 6
  s_cbranch_scc1 L_np_48
  s_mov_b32 exec_lo, 0x3fff3fff
  s_mov_b32 exec_hi, 0x3fff3fff
  buffer_load_dword v250, v152, s[36:39], s19 offen
  s_mov_b64 exec, 0xffff
  buffer_load_dword v250, v153, s[56:59], s22 offen
  s_mov_b64 exec, -1
  s_add_u32 s19, s19, 1835008
  s_add_u32 s22, s22, 524288
L_np_48:
  s_cmp_lg_u32 s83, 5
  s_cbranch_scc1 L_pw_50
  s_waitcnt vmcnt(12)
  s_branch L_pw_49
L_pw_50:
  s_cmp_lg_u32 s83, 6
  s_cbranch_scc1 L_pw_51
  s_waitcnt vmcnt(12)
  s_branch L_pw_49
L_pw_51:
  s_waitcnt vmcnt(10)
L_pw_49:
  s_barrier
  s_cmp_lg_u32 s83, 5
  s_cbranch_scc1 L_pw_53
  s_waitcnt vmcnt(10)
  s_branch L_pw_52
L_pw_53:
  s_cmp_lg_u32 s83, 6
  s_cbranch_scc1 L_pw_54
  s_waitcnt vmcnt(10)
  s_branch L_pw_52
L_pw_54:
  s_waitcnt vmcnt(8)
L_pw_52:
  s_add_u32 m0, s80, 28672
  s_nop 0
  buffer_load_dwordx4 v3, s[36:39], s81 offen offset:0 lds
  ds_read_b64_tr_b16 v[96:97], v24 offset:2048
  ds_read_b64_tr_b16 v[98:99], v24 offset:2304
  buffer_load_dwordx4 v4, s[36:39], s81 offen offset:1024 lds
  ds_read_b64_tr_b16 v[100:101], v25 offset:2048
  ds_read_b64_tr_b16 v[102:103], v25 offset:2304
  buffer_load_dwordx4 v5, s[36:39], s81 offen offset:2048 lds
  ds_read_b64_tr_b16 v[104:105], v24 offset:4096
  ds_read_b64_tr_b16 v[106:107], v24 offset:4352
  buffer_load_dwordx4 v6, s[36:39], s81 offen offset:3072 lds
  ds_read_b64_tr_b16 v[108:109], v25 offset:4096
  ds_read_b64_tr_b16 v[110:111], v25 offset:4352
  s_add_u32 m0, s80, 32768
  s_nop 0
  buffer_load_dwordx4 v7, s[36:39], s81 offen offset:0 lds
  ds_read_b128 v[32:35], v142 offset:6144
  ds_read_b128 v[36:39], v143 offset:6144
  buffer_load_dwordx4 v8, s[36:39], s81 offen offset:1024 lds
  s_cmp_lg_u32 s77, 0
  s_cbranch_scc1 L_ko_55
  ds_read_b128 v[64:67], v12 offset:512
  ds_read_b128 v[68:71], v12 offset:576
L_ko_55:
  buffer_load_dwordx4 v9, s[36:39], s81 offen offset:2048 lds
  s_add_u32 s81, s81, 458752
  s_waitcnt lgkmcnt(0)
  s_add_u32 m0, s79, 4096
  s_mov_b32 s70, 34816
  buffer_load_dwordx4 v13, s[40:43], s70 offen offset:0 lds
  buffer_load_dwordx4 v13, s[40:43], s70 offen offset:1024 lds
  s_cmp_lg_u32 s83, 7
  s_cbranch_scc1 L_np_56
  s_mov_b32 exec_lo, 0x3fff3fff
  s_mov_b32 exec_hi, 0x3fff3fff
  buffer_load_dword v250, v152, s[36:39], s19 offen
  s_mov_b64 exec, 0xffff
  buffer_load_dword v250, v153, s[56:59], s22 offen
  s_mov_b64 exec, -1
  s_add_u32 s19, s19, 1835008
  s_add_u32 s22, s22, 524288
L_np_56:
  s_cmp_lg_u32 s83, 6
  s_cbranch_scc1 L_pw_58
  s_waitcnt vmcnt(13)
  s_branch L_pw_57
L_pw_58:
  s_cmp_lg_u32 s83, 7
  s_cbranch_scc1 L_pw_59
  s_waitcnt vmcnt(13)
  s_branch L_pw_57
L_pw_59:
  s_waitcnt vmcnt(11)
L_pw_57:
  s_barrier
  s_add_u32 m0, s18, 57344
  s_nop 0
  buffer_load_dwordx4 v148, s[56:59], s14 offen offset:0 lds
  buffer_load_dwordx4 v149, s[56:59], s14 offen offset:1024 lds
  s_add_u32 s14, s14, 131072
  s_waitcnt lgkmcnt(0)
  s_cmp_lg_u32 s77, 0
  s_cbranch_scc1 L_kv_60
  v_mfma_f32_16x16x32_bf16 v[128:131], v[96:99], v[32:35], v[128:131]
  v_mfma_f32_16x16x32_bf16 v[128:131], v[104:107], v[36:39], v[128:131]
  v_mfma_f32_16x16x32_bf16 v[132:135], v[100:103], v[32:35], v[132:135]
  v_mfma_f32_16x16x32_bf16 v[132:135], v[108:111], v[36:39], v[132:135]
  v_mfma_f32_16x16x32_bf16 v[136:139], v[64:67], v[32:35], v[136:139]
  v_mfma_f32_16x16x32_bf16 v[136:139], v[68:71], v[36:39], v[136:139]
  s_branch L_kd_61
L_kv_60:
  v_mfma_f32_16x16x32_bf16 v[128:131], v[32:35], v[96:99], v[128:131]
  v_mfma_f32_16x16x32_bf16 v[128:131], v[36:39], v[104:107], v[128:131]
  v_mfma_f32_16x16x32_bf16 v[132:135], v[32:35], v[100:103], v[132:135]
  v_mfma_f32_16x16x32_bf16 v[132:135], v[36:39], v[108:111], v[132:135]
L_kd_61:
  s_add_u32 m0, s15, 73728
  s_nop 0
  buffer_load_dwordx4 v144, s[32:35], s82 offen offset:0 lds
  buffer_load_dwordx4 v145, s[32:35], s82 offen offset:1024 lds
  buffer_load_dwordx4 v146, s[32:35], s82 offen offset:2048 lds
  buffer_load_dwordx4 v147, s[32:35], s82 offen offset:3072 lds
  s_add_u32 s82, s82, 128
  s_add_u32 m0, s79, 6144
  s_movk_i32 s70, 1024
  buffer_load_dwordx4 v140, s[32:35], s70 offen offset:0 lds
  buffer_load_dwordx4 v141, s[32:35], s70 offen offset:1024 lds
  s_cmp_lg_u32 s83, 0
  s_cbranch_scc1 L_np_62
  s_mov_b32 exec_lo, 0x3fff3fff
  s_mov_b32 exec_hi, 0x3fff3fff
  buffer_load_dword v250, v152, s[36:39], s19 offen
  s_mov_b64 exec, 0xffff
  buffer_load_dword v250, v153, s[56:59], s22 offen
  s_mov_b64 exec, -1
  s_add_u32 s19, s19, 1835008
  s_add_u32 s22, s22, 524288
L_np_62:
  s_cmp_lg_u32 s83, 0
  s_cbranch_scc1 L_pw_64
  s_waitcnt vmcnt(12)
  s_branch L_pw_63
L_pw_64:
  s_cmp_lg_u32 s83, 7
  s_cbranch_scc1 L_pw_65
  s_waitcnt vmcnt(12)
  s_branch L_pw_63
L_pw_65:
  s_waitcnt vmcnt(10)
L_pw_63:
  s_barrier
  s_add_u32 m0, s80, 0
  s_nop 0
  buffer_load_dwordx4 v3, s[36:39], s81 offen offset:0 lds
  buffer_load_dwordx4 v4, s[36:39], s81 offen offset:1024 lds
  buffer_load_dwordx4 v5, s[36:39], s81 offen offset:2048 lds
  buffer_load_dwordx4 v6, s[36:39], s81 offen offset:3072 lds
  s_add_u32 m0, s80, 4096
  s_nop 0
  buffer_load_dwordx4 v7, s[36:39], s81 offen offset:0 lds
  buffer_load_dwordx4 v8, s[36:39], s81 offen offset:1024 lds
  buffer_load_dwordx4 v9, s[36:39], s81 offen offset:2048 lds
  s_add_u32 s81, s81, 458752
  s_add_u32 m0, s79, 2048
  s_mov_b32 s70, 49152
  buffer_load_dwordx4 v13, s[40:43], s70 offen offset:0 lds
  buffer_load_dwordx4 v13, s[40:43], s70 offen offset:1024 lds
  s_cmp_lg_u32 s83, 1
  s_cbranch_scc1 L_np_66
  s_mov_b32 exec_lo, 0x3fff3fff
  s_mov_b32 exec_hi, 0x3fff3fff
  buffer_load_dword v250, v152, s[36:39], s19 offen
  s_mov_b64 exec, 0xffff
  buffer_load_dword v250, v153, s[56:59], s22 offen
  s_mov_b64 exec, -1
  s_add_u32 s19, s19, 1835008
  s_add_u32 s22, s22, 524288
L_np_66:
  s_cmp_lg_u32 s83, 0
  s_cbranch_scc1 L_pw_68
  s_waitcnt vmcnt(13)
  s_branch L_pw_67
L_pw_68:
  s_cmp_lg_u32 s83, 1
  s_cbranch_scc1 L_pw_69
  s_waitcnt vmcnt(13)
  s_branch L_pw_67
L_pw_69:
  s_waitcnt vmcnt(11)
L_pw_67:
  s_barrier
  s_cmp_lg_u32 s83, 0
  s_cbranch_scc1 L_pw_71
  s_waitcnt vmcnt(11)
  s_branch L_pw_70
L_pw_71:
  s_cmp_lg_u32 s83, 1
  s_cbranch_scc1 L_pw_72
  s_waitcnt vmcnt(11)
  s_branch L_pw_70
L_pw_72:
  s_waitcnt vmcnt(9)
L_pw_70:
  s_add_u32 m0, s18, 65536
  s_nop 0
  buffer_load_dwordx4 v148, s[56:59], s14 offen offset:0 lds
  ds_read_b64_tr_b16 v[96:97], v24 offset:0
  ds_read_b64_tr_b16 v[98:99], v24 offset:256
  buffer_load_dwordx4 v149, s[56:59], s14 offen offset:1024 lds
  ds_read_b64_tr_b16 v[100:101], v25 offset:0
  ds_read_b64_tr_b16 v[102:103], v25 offset:256
  s_add_u32 s14, s14, 131072
  s_add_u32 m0, s15, 90112
  s_nop 0
  buffer_load_dwordx4 v144, s[32:35], s82 offen offset:0 lds
  ds_read_b64_tr_b16 v[104:105], v24 offset:4096
  ds_read_b64_tr_b16 v[106:107], v24 offset:4352
  buffer_load_dwordx4 v145, s[32:35], s82 offen offset:1024 lds
  ds_read_b64_tr_b16 v[108:109], v25 offset:4096
  ds_read_b64_tr_b16 v[110:111], v25 offset:4352
  buffer_load_dwordx4 v146, s[32:35], s82 offen offset:2048 lds
  ds_read_b128 v[32:35], v142 offset:6144
  ds_read_b128 v[36:39], v143 offset:6144
  buffer_load_dwordx4 v147, s[32:35], s82 offen offset:3072 lds
  s_cmp_lg_u32 s77, 0
  s_cbranch_scc1 L_ko_73
  ds_read_b128 v[64:67], v12 offset:1024
  ds_read_b128 v[68:71], v12 offset:1088
L_ko_73:
  s_add_u32 s82, s82, 128
  s_waitcnt lgkmcnt(0)
  s_add_u32 m0, s79, 4096
  s_mov_b32 s70, 51200
  buffer_load_dwordx4 v13, s[40:43], s70 offen offset:0 lds
  buffer_load_dwordx4 v13, s[40:43], s70 offen offset:1024 lds
  s_cmp_lg_u32 s83, 2
  s_cbranch_scc1 L_np_74
  s_mov_b32 exec_lo, 0x3fff3fff
  s_mov_b32 exec_hi, 0x3fff3fff
  buffer_load_dword v250, v152, s[36:39], s19 offen
  s_mov_b64 exec, 0xffff
  buffer_load_dword v250, v153, s[56:59], s22 offen
  s_mov_b64 exec, -1
  s_add_u32 s19, s19, 1835008
  s_add_u32 s22, s22, 524288
L_np_74:
  s_cmp_lg_u32 s83, 1
  s_cbranch_scc1 L_pw_76
  s_waitcnt vmcnt(12)
  s_branch L_pw_75
L_pw_76:
  s_cmp_lg_u32 s83, 2
  s_cbranch_scc1 L_pw_77
  s_waitcnt vmcnt(12)
  s_branch L_pw_75
L_pw_77:
  s_waitcnt vmcnt(10)
L_pw_75:
  s_barrier
  s_add_u32 m0, s80, 28672
  s_nop 0
  buffer_load_dwordx4 v3, s[36:39], s81 offen offset:0 lds
  buffer_load_dwordx4 v4, s[36:39], s81 offen offset:1024 lds
  buffer_load_dwordx4 v5, s[36:39], s81 offen offset:2048 lds
  buffer_load_dwordx4 v6, s[36:39], s81 offen offset:3072 lds
  s_waitcnt lgkmcnt(0)
  s_cmp_lg_u32 s77, 0
  s_cbranch_scc1 L_kv_78
  v_mfma_f32_16x16x32_bf16 v[128:131], v[96:99], v[32:35], v[128:131]
  v_mfma_f32_16x16x32_bf16 v[128:131], v[104:107], v[36:39], v[128:131]
  v_mfma_f32_16x16x32_bf16 v[132:135], v[100:103], v[32:35], v[132:135]
  v_mfma_f32_16x16x32_bf16 v[132:135], v[108:111], v[36:39], v[132:135]
  v_mfma_f32_16x16x32_bf16 v[136:139], v[64:67], v[32:35], v[136:139]
  v_mfma_f32_16x16x32_bf16 v[136:139], v[68:71], v[36:39], v[136:139]
  s_branch L_kd_79
L_kv_78:
  v_mfma_f32_16x16x32_bf16 v[128:131], v[32:35], v[96:99], v[128:131]
  v_mfma_f32_16x16x32_bf16 v[128:131], v[36:39], v[104:107], v[128:131]
  v_mfma_f32_16x16x32_bf16 v[132:135], v[32:35], v[100:103], v[132:135]
  v_mfma_f32_16x16x32_bf16 v[132:135], v[36:39], v[108:111], v[132:135]
L_kd_79:
  s_add_u32 m0, s80, 32768
  s_nop 0
  buffer_load_dwordx4 v7, s[36:39], s81 offen offset:0 lds
  buffer_load_dwordx4 v8, s[36:39], s81 offen offset:1024 lds
  buffer_load_dwordx4 v9, s[36:39], s81 offen offset:2048 lds
  s_add_u32 s81, s81, 458752
  s_add_u32 m0, s79, 6144
  s_movk_i32 s70, 1536
  buffer_load_dwordx4 v140, s[32:35], s70 offen offset:0 lds
  buffer_load_dwordx4 v141, s[32:35], s70 offen offset:1024 lds
  s_cmp_lg_u32 s83, 3
  s_cbranch_scc1 L_np_80
  s_mov_b32 exec_lo, 0x3fff3fff
  s_mov_b32 exec_hi, 0x3fff3fff
  buffer_load_dword v250, v152, s[36:39], s19 offen
  s_mov_b64 exec, 0xffff
  buffer_load_dword v250, v153, s[56:59], s22 offen
  s_mov_b64 exec, -1
  s_add_u32 s19, s19, 1835008
  s_add_u32 s22, s22, 524288
L_np_80:
  s_cmp_lg_u32 s83, 2
  s_cbranch_scc1 L_pw_82
  s_waitcnt vmcnt(13)
  s_branch L_pw_81
L_pw_82:
  s_cmp_lg_u32 s83, 3
  s_cbranch_scc1 L_pw_83
  s_waitcnt vmcnt(13)
  s_branch L_pw_81
L_pw_83:
  s_waitcnt vmcnt(11)
L_pw_81:
  s_barrier
  s_add_u32 m0, s18, 57344
  s_nop 0
  buffer_load_dwordx4 v148, s[56:59], s14 offen offset:0 lds
  buffer_load_dwordx4 v149, s[56:59], s14 offen offset:1024 lds
  s_add_u32 s14, s14, 131072
  s_add_u32 m0, s15, 106496
  s_nop 0
  buffer_load_dwordx4 v144, s[32:35], s82 offen offset:0 lds
  buffer_load_dwordx4 v145, s[32:35], s82 offen offset:1024 lds
  buffer_load_dwordx4 v146, s[32:35], s82 offen offset:2048 lds
  buffer_load_dwordx4 v147, s[32:35], s82 offen offset:3072 lds
  s_add_u32 s82, s82, 128
  s_cmp_lg_u32 s83, 4
  s_cbranch_scc1 L_np_84
  s_mov_b32 exec_lo, 0x3fff3fff
  s_mov_b32 exec_hi, 0x3fff3fff
  buffer_load_dword v250, v152, s[36:39], s19 offen
  s_mov_b64 exec, 0xffff
  buffer_load_dword v250, v153, s[56:59], s22 offen
  s_mov_b64 exec, -1
  s_add_u32 s19, s19, 1835008
  s_add_u32 s22, s22, 524288
L_np_84:
  s_cmp_lg_u32 s83, 3
  s_cbranch_scc1 L_pw_86
  s_waitcnt vmcnt(10)
  s_branch L_pw_85
L_pw_86:
  s_cmp_lg_u32 s83, 4
  s_cbranch_scc1 L_pw_87
  s_waitcnt vmcnt(10)
  s_branch L_pw_85
L_pw_87:
  s_waitcnt vmcnt(8)
L_pw_85:
  s_barrier
  s_cmp_lg_u32 s83, 3
  s_cbranch_scc1 L_pw_89
  s_waitcnt vmcnt(8)
  s_branch L_pw_88
L_pw_89:
  s_cmp_lg_u32 s83, 4
  s_cbranch_scc1 L_pw_90
  s_waitcnt vmcnt(8)
  s_branch L_pw_88
L_pw_90:
  s_waitcnt vmcnt(6)
L_pw_88:
  s_add_u32 m0, s80, 0
  s_nop 0
  buffer_load_dwordx4 v3, s[36:39], s81 offen offset:0 lds
  ds_read_b64_tr_b16 v[96:97], v24 offset:2048
  ds_read_b64_tr_b16 v[98:99], v24 offset:2304
  buffer_load_dwordx4 v4, s[36:39], s81 offen offset:1024 lds
  ds_read_b64_tr_b16 v[100:101], v25 offset:2048
  ds_read_b64_tr_b16 v[102:103], v25 offset:2304
  buffer_load_dwordx4 v5, s[36:39], s81 offen offset:2048 lds
  ds_read_b64_tr_b16 v[104:105], v24 offset:4096
  ds_read_b64_tr_b16 v[106:107], v24 offset:4352
  buffer_load_dwordx4 v6, s[36:39], s81 offen offset:3072 lds
  ds_read_b64_tr_b16 v[108:109], v25 offset:4096
  ds_read_b64_tr_b16 v[110:111], v25 offset:4352
  s_add_u32 m0, s80, 4096
  s_nop 0
  buffer_load_dwordx4 v7, s[36:39], s81 offen offset:0 lds
  ds_read_b128 v[32:35], v142 offset:6144
  ds_read_b128 v[36:39], v143 offset:6144
  buffer_load_dwordx4 v8, s[36:39], s81 offen offset:1024 lds
  s_cmp_lg_u32 s77, 0
  s_cbranch_scc1 L_ko_91
  ds_read_b128 v[64:67], v12 offset:1536
  ds_read_b128 v[68:71], v12 offset:1600
L_ko_91:
  buffer_load_dwordx4 v9, s[36:39], s81 offen offset:2048 lds
  s_add_u32 s81, s81, 458752
  s_cmp_lg_u32 s83, 5
  s_cbranch_scc1 L_np_92
  s_mov_b32 exec_lo, 0x3fff3fff
  s_mov_b32 exec_hi, 0x3fff3fff
  buffer_load_dword v250, v152, s[36:39], s19 offen
  s_mov_b64 exec, 0xffff
  buffer_load_dword v250, v153, s[56:59], s22 offen
  s_mov_b64 exec, -1
  s_add_u32 s19, s19, 1835008
  s_add_u32 s22, s22, 524288
L_np_92:
  s_cmp_lg_u32 s83, 4
  s_cbranch_scc1 L_pw_94
  s_waitcnt vmcnt(9)
  s_branch L_pw_93
L_pw_94:
  s_cmp_lg_u32 s83, 5
  s_cbranch_scc1 L_pw_95
  s_waitcnt vmcnt(9)
  s_branch L_pw_93
L_pw_95:
  s_waitcnt vmcnt(7)
L_pw_93:
  s_barrier
  s_add_u32 m0, s18, 65536
  s_nop 0
  buffer_load_dwordx4 v148, s[56:59], s14 offen offset:0 lds
  buffer_load_dwordx4 v149, s[56:59], s14 offen offset:1024 lds
  s_add_u32 s14, s14, 131072
  s_waitcnt lgkmcnt(0)
  s_cmp_lg_u32 s77, 0
  s_cbranch_scc1 L_kv_96
  v_mfma_f32_16x16x32_bf16 v[128:131], v[96:99], v[32:35], v[128:131]
  v_mfma_f32_16x16x32_bf16 v[128:131], v[104:107], v[36:39], v[128:131]
  v_mfma_f32_16x16x32_bf16 v[132:135], v[100:103], v[32:35], v[132:135]
  v_mfma_f32_16x16x32_bf16 v[132:135], v[108:111], v[36:39], v[132:135]
  v_mfma_f32_16x16x32_bf16 v[136:139], v[64:67], v[32:35], v[136:139]
  v_mfma_f32_16x16x32_bf16 v[136:139], v[68:71], v[36:39], v[136:139]
  s_branch L_kd_97
L_kv_96:
  v_mfma_f32_16x16x32_bf16 v[128:131], v[32:35], v[96:99], v[128:131]
  v_mfma_f32_16x16x32_bf16 v[128:131], v[36:39], v[104:107], v[128:131]
  v_mfma_f32_16x16x32_bf16 v[132:135], v[32:35], v[100:103], v[132:135]
  v_mfma_f32_16x16x32_bf16 v[132:135], v[36:39], v[108:111], v[132:135]
L_kd_97:
  s_add_u32 m0, s15, 73728
  s_nop 0
  buffer_load_dwordx4 v144, s[32:35], s82 offen offset:0 lds
  buffer_load_dwordx4 v145, s[32:35], s82 offen offset:1024 lds
  buffer_load_dwordx4 v146, s[32:35], s82 offen offset:2048 lds
  buffer_load_dwordx4 v147, s[32:35], s82 offen offset:3072 lds
  s_add_u32 s82, s82, 128
  s_cmp_lg_u32 s83, 6
  s_cbranch_scc1 L_np_98
  s_mov_b32 exec_lo, 0x3fff3fff
  s_mov_b32 exec_hi, 0x3fff3fff
  buffer_load_dword v250, v152, s[36:39], s19 offen
  s_mov_b64 exec, 0xffff
  buffer_load_dword v250, v153, s[56:59], s22 offen
  s_mov_b64 exec, -1
  s_add_u32 s19, s19, 1835008
  s_add_u32 s22, s22, 524288
L_np_98:
  s_cmp_lg_u32 s83, 5
  s_cbranch_scc1 L_pw_100
  s_waitcnt vmcnt(8)
  s_branch L_pw_99
L_pw_100:
  s_cmp_lg_u32 s83, 6
  s_cbranch_scc1 L_pw_101
  s_waitcnt vmcnt(8)
  s_branch L_pw_99
L_pw_101:
  s_waitcnt vmcnt(6)
L_pw_99:
  s_barrier
  s_add_u32 m0, s80, 28672
  s_nop 0
  buffer_load_dwordx4 v3, s[36:39], s81 offen offset:0 lds
  buffer_load_dwordx4 v4, s[36:39], s81 offen offset:1024 lds
  buffer_load_dwordx4 v5, s[36:39], s81 offen offset:2048 lds
  buffer_load_dwordx4 v6, s[36:39], s81 offen offset:3072 lds
  s_add_u32 m0, s80, 32768
  s_nop 0
  buffer_load_dwordx4 v7, s[36:39], s81 offen offset:0 lds
  buffer_load_dwordx4 v8, s[36:39], s81 offen offset:1024 lds
  buffer_load_dwordx4 v9, s[36:39], s81 offen offset:2048 lds
  s_add_u32 s81, s81, 458752
  s_setprio 0
  v_bfe_u32 v16, v1, 2, 1
  v_lshlrev_b32 v16, 10, v16
  v_lshl_add_u32 v16, v2, 8, v16
  v_lshrrev_b32 v17, 3, v1
  v_lshl_add_u32 v16, v17, 6, v16
  v_and_b32 v17, 3, v1
  v_lshl_add_u32 v27, v17, 4, v16
  s_cmp_eq_u32 s77, 0
  s_cbranch_scc1 L_kadr
  v_and_b32 v16, 1, v2
  v_lshlrev_b32 v16, 10, v16
  v_lshrrev_b32 v17, 1, v2
  v_lshl_add_u32 v16, v17, 8, v16
  v_lshl_add_u32 v27, v1, 4, v16
L_kadr:
  s_setprio 1
  s_cmp_lg_u32 s83, 7
  s_cbranch_scc1 L_np_102
  s_mov_b32 exec_lo, 0x3fff3fff
  s_mov_b32 exec_hi, 0x3fff3fff
  buffer_load_dword v250, v152, s[36:39], s19 offen
  s_mov_b64 exec, 0xffff
  buffer_load_dword v250, v153, s[56:59], s22 offen
  s_mov_b64 exec, -1
  s_add_u32 s19, s19, 1835008
  s_add_u32 s22, s22, 524288
  s_mov_b32 s44, s20
  s_mov_b32 s45, s21
  s_mov_b32 s46, 7340032
  s_mov_b32 s47, 0x20000
  s_bfe_u32 s70, s2, 0x10002
  s_lshl_b32 s70, s70, 5
  s_add_u32 s71, s70, s68
  s_lshr_b32 s70, s71, 4
  s_mul_i32 s70, s70, 1835008
  s_and_b32 s71, s71, 15
  s_lshl_b32 s71, s71, 15
  s_add_u32 s70, s70, s71
  s_and_b32 s71, s67, 3
  s_lshl_b32 s71, s71, 7
  s_add_u32 s70, s70, s71
  v_lshlrev_b32 v151, 9, v0
  buffer_load_dword v250, v151, s[44:47], s70 offen
L_np_102:
  s_cmp_lg_u32 s83, 6
  s_cbranch_scc1 L_pw_104
  s_waitcnt vmcnt(9)
  s_branch L_pw_103
L_pw_104:
  s_cmp_lg_u32 s83, 7
  s_cbranch_scc1 L_pw_105
  s_waitcnt vmcnt(10)
  s_branch L_pw_103
L_pw_105:
  s_waitcnt vmcnt(7)
L_pw_103:
  s_barrier
  v_add_u32 v26, 122880, v15
  ds_read_b128 v[32:35], v26 offset:0
  ds_read_b128 v[36:39], v26 offset:1024
  ds_read_b128 v[40:43], v26 offset:8192
  ds_read_b128 v[44:47], v26 offset:9216
  ds_read_b128 v[48:51], v26 offset:16384
  ds_read_b128 v[52:55], v26 offset:17408
  s_lshr_b32 s73, s78, 5
  s_lshl_b32 s73, s73, 12
  s_add_u32 s73, s73, 18874368
  s_bfe_u32 s74, s78, 0x10004
  s_cmp_eq_u32 s77, 0
  s_cselect_b32 s70, 1048744942, 1.0
  s_cselect_b32 s72, 7, 9
  s_cselect_b32 s75, 0, 2048
  s_lshl_b32 s74, s74, s72
  s_add_u32 s73, s73, s74
  s_add_u32 s73, s73, s75
  s_waitcnt lgkmcnt(0)
  v_add_f32 v32, v32, v40
  v_add_f32 v48, v48, v128
  v_add_f32 v32, v32, v48
  v_mul_f32 v32, s70, v32
  v_add_f32 v33, v33, v41
  v_add_f32 v49, v49, v129
  v_add_f32 v33, v33, v49
  v_mul_f32 v33, s70, v33
  v_add_f32 v34, v34, v42
  v_add_f32 v50, v50, v130
  v_add_f32 v34, v34, v50
  v_mul_f32 v34, s70, v34
  v_add_f32 v35, v35, v43
  v_add_f32 v51, v51, v131
  v_add_f32 v35, v35, v51
  v_mul_f32 v35, s70, v35
  v_add_f32 v36, v36, v44
  v_add_f32 v52, v52, v132
  v_add_f32 v36, v36, v52
  v_mul_f32 v36, s70, v36
  v_add_f32 v37, v37, v45
  v_add_f32 v53, v53, v133
  v_add_f32 v37, v37, v53
  v_mul_f32 v37, s70, v37
  v_add_f32 v38, v38, v46
  v_add_f32 v54, v54, v134
  v_add_f32 v38, v38, v54
  v_mul_f32 v38, s70, v38
  v_add_f32 v39, v39, v47
  v_add_f32 v55, v55, v135
  v_add_f32 v39, v39, v55
  v_mul_f32 v39, s70, v39
  v_cvt_pk_bf16_f32 v40, v32, v33
  v_cvt_pk_bf16_f32 v41, v34, v35
  v_cvt_pk_bf16_f32 v42, v36, v37
  v_cvt_pk_bf16_f32 v43, v38, v39
  s_cmp_eq_u32 s77, 0
  s_cbranch_scc1 L_nosw
  v_permlane16_swap_b32 v40, v42
  v_permlane16_swap_b32 v41, v43
L_nosw:
  buffer_store_dwordx4 v[40:43], v27, s[48:51], s73 offen sc1
  s_add_u32 m0, s18, 57344
  s_nop 0
  buffer_load_dwordx4 v148, s[56:59], s14 offen offset:0 lds
  buffer_load_dwordx4 v149, s[56:59], s14 offen offset:1024 lds
  s_add_u32 s14, s14, 131072
  s_add_u32 m0, s15, 90112
  s_nop 0
  buffer_load_dwordx4 v144, s[32:35], s82 offen offset:0 lds
  buffer_load_dwordx4 v145, s[32:35], s82 offen offset:1024 lds
  buffer_load_dwordx4 v146, s[32:35], s82 offen offset:2048 lds
  buffer_load_dwordx4 v147, s[32:35], s82 offen offset:3072 lds
  s_add_u32 s82, s82, 128
  s_cmp_lg_u32 s83, 0
  s_cbranch_scc1 L_np_106
  s_mov_b32 exec_lo, 0x3fff3fff
  s_mov_b32 exec_hi, 0x3fff3fff
  buffer_load_dword v250, v152, s[36:39], s19 offen
  s_mov_b64 exec, 0xffff
  buffer_load_dword v250, v153, s[56:59], s22 offen
  s_mov_b64 exec, -1
  s_add_u32 s19, s19, 1835008
  s_add_u32 s22, s22, 524288
  s_mov_b32 s44, s20
  s_mov_b32 s45, s21
  s_mov_b32 s46, 7340032
  s_mov_b32 s47, 0x20000
  s_bfe_u32 s70, s2, 0x10002
  s_lshl_b32 s70, s70, 5
  s_add_u32 s71, s70, s68
  s_lshr_b32 s70, s71, 4
  s_mul_i32 s70, s70, 1835008
  s_and_b32 s71, s71, 15
  s_lshl_b32 s71, s71, 15
  s_add_u32 s70, s70, s71
  s_and_b32 s71, s67, 3
  s_lshl_b32 s71, s71, 7
  s_add_u32 s70, s70, s71
  v_lshlrev_b32 v151, 9, v0
  buffer_load_dword v250, v151, s[44:47], s70 offen
L_np_106:
  s_cmp_lg_u32 s83, 0
  s_cbranch_scc1 L_pw_108
  s_waitcnt vmcnt(10)
  s_branch L_pw_107
L_pw_108:
  s_cmp_lg_u32 s83, 7
  s_cbranch_scc1 L_pw_109
  s_waitcnt vmcnt(10)
  s_branch L_pw_107
L_pw_109:
  s_waitcnt vmcnt(7)
L_pw_107:
  s_barrier
  v_and_b32 v19, 31, v0
  v_lshlrev_b32 v19, 2, v19
  buffer_load_dword v18, v19, s[52:55], 0 offen sc1
  s_add_u32 m0, s80, 0
  s_nop 0
  buffer_load_dwordx4 v3, s[36:39], s81 offen offset:0 lds
  buffer_load_dwordx4 v4, s[36:39], s81 offen offset:1024 lds
  buffer_load_dwordx4 v5, s[36:39], s81 offen offset:2048 lds
  buffer_load_dwordx4 v6, s[36:39], s81 offen offset:3072 lds
  s_mov_b32 s70, 1073741824
  v_lshlrev_b32 v20, 2, v0
  s_cmp_lg_u32 s77, 0
  s_cbranch_scc1 L_nogate
  ds_read_b32 v64, v26 offset:2048
  ds_read_b32 v65, v26 offset:10240
  ds_read_b32 v66, v26 offset:18432
  s_lshl_b32 s70, s78, 2
  s_add_u32 s70, s70, 19136512
  s_waitcnt lgkmcnt(0)
  v_add_f32 v64, v64, v65
  v_add_f32 v66, v66, v136
  v_add_f32 v64, v64, v66
  v_mul_f32 v64, 3216550459, v64
  v_exp_f32 v64, v64
  s_nop 0
  v_add_f32 v64, 1.0, v64
  v_rcp_f32 v64, v64
L_nogate:
  s_mov_b64 exec, 0xffff
  buffer_store_dword v64, v20, s[48:51], s70 offen sc1
  s_mov_b64 exec, -1
  s_add_u32 m0, s80, 4096
  s_nop 0
  buffer_load_dwordx4 v7, s[36:39], s81 offen offset:0 lds
  buffer_load_dwordx4 v8, s[36:39], s81 offen offset:1024 lds
  buffer_load_dwordx4 v9, s[36:39], s81 offen offset:2048 lds
  s_add_u32 s81, s81, 458752
  s_cmp_lg_u32 s83, 1
  s_cbranch_scc1 L_np_110
  s_mov_b32 exec_lo, 0x3fff3fff
  s_mov_b32 exec_hi, 0x3fff3fff
  buffer_load_dword v250, v152, s[36:39], s19 offen
  s_mov_b64 exec, 0xffff
  buffer_load_dword v250, v153, s[56:59], s22 offen
  s_mov_b64 exec, -1
  s_add_u32 s19, s19, 1835008
  s_add_u32 s22, s22, 524288
  s_mov_b32 s44, s20
  s_mov_b32 s45, s21
  s_mov_b32 s46, 7340032
  s_mov_b32 s47, 0x20000
  s_bfe_u32 s70, s2, 0x10002
  s_lshl_b32 s70, s70, 5
  s_add_u32 s71, s70, s68
  s_lshr_b32 s70, s71, 4
  s_mul_i32 s70, s70, 1835008
  s_and_b32 s71, s71, 15
  s_lshl_b32 s71, s71, 15
  s_add_u32 s70, s70, s71
  s_and_b32 s71, s67, 3
  s_lshl_b32 s71, s71, 7
  s_add_u32 s70, s70, s71
  v_lshlrev_b32 v151, 9, v0
  buffer_load_dword v250, v151, s[44:47], s70 offen
L_np_110:
  s_cmp_lg_u32 s83, 0
  s_cbranch_scc1 L_pw_112
  s_waitcnt vmcnt(12)
  s_branch L_pw_111
L_pw_112:
  s_cmp_lg_u32 s83, 1
  s_cbranch_scc1 L_pw_113
  s_waitcnt vmcnt(12)
  s_branch L_pw_111
L_pw_113:
  s_waitcnt vmcnt(9)
L_pw_111:
  s_barrier
  s_add_u32 m0, s18, 65536
  s_nop 0
  buffer_load_dwordx4 v148, s[56:59], s14 offen offset:0 lds
  buffer_load_dwordx4 v149, s[56:59], s14 offen offset:1024 lds
  s_add_u32 s14, s14, 131072
  s_add_u32 m0, s15, 106496
  s_nop 0
  buffer_load_dwordx4 v144, s[32:35], s82 offen offset:0 lds
  buffer_load_dwordx4 v145, s[32:35], s82 offen offset:1024 lds
  buffer_load_dwordx4 v146, s[32:35], s82 offen offset:2048 lds
  buffer_load_dwordx4 v147, s[32:35], s82 offen offset:3072 lds
  s_add_u32 s82, s82, 128
  s_cmp_lg_u32 s83, 2
  s_cbranch_scc1 L_np_114
  s_mov_b32 exec_lo, 0x3fff3fff
  s_mov_b32 exec_hi, 0x3fff3fff
  buffer_load_dword v250, v152, s[36:39], s19 offen
  s_mov_b64 exec, 0xffff
  buffer_load_dword v250, v153, s[56:59], s22 offen
  s_mov_b64 exec, -1
  s_add_u32 s19, s19, 1835008
  s_add_u32 s22, s22, 524288
  s_mov_b32 s44, s20
  s_mov_b32 s45, s21
  s_mov_b32 s46, 7340032
  s_mov_b32 s47, 0x20000
  s_bfe_u32 s70, s2, 0x10002
  s_lshl_b32 s70, s70, 5
  s_add_u32 s71, s70, s68
  s_lshr_b32 s70, s71, 4
  s_mul_i32 s70, s70, 1835008
  s_and_b32 s71, s71, 15
  s_lshl_b32 s71, s71, 15
  s_add_u32 s70, s70, s71
  s_and_b32 s71, s67, 3
  s_lshl_b32 s71, s71, 7
  s_add_u32 s70, s70, s71
  v_lshlrev_b32 v151, 9, v0
  buffer_load_dword v250, v151, s[44:47], s70 offen
L_np_114:
  s_cmp_lg_u32 s83, 1
  s_cbranch_scc1 L_pw_116
  s_waitcnt vmcnt(9)
  s_branch L_pw_115
L_pw_116:
  s_cmp_lg_u32 s83, 2
  s_cbranch_scc1 L_pw_117
  s_waitcnt vmcnt(9)
  s_branch L_pw_115
L_pw_117:
  s_waitcnt vmcnt(6)
L_pw_115:
  s_barrier
  s_add_u32 m0, s80, 28672
  s_nop 0
  buffer_load_dwordx4 v3, s[36:39], s81 offen offset:0 lds
  buffer_load_dwordx4 v4, s[36:39], s81 offen offset:1024 lds
  buffer_load_dwordx4 v5, s[36:39], s81 offen offset:2048 lds
  buffer_load_dwordx4 v6, s[36:39], s81 offen offset:3072 lds
  s_mov_b32 s71, 262144
L_poll0:
  v_cmp_ne_u32 vcc, 1, v18
  s_sub_u32 s71, s71, 1
  s_cbranch_vccz L_poll0x
  s_sleep 16
  buffer_load_dword v18, v19, s[52:55], 0 offen sc1
  s_waitcnt vmcnt(0)
  s_cmp_lg_u32 s71, 0
  s_cbranch_scc1 L_poll0
L_poll0x:
  s_lshl_b32 s70, s64, 4
  s_add_u32 s70, s70, s65
  s_lshl_b32 s70, s70, 2
  s_add_u32 s70, s70, 19152896
  v_mov_b32 v16, 1
  v_mov_b32 v17, 0
  s_mov_b64 exec, 1
  buffer_store_dword v16, v17, s[48:51], s70 offen sc1
  s_mov_b64 exec, -1
  s_add_u32 m0, s80, 32768
  s_nop 0
  buffer_load_dwordx4 v7, s[36:39], s81 offen offset:0 lds
  buffer_load_dwordx4 v8, s[36:39], s81 offen offset:1024 lds
  buffer_load_dwordx4 v9, s[36:39], s81 offen offset:2048 lds
  s_add_u32 s81, s81, 458752
  s_cmp_lg_u32 s83, 3
  s_cbranch_scc1 L_np_118
  s_mov_b32 exec_lo, 0x3fff3fff
  s_mov_b32 exec_hi, 0x3fff3fff
  buffer_load_dword v250, v152, s[36:39], s19 offen
  s_mov_b64 exec, 0xffff
  buffer_load_dword v250, v153, s[56:59], s22 offen
  s_mov_b64 exec, -1
  s_add_u32 s19, s19, 1835008
  s_add_u32 s22, s22, 524288
  s_mov_b32 s44, s20
  s_mov_b32 s45, s21
  s_mov_b32 s46, 7340032
  s_mov_b32 s47, 0x20000
  s_bfe_u32 s70, s2, 0x10002
  s_lshl_b32 s70, s70, 5
  s_add_u32 s71, s70, s68
  s_lshr_b32 s70, s71, 4
  s_mul_i32 s70, s70, 1835008
  s_and_b32 s71, s71, 15
  s_lshl_b32 s71, s71, 15
  s_add_u32 s70, s70, s71
  s_and_b32 s71, s67, 3
  s_lshl_b32 s71, s71, 7
  s_add_u32 s70, s70, s71
  v_lshlrev_b32 v151, 9, v0
  buffer_load_dword v250, v151, s[44:47], s70 offen
L_np_118:
  s_cmp_lg_u32 s83, 2
  s_cbranch_scc1 L_pw_120
  s_waitcnt vmcnt(11)
  s_branch L_pw_119
L_pw_120:
  s_cmp_lg_u32 s83, 3
  s_cbranch_scc1 L_pw_121
  s_waitcnt vmcnt(11)
  s_branch L_pw_119
L_pw_121:
  s_waitcnt vmcnt(8)
L_pw_119:
  s_barrier
  s_add_u32 m0, s18, 57344
  s_nop 0
  buffer_load_dwordx4 v148, s[56:59], s14 offen offset:0 lds
  buffer_load_dwordx4 v149, s[56:59], s14 offen offset:1024 lds
  s_add_u32 s14, s14, 131072
  s_add_u32 m0, s15, 73728
  s_nop 0
  buffer_load_dwordx4 v144, s[32:35], s82 offen offset:0 lds
  buffer_load_dwordx4 v145, s[32:35], s82 offen offset:1024 lds
  buffer_load_dwordx4 v146, s[32:35], s82 offen offset:2048 lds
  buffer_load_dwordx4 v147, s[32:35], s82 offen offset:3072 lds
  s_add_u32 s82, s82, 128
  s_cmp_lg_u32 s83, 4
  s_cbranch_scc1 L_np_122
  s_mov_b32 exec_lo, 0x3fff3fff
  s_mov_b32 exec_hi, 0x3fff3fff
  buffer_load_dword v250, v152, s[36:39], s19 offen
  s_mov_b64 exec, 0xffff
  buffer_load_dword v250, v153, s[56:59], s22 offen
  s_mov_b64 exec, -1
  s_add_u32 s19, s19, 1835008
  s_add_u32 s22, s22, 524288
  s_mov_b32 s44, s20
  s_mov_b32 s45, s21
  s_mov_b32 s46, 7340032
  s_mov_b32 s47, 0x20000
  s_bfe_u32 s70, s2, 0x10002
  s_lshl_b32 s70, s70, 5
  s_add_u32 s71, s70, s68
  s_lshr_b32 s70, s71, 4
  s_mul_i32 s70, s70, 1835008
  s_and_b32 s71, s71, 15
  s_lshl_b32 s71, s71, 15
  s_add_u32 s70, s70, s71
  s_and_b32 s71, s67, 3
  s_lshl_b32 s71, s71, 7
  s_add_u32 s70, s70, s71
  v_lshlrev_b32 v151, 9, v0
  buffer_load_dword v250, v151, s[44:47], s70 offen
L_np_122:
  s_cmp_lg_u32 s83, 3
  s_cbranch_scc1 L_pw_124
  s_waitcnt vmcnt(9)
  s_branch L_pw_123
L_pw_124:
  s_cmp_lg_u32 s83, 4
  s_cbranch_scc1 L_pw_125
  s_waitcnt vmcnt(9)
  s_branch L_pw_123
L_pw_125:
  s_waitcnt vmcnt(6)
L_pw_123:
  s_barrier
  s_add_u32 m0, s80, 0
  s_nop 0
  buffer_load_dwordx4 v3, s[36:39], s81 offen offset:0 lds
  buffer_load_dwordx4 v4, s[36:39], s81 offen offset:1024 lds
  buffer_load_dwordx4 v5, s[36:39], s81 offen offset:2048 lds
  buffer_load_dwordx4 v6, s[36:39], s81 offen offset:3072 lds
  s_setprio 0
  v_lshrrev_b32 v22, 3, v0
  v_lshlrev_b32 v22, 11, v22
  v_and_b32 v23, 1, v2
  v_lshlrev_b32 v23, 2, v23
  v_and_b32 v24, 7, v0
  v_xor_b32 v23, v23, v24
  v_lshl_add_u32 v22, v23, 4, v22
  s_lshl_b32 s70, s67, 7
  v_add_u32 v22, s70, v22
  v_xor_b32 v23, 0, v22
  v_add_u32 v244, 0, v23
  v_xor_b32 v23, 32, v22
  v_add_u32 v245, 15360, v23
  v_xor_b32 v23, 0, v22
  v_add_u32 v246, 30720, v23
  v_xor_b32 v23, 32, v22
  v_add_u32 v247, 46080, v23
  s_setprio 1
  s_add_u32 m0, s80, 4096
  s_nop 0
  buffer_load_dwordx4 v7, s[36:39], s81 offen offset:0 lds
  buffer_load_dwordx4 v8, s[36:39], s81 offen offset:1024 lds
  buffer_load_dwordx4 v9, s[36:39], s81 offen offset:2048 lds
  s_add_u32 s81, s81, 458752
  s_cmp_lg_u32 s83, 5
  s_cbranch_scc1 L_np_126
  s_mov_b32 exec_lo, 0x3fff3fff
  s_mov_b32 exec_hi, 0x3fff3fff
  buffer_load_dword v250, v152, s[36:39], s19 offen
  s_mov_b64 exec, 0xffff
  buffer_load_dword v250, v153, s[56:59], s22 offen
  s_mov_b64 exec, -1
  s_add_u32 s19, s19, 1835008
  s_add_u32 s22, s22, 524288
  s_mov_b32 s44, s20
  s_mov_b32 s45, s21
  s_mov_b32 s46, 7340032
  s_mov_b32 s47, 0x20000
  s_bfe_u32 s70, s2, 0x10002
  s_lshl_b32 s70, s70, 5
  s_add_u32 s71, s70, s68
  s_lshr_b32 s70, s71, 4
  s_mul_i32 s70, s70, 1835008
  s_and_b32 s71, s71, 15
  s_lshl_b32 s71, s71, 15
  s_add_u32 s70, s70, s71
  s_and_b32 s71, s67, 3
  s_lshl_b32 s71, s71, 7
  s_add_u32 s70, s70, s71
  v_lshlrev_b32 v151, 9, v0
  buffer_load_dword v250, v151, s[44:47], s70 offen
L_np_126:
  s_cmp_lg_u32 s83, 4
  s_cbranch_scc1 L_pw_128
  s_waitcnt vmcnt(10)
  s_branch L_pw_127
L_pw_128:
  s_cmp_lg_u32 s83, 5
  s_cbranch_scc1 L_pw_129
  s_waitcnt vmcnt(10)
  s_branch L_pw_127
L_pw_129:
  s_waitcnt vmcnt(7)
L_pw_127:
  s_barrier
  s_add_u32 m0, s18, 65536
  s_nop 0
  buffer_load_dwordx4 v148, s[56:59], s14 offen offset:0 lds
  buffer_load_dwordx4 v149, s[56:59], s14 offen offset:1024 lds
  s_add_u32 s14, s14, 131072
  s_setprio 0
  s_lshl_b32 s70, s69, 12
  s_add_u32 s71, s70, 73728
  v_lshl_add_u32 v30, v0, 4, s71
  v_add_u32 v248, 90112, v15
  v_mov_b32 v249, 155648
  v_and_b32 v22, 2, v1
  v_mov_b32 v23, 0x3f803f80
  v_cmp_eq_u32 vcc, 0, v22
  v_lshl_add_u32 v251, v0, 2, v249
  v_sub_u32 v252, 1, v0
  v_max_i32 v252, 0, v252
  v_cndmask_b32 v168, 0, v23, vcc
  v_cndmask_b32 v169, 0, v23, vcc
  v_xor_b32 v172, v168, v23
  v_xor_b32 v173, v168, v23
  v_mov_b64 v[170:171], v[168:169]
  v_mov_b64 v[174:175], v[172:173]
  v_and_b32 v22, 1, v1
  v_mul_u32_u24 v22, 0xaaaa, v22
  v_or_b32 v255, 0x4444, v22
  s_setprio 1
  s_add_u32 m0, s15, 90112
  s_nop 0
  buffer_load_dwordx4 v144, s[32:35], s82 offen offset:0 lds
  buffer_load_dwordx4 v145, s[32:35], s82 offen offset:1024 lds
  buffer_load_dwordx4 v146, s[32:35], s82 offen offset:2048 lds
  buffer_load_dwordx4 v147, s[32:35], s82 offen offset:3072 lds
  s_add_u32 s82, s82, 128
  s_cmp_lg_u32 s83, 6
  s_cbranch_scc1 L_np_130
  s_mov_b32 exec_lo, 0x3fff3fff
  s_mov_b32 exec_hi, 0x3fff3fff
  buffer_load_dword v250, v152, s[36:39], s19 offen
  s_mov_b64 exec, 0xffff
  buffer_load_dword v250, v153, s[56:59], s22 offen
  s_mov_b64 exec, -1
  s_add_u32 s19, s19, 1835008
  s_add_u32 s22, s22, 524288
  s_mov_b32 s44, s20
  s_mov_b32 s45, s21
  s_mov_b32 s46, 7340032
  s_mov_b32 s47, 0x20000
  s_bfe_u32 s70, s2, 0x10002
  s_lshl_b32 s70, s70, 5
  s_add_u32 s71, s70, s68
  s_lshr_b32 s70, s71, 4
  s_mul_i32 s70, s70, 1835008
  s_and_b32 s71, s71, 15
  s_lshl_b32 s71, s71, 15
  s_add_u32 s70, s70, s71
  s_and_b32 s71, s67, 3
  s_lshl_b32 s71, s71, 7
  s_add_u32 s70, s70, s71
  v_lshlrev_b32 v151, 9, v0
  buffer_load_dword v250, v151, s[44:47], s70 offen
L_np_130:
  s_cmp_lg_u32 s83, 5
  s_cbranch_scc1 L_pw_132
  s_waitcnt vmcnt(9)
  s_branch L_pw_131
L_pw_132:
  s_cmp_lg_u32 s83, 6
  s_cbranch_scc1 L_pw_133
  s_waitcnt vmcnt(9)
  s_branch L_pw_131
L_pw_133:
  s_waitcnt vmcnt(6)
L_pw_131:
  s_barrier
  s_add_u32 m0, s80, 28672
  s_nop 0
  buffer_load_dwordx4 v3, s[36:39], s81 offen offset:0 lds
  buffer_load_dwordx4 v4, s[36:39], s81 offen offset:1024 lds
  buffer_load_dwordx4 v5, s[36:39], s81 offen offset:2048 lds
  buffer_load_dwordx4 v6, s[36:39], s81 offen offset:3072 lds
  s_setprio 0
  v_and_b32 v22, 1, v2
  v_lshlrev_b32 v22, 9, v22
  v_lshrrev_b32 v23, 1, v2
  v_lshl_add_u32 v22, v23, 8, v22
  v_lshl_add_u32 v31, v1, 4, v22
  v_mov_b32 v240, v15
  v_mov_b32 v241, v15
  v_mov_b32 v242, v15
  v_mov_b32 v243, v15
  v_mov_b64 v[128:129], 0
  v_mov_b64 v[130:131], 0
  v_mov_b64 v[132:133], 0
  v_mov_b64 v[134:135], 0
  v_mov_b64 v[192:193], 0
  v_mov_b64 v[194:195], 0
  v_mov_b64 v[196:197], 0
  v_mov_b64 v[198:199], 0
  v_mov_b64 v[200:201], 0
  v_mov_b64 v[202:203], 0
  v_mov_b64 v[204:205], 0
  v_mov_b64 v[206:207], 0
  s_setprio 1
  s_add_u32 m0, s80, 32768
  s_nop 0
  buffer_load_dwordx4 v7, s[36:39], s81 offen offset:0 lds
  buffer_load_dwordx4 v8, s[36:39], s81 offen offset:1024 lds
  buffer_load_dwordx4 v9, s[36:39], s81 offen offset:2048 lds
  s_add_u32 s81, s81, 458752
  s_cmp_lg_u32 s83, 7
  s_cbranch_scc1 L_np_134
  s_mov_b32 exec_lo, 0x3fff3fff
  s_mov_b32 exec_hi, 0x3fff3fff
  buffer_load_dword v250, v152, s[36:39], s19 offen
  s_mov_b64 exec, 0xffff
  buffer_load_dword v250, v153, s[56:59], s22 offen
  s_mov_b64 exec, -1
  s_add_u32 s19, s19, 1835008
  s_add_u32 s22, s22, 524288
L_np_134:
  s_cmp_lg_u32 s83, 6
  s_cbranch_scc1 L_pw_136
  s_waitcnt vmcnt(10)
  s_branch L_pw_135
L_pw_136:
  s_cmp_lg_u32 s83, 7
  s_cbranch_scc1 L_pw_137
  s_waitcnt vmcnt(9)
  s_branch L_pw_135
L_pw_137:
  s_waitcnt vmcnt(7)
L_pw_135:
  s_barrier
  s_add_u32 m0, s18, 57344
  s_nop 0
  buffer_load_dwordx4 v148, s[56:59], s14 offen offset:0 lds
  buffer_load_dwordx4 v149, s[56:59], s14 offen offset:1024 lds
  s_add_u32 s14, s14, 131072
  s_setprio 0
  v_mov_b64 v[48:49], 0
  v_mov_b64 v[50:51], 0
  v_mov_b64 v[52:53], 0
  v_mov_b64 v[54:55], 0
  v_mov_b64 v[56:57], 0
  v_mov_b64 v[58:59], 0
  v_mov_b64 v[60:61], 0
  v_mov_b64 v[62:63], 0
  v_mov_b64 v[64:65], 0
  v_mov_b64 v[66:67], 0
  v_mov_b64 v[68:69], 0
  v_mov_b64 v[70:71], 0
  v_mov_b64 v[72:73], 0
  v_mov_b64 v[74:75], 0
  v_mov_b64 v[76:77], 0
  v_mov_b64 v[78:79], 0
  v_mov_b64 v[80:81], 0
  v_mov_b64 v[82:83], 0
  v_mov_b64 v[84:85], 0
  v_mov_b64 v[86:87], 0
  s_setprio 1
  s_add_u32 m0, s15, 106496
  s_nop 0
  buffer_load_dwordx4 v144, s[32:35], s82 offen offset:0 lds
  buffer_load_dwordx4 v145, s[32:35], s82 offen offset:1024 lds
  buffer_load_dwordx4 v146, s[32:35], s82 offen offset:2048 lds
  buffer_load_dwordx4 v147, s[32:35], s82 offen offset:3072 lds
  s_add_u32 s82, s82, 128
  s_cmp_lg_u32 s83, 7
  s_cbranch_scc1 L_pw_139
  s_waitcnt vmcnt(8)
  s_branch L_pw_138
L_pw_139:
  s_waitcnt vmcnt(6)
L_pw_138:
  s_barrier
  s_mov_b32 s73, 19152896
  buffer_load_dwordx4 v[96:99], v15, s[48:51], s73 offen sc1
  s_add_u32 m0, s80, 0
  s_nop 0
  buffer_load_dwordx4 v3, s[36:39], s81 offen offset:0 lds
  buffer_load_dwordx4 v4, s[36:39], s81 offen offset:1024 lds
  buffer_load_dwordx4 v5, s[36:39], s81 offen offset:2048 lds
  buffer_load_dwordx4 v6, s[36:39], s81 offen offset:3072 lds
  s_add_u32 m0, s80, 4096
  s_nop 0
  buffer_load_dwordx4 v7, s[36:39], s81 offen offset:0 lds
  buffer_load_dwordx4 v8, s[36:39], s81 offen offset:1024 lds
  buffer_load_dwordx4 v9, s[36:39], s81 offen offset:2048 lds
  s_add_u32 s81, s81, 458752
  s_waitcnt vmcnt(8)
  s_barrier
  s_add_u32 m0, s18, 65536
  s_nop 0
  buffer_load_dwordx4 v148, s[56:59], s14 offen offset:0 lds
  buffer_load_dwordx4 v149, s[56:59], s14 offen offset:1024 lds
  s_add_u32 s14, s14, 131072
  s_add_u32 m0, s15, 73728
  s_nop 0
  buffer_load_dwordx4 v144, s[32:35], s82 offen offset:0 lds
  buffer_load_dwordx4 v145, s[32:35], s82 offen offset:1024 lds
  buffer_load_dwordx4 v146, s[32:35], s82 offen offset:2048 lds
  buffer_load_dwordx4 v147, s[32:35], s82 offen offset:3072 lds
  s_add_u32 s82, s82, 128
  s_mov_b32 s71, 262144
  s_waitcnt vmcnt(13)
L_poll1:
  v_and_b32 v96, v96, v97
  v_and_b32 v98, v98, v99
  v_and_b32 v96, v96, v98
  v_cmp_ne_u32 vcc, 1, v96
  s_sub_u32 s71, s71, 1
  s_cbranch_vccz L_poll1x
  s_sleep 16
  buffer_load_dwordx4 v[96:99], v15, s[48:51], s73 offen sc1
  s_waitcnt vmcnt(0)
  s_cmp_lg_u32 s71, 0
  s_cbranch_scc1 L_poll1
L_poll1x:
  s_waitcnt vmcnt(6)
  s_barrier
  s_add_u32 m0, s80, 28672
  s_nop 0
  buffer_load_dwordx4 v3, s[36:39], s81 offen offset:0 lds
  buffer_load_dwordx4 v4, s[36:39], s81 offen offset:1024 lds
  buffer_load_dwordx4 v5, s[36:39], s81 offen offset:2048 lds
  buffer_load_dwordx4 v6, s[36:39], s81 offen offset:3072 lds
  s_add_u32 m0, s80, 32768
  s_nop 0
  buffer_load_dwordx4 v7, s[36:39], s81 offen offset:0 lds
  buffer_load_dwordx4 v8, s[36:39], s81 offen offset:1024 lds
  buffer_load_dwordx4 v9, s[36:39], s81 offen offset:2048 lds
  s_add_u32 s81, s81, 458752
  s_lshl_b32 s71, s64, 9
  s_lshl_b32 s72, s69, 7
  s_add_u32 s71, s71, s72
  s_add_u32 s71, s71, 19136512
  v_lshlrev_b32 v22, 2, v1
  buffer_load_dword v253, v22, s[48:51], s71 offen offset:0 sc1
  buffer_load_dword v254, v22, s[48:51], s71 offen offset:64 sc1
  s_add_u32 s60, s30, 18874368
  s_addc_u32 s61, s31, 0
  s_mov_b32 s62, 0x40000
  s_mov_b32 s63, 0x20000
  s_lshl_b32 s76, s69, 12
  s_add_u32 m0, s76, 122880
  s_add_u32 s70, s76, 0
  buffer_load_dwordx4 v15, s[60:63], s70 offen offset:0 sc1 lds
  buffer_load_dwordx4 v15, s[60:63], s70 offen offset:1024 sc1 lds
  buffer_load_dwordx4 v15, s[60:63], s70 offen offset:2048 sc1 lds
  buffer_load_dwordx4 v15, s[60:63], s70 offen offset:3072 sc1 lds
  s_waitcnt vmcnt(13)
L_a1done:
  s_barrier
  s_add_u32 m0, s76, 139264
  s_add_u32 s70, s76, 16384
  buffer_load_dwordx4 v15, s[60:63], s70 offen offset:0 sc1 lds
  buffer_load_dwordx4 v15, s[60:63], s70 offen offset:1024 sc1 lds
  buffer_load_dwordx4 v15, s[60:63], s70 offen offset:2048 sc1 lds
  buffer_load_dwordx4 v15, s[60:63], s70 offen offset:3072 sc1 lds
  s_add_u32 m0, s76, 90112
  s_add_u32 s70, s76, 32768
  buffer_load_dwordx4 v15, s[60:63], s70 offen offset:0 sc1 lds
  buffer_load_dwordx4 v15, s[60:63], s70 offen offset:1024 sc1 lds
  buffer_load_dwordx4 v15, s[60:63], s70 offen offset:2048 sc1 lds
  buffer_load_dwordx4 v15, s[60:63], s70 offen offset:3072 sc1 lds
  s_waitcnt vmcnt(14)
  s_barrier
  s_add_u32 m0, s76, 106496
  s_add_u32 s70, s76, 49152
  buffer_load_dwordx4 v15, s[60:63], s70 offen offset:0 sc1 lds
  buffer_load_dwordx4 v15, s[60:63], s70 offen offset:1024 sc1 lds
  buffer_load_dwordx4 v15, s[60:63], s70 offen offset:2048 sc1 lds
  buffer_load_dwordx4 v15, s[60:63], s70 offen offset:3072 sc1 lds
  s_add_u32 s70, s76, 65536
  buffer_load_dwordx4 v[208:211], v15, s[60:63], s70 offen offset:0 sc1
  buffer_load_dwordx4 v[212:215], v15, s[60:63], s70 offen offset:1024 sc1
  buffer_load_dwordx4 v[216:219], v15, s[60:63], s70 offen offset:2048 sc1
  buffer_load_dwordx4 v[220:223], v15, s[60:63], s70 offen offset:3072 sc1
  s_add_u32 s70, s76, 81920
  buffer_load_dwordx4 v[224:227], v15, s[60:63], s70 offen offset:0 sc1
  buffer_load_dwordx4 v[228:231], v15, s[60:63], s70 offen offset:1024 sc1
  buffer_load_dwordx4 v[232:235], v15, s[60:63], s70 offen offset:2048 sc1
  buffer_load_dwordx4 v[236:239], v15, s[60:63], s70 offen offset:3072 sc1
  s_waitcnt vmcnt(16)
  s_barrier
  s_lshl_b32 s70, s69, 12
  s_mov_b32 s78, 4
  s_add_u32 s79, s70, 49152
  s_mov_b32 s81, 16384
  s_mov_b32 s77, 16384
  s_add_u32 s80, s70, 90112
  s_mul_i32 s82, s64, 1179648
  s_lshl_b32 s71, s100, 14
  s_add_u32 s82, s82, s71
  s_lshl_b32 s71, s69, 11
  s_add_u32 s82, s82, s71
  s_add_u32 s82, s82, 917504
  s_add_u32 s83, s82, 8192
  s_mov_b32 s76, 0
  s_barrier
  ds_read_b128 v[32:35], v30
  ds_read_b128 v[136:139], v248 offset:32768
  ds_read_b128 v[140:143], v248 offset:33792
  ds_read_b128 v[144:147], v248 offset:36864
  ds_read_b128 v[148:151], v248 offset:37888
  ds_read_b128 v[36:39], v30 offset:1024
  ds_read_b128 v[40:43], v30 offset:2048
  ds_read_b128 v[44:47], v30 offset:3072
  ds_read_b128 v[176:179], v248 offset:34816
  ds_read_b128 v[180:183], v248 offset:35840
  ds_read_b128 v[184:187], v248 offset:38912
  ds_read_b128 v[188:191], v248 offset:39936
  s_waitcnt lgkmcnt(7)
  v_mfma_f32_16x16x32_bf16 v[88:91], v[136:139], v[32:35], 0
  v_mfma_f32_16x16x32_bf16 v[92:95], v[140:143], v[32:35], 0
  v_mfma_f32_16x16x32_bf16 v[96:99], v[144:147], v[32:35], 0
  v_mfma_f32_16x16x32_bf16 v[100:103], v[148:151], v[32:35], 0
  s_waitcnt lgkmcnt(6)
  s_nop 3
.p2align 3
L_att:
  v_exp_f32 v88, v88
  v_exp_f32 v89, v89
  v_exp_f32 v90, v90
  v_exp_f32 v91, v91
  v_exp_f32 v92, v92
  v_exp_f32 v93, v93
  v_exp_f32 v94, v94
  v_mfma_f32_16x16x32_bf16 v[104:107], v[136:139], v[36:39], 0
  v_cvt_pk_bf16_f32 v120, v88, v89
  v_cvt_pk_bf16_f32 v121, v90, v91
  v_mfma_f32_16x16x32_bf16 v[108:111], v[140:143], v[36:39], 0
  v_exp_f32 v95, v95
  v_mfma_f32_16x16x32_bf16 v[112:115], v[144:147], v[36:39], 0
  v_cvt_pk_bf16_f32 v122, v92, v93
  v_cvt_pk_bf16_f32 v123, v94, v95
  v_mfma_f32_16x16x32_bf16 v[116:119], v[148:151], v[36:39], 0
  v_exp_f32 v96, v96
  v_mfma_f32_16x16x32_bf16 v[72:75], v[192:195], v[128:131], v[72:75]
  v_exp_f32 v97, v97
  v_mfma_f32_16x16x32_bf16 v[72:75], v[200:203], v[132:135], v[72:75]
  v_exp_f32 v98, v98
  v_mfma_f32_16x16x32_bf16 v[76:79], v[204:207], v[132:135], v[76:79]
  s_waitcnt vmcnt(4) lgkmcnt(0)
  v_exp_f32 v99, v99
  v_mfma_f32_16x16x32_bf16 v[76:79], v[196:199], v[128:131], v[76:79]
  v_cvt_pk_bf16_f32 v124, v96, v97
  v_cvt_pk_bf16_f32 v125, v98, v99
  v_smfmac_f32_16x16x64_bf16 v[84:87], v[172:175], v[128:135], v255
  ds_read_b128 v[152:155], v248 offset:40960
  ds_read_b128 v[156:159], v248 offset:41984
  ds_add_u32 v251, v252
  v_exp_f32 v100, v100
  v_exp_f32 v101, v101
  v_exp_f32 v102, v102
  v_exp_f32 v103, v103
  v_cvt_pk_bf16_f32 v126, v100, v101
  v_cvt_pk_bf16_f32 v127, v102, v103
  v_exp_f32 v104, v104
  v_exp_f32 v105, v105
  v_exp_f32 v106, v106
  v_exp_f32 v107, v107
  v_exp_f32 v108, v108
  v_exp_f32 v109, v109
  v_exp_f32 v110, v110
  v_mfma_f32_16x16x32_bf16 v[88:91], v[136:139], v[40:43], 0
  s_add_u32 m0, s80, 16384
  v_cvt_pk_bf16_f32 v128, v104, v105
  v_cvt_pk_bf16_f32 v129, v106, v107
  v_mfma_f32_16x16x32_bf16 v[92:95], v[140:143], v[40:43], 0
  v_exp_f32 v111, v111
  v_mfma_f32_16x16x32_bf16 v[96:99], v[144:147], v[40:43], 0
  v_cvt_pk_bf16_f32 v130, v108, v109
  v_cvt_pk_bf16_f32 v131, v110, v111
  v_mfma_f32_16x16x32_bf16 v[100:103], v[148:151], v[40:43], 0
  v_exp_f32 v112, v112
  v_mfma_f32_16x16x32_bf16 v[48:51], v[176:179], v[120:123], v[48:51]
  v_exp_f32 v113, v113
  v_mfma_f32_16x16x32_bf16 v[48:51], v[184:187], v[124:127], v[48:51]
  v_exp_f32 v114, v114
  v_mfma_f32_16x16x32_bf16 v[52:55], v[188:191], v[124:127], v[52:55]
  s_waitcnt lgkmcnt(1)
  v_exp_f32 v115, v115
  v_mfma_f32_16x16x32_bf16 v[52:55], v[180:183], v[120:123], v[52:55]
  v_cvt_pk_bf16_f32 v132, v112, v113
  v_cvt_pk_bf16_f32 v133, v114, v115
  v_smfmac_f32_16x16x64_bf16 v[80:83], v[168:171], v[120:127], v255
  ds_read_b128 v[160:163], v248 offset:45056
  ds_read_b128 v[164:167], v248 offset:46080
  v_exp_f32 v116, v116
  v_exp_f32 v117, v117
  v_exp_f32 v118, v118
  v_exp_f32 v119, v119
  v_cvt_pk_bf16_f32 v134, v116, v117
  v_cvt_pk_bf16_f32 v135, v118, v119
  v_exp_f32 v88, v88
  v_exp_f32 v89, v89
  v_exp_f32 v90, v90
  v_exp_f32 v91, v91
  v_exp_f32 v92, v92
  v_exp_f32 v93, v93
  v_exp_f32 v94, v94
  v_mfma_f32_16x16x32_bf16 v[104:107], v[136:139], v[44:47], 0
  v_cvt_pk_bf16_f32 v120, v88, v89
  v_cvt_pk_bf16_f32 v121, v90, v91
  v_mfma_f32_16x16x32_bf16 v[108:111], v[140:143], v[44:47], 0
  v_exp_f32 v95, v95
  v_mfma_f32_16x16x32_bf16 v[112:115], v[144:147], v[44:47], 0
  v_cvt_pk_bf16_f32 v122, v92, v93
  v_cvt_pk_bf16_f32 v123, v94, v95
  v_mfma_f32_16x16x32_bf16 v[116:119], v[148:151], v[44:47], 0
  v_exp_f32 v96, v96
  v_mfma_f32_16x16x32_bf16 v[56:59], v[176:179], v[128:131], v[56:59]
  v_exp_f32 v97, v97
  v_mfma_f32_16x16x32_bf16 v[56:59], v[184:187], v[132:135], v[56:59]
  v_exp_f32 v98, v98
  v_mfma_f32_16x16x32_bf16 v[60:63], v[188:191], v[132:135], v[60:63]
  s_waitcnt lgkmcnt(0)
  v_exp_f32 v99, v99
  v_mfma_f32_16x16x32_bf16 v[60:63], v[180:183], v[128:131], v[60:63]
  v_cvt_pk_bf16_f32 v124, v96, v97
  v_cvt_pk_bf16_f32 v125, v98, v99
  v_smfmac_f32_16x16x64_bf16 v[80:83], v[172:175], v[128:135], v255
  ds_read_b128 v[192:195], v248 offset:43008
  ds_read_b128 v[196:199], v248 offset:44032
  ds_read_b32 v20, v249
  v_exp_f32 v100, v100
  v_exp_f32 v101, v101
  v_exp_f32 v102, v102
  v_exp_f32 v103, v103
  v_cvt_pk_bf16_f32 v126, v100, v101
  v_cvt_pk_bf16_f32 v127, v102, v103
  v_exp_f32 v104, v104
  v_exp_f32 v105, v105
  v_exp_f32 v106, v106
  v_exp_f32 v107, v107
  v_exp_f32 v108, v108
  v_exp_f32 v109, v109
  v_exp_f32 v110, v110
  v_mfma_f32_16x16x32_bf16 v[88:91], v[152:155], v[32:35], 0
  v_cvt_pk_bf16_f32 v128, v104, v105
  v_cvt_pk_bf16_f32 v129, v106, v107
  v_mfma_f32_16x16x32_bf16 v[92:95], v[156:159], v[32:35], 0
  v_exp_f32 v111, v111
  v_mfma_f32_16x16x32_bf16 v[96:99], v[160:163], v[32:35], 0
  v_cvt_pk_bf16_f32 v130, v108, v109
  v_cvt_pk_bf16_f32 v131, v110, v111
  v_mfma_f32_16x16x32_bf16 v[100:103], v[164:167], v[32:35], 0
  v_exp_f32 v112, v112
  v_mfma_f32_16x16x32_bf16 v[64:67], v[176:179], v[120:123], v[64:67]
  v_exp_f32 v113, v113
  v_mfma_f32_16x16x32_bf16 v[64:67], v[184:187], v[124:127], v[64:67]
  v_exp_f32 v114, v114
  v_mfma_f32_16x16x32_bf16 v[68:71], v[188:191], v[124:127], v[68:71]
  s_waitcnt lgkmcnt(0)
  v_exp_f32 v115, v115
  v_mfma_f32_16x16x32_bf16 v[68:71], v[180:183], v[120:123], v[68:71]
  v_cvt_pk_bf16_f32 v132, v112, v113
  v_cvt_pk_bf16_f32 v133, v114, v115
  v_smfmac_f32_16x16x64_bf16 v[84:87], v[168:171], v[120:127], v255
  ds_read_b128 v[200:203], v248 offset:47104
  ds_read_b128 v[204:207], v248 offset:48128
  v_exp_f32 v116, v116
  v_cmp_gt_u32 vcc, s78, v20
  v_exp_f32 v117, v117
  v_exp_f32 v118, v118
  v_exp_f32 v119, v119
  v_cvt_pk_bf16_f32 v134, v116, v117
  v_cvt_pk_bf16_f32 v135, v118, v119
  v_exp_f32 v88, v88
  v_exp_f32 v89, v89
  v_exp_f32 v90, v90
  v_exp_f32 v91, v91
  v_exp_f32 v92, v92
  v_exp_f32 v93, v93
  v_exp_f32 v94, v94
  v_mfma_f32_16x16x32_bf16 v[104:107], v[152:155], v[36:39], 0
  s_cbranch_vccnz L_attspin0
L_attgo0:
  v_cvt_pk_bf16_f32 v120, v88, v89
  v_cvt_pk_bf16_f32 v121, v90, v91
  v_mfma_f32_16x16x32_bf16 v[108:111], v[156:159], v[36:39], 0
  s_add_u32 s78, s78, 4
  v_exp_f32 v95, v95
  v_mfma_f32_16x16x32_bf16 v[112:115], v[160:163], v[36:39], 0
  v_cvt_pk_bf16_f32 v122, v92, v93
  v_cvt_pk_bf16_f32 v123, v94, v95
  v_mfma_f32_16x16x32_bf16 v[116:119], v[164:167], v[36:39], 0
  v_exp_f32 v96, v96
  v_mfma_f32_16x16x32_bf16 v[72:75], v[176:179], v[128:131], v[72:75]
  s_cmp_eq_u32 s76, 0
  v_exp_f32 v97, v97
  v_mfma_f32_16x16x32_bf16 v[72:75], v[184:187], v[132:135], v[72:75]
  v_exp_f32 v98, v98
  v_mfma_f32_16x16x32_bf16 v[76:79], v[188:191], v[132:135], v[76:79]
  s_waitcnt lgkmcnt(0)
  v_exp_f32 v99, v99
  v_mfma_f32_16x16x32_bf16 v[76:79], v[180:183], v[128:131], v[76:79]
  v_cvt_pk_bf16_f32 v124, v96, v97
  v_cvt_pk_bf16_f32 v125, v98, v99
  v_smfmac_f32_16x16x64_bf16 v[84:87], v[172:175], v[128:135], v255
  ds_read_b128 v[136:139], v248 offset:49152
  ds_read_b128 v[140:143], v248 offset:50176
  s_cbranch_scc1 L_nodma0_0
  buffer_load_dwordx4 v240, s[60:63], s79 offen offset:0 sc1 lds
  buffer_load_dwordx4 v241, s[60:63], s79 offen offset:1024 sc1 lds
L_nodma0_0:
  v_exp_f32 v100, v100
  v_exp_f32 v101, v101
  v_exp_f32 v102, v102
  v_exp_f32 v103, v103
  v_cvt_pk_bf16_f32 v126, v100, v101
  v_cvt_pk_bf16_f32 v127, v102, v103
  v_exp_f32 v104, v104
  v_exp_f32 v105, v105
  v_exp_f32 v106, v106
  v_exp_f32 v107, v107
  v_exp_f32 v108, v108
  v_exp_f32 v109, v109
  v_exp_f32 v110, v110
  v_mfma_f32_16x16x32_bf16 v[88:91], v[152:155], v[40:43], 0
  v_cvt_pk_bf16_f32 v128, v104, v105
  v_cvt_pk_bf16_f32 v129, v106, v107
  v_mfma_f32_16x16x32_bf16 v[92:95], v[156:159], v[40:43], 0
  v_exp_f32 v111, v111
  v_mfma_f32_16x16x32_bf16 v[96:99], v[160:163], v[40:43], 0
  v_cvt_pk_bf16_f32 v130, v108, v109
  v_cvt_pk_bf16_f32 v131, v110, v111
  v_mfma_f32_16x16x32_bf16 v[100:103], v[164:167], v[40:43], 0
  v_exp_f32 v112, v112
  v_mfma_f32_16x16x32_bf16 v[48:51], v[192:195], v[120:123], v[48:51]
  v_exp_f32 v113, v113
  v_mfma_f32_16x16x32_bf16 v[48:51], v[200:203], v[124:127], v[48:51]
  v_exp_f32 v114, v114
  v_mfma_f32_16x16x32_bf16 v[52:55], v[204:207], v[124:127], v[52:55]
  s_waitcnt lgkmcnt(0)
  v_exp_f32 v115, v115
  v_mfma_f32_16x16x32_bf16 v[52:55], v[196:199], v[120:123], v[52:55]
  v_cvt_pk_bf16_f32 v132, v112, v113
  v_cvt_pk_bf16_f32 v133, v114, v115
  v_smfmac_f32_16x16x64_bf16 v[80:83], v[168:171], v[120:127], v255
  ds_read_b128 v[144:147], v248 offset:53248
  ds_read_b128 v[148:151], v248 offset:54272
  s_cbranch_scc1 L_nodma0_2
  buffer_load_dwordx4 v242, s[60:63], s79 offen offset:2048 sc1 lds
  buffer_load_dwordx4 v243, s[60:63], s79 offen offset:3072 sc1 lds
L_nodma0_2:
  v_exp_f32 v116, v116
  v_exp_f32 v117, v117
  v_exp_f32 v118, v118
  v_exp_f32 v119, v119
  v_cvt_pk_bf16_f32 v134, v116, v117
  v_cvt_pk_bf16_f32 v135, v118, v119
  v_exp_f32 v88, v88
  v_exp_f32 v89, v89
  v_exp_f32 v90, v90
  v_exp_f32 v91, v91
  v_exp_f32 v92, v92
  v_exp_f32 v93, v93
  v_exp_f32 v94, v94
  v_mfma_f32_16x16x32_bf16 v[104:107], v[152:155], v[44:47], 0
  v_cvt_pk_bf16_f32 v120, v88, v89
  v_cvt_pk_bf16_f32 v121, v90, v91
  v_mfma_f32_16x16x32_bf16 v[108:111], v[156:159], v[44:47], 0
  v_exp_f32 v95, v95
  v_mfma_f32_16x16x32_bf16 v[112:115], v[160:163], v[44:47], 0
  v_cvt_pk_bf16_f32 v122, v92, v93
  v_cvt_pk_bf16_f32 v123, v94, v95
  v_mfma_f32_16x16x32_bf16 v[116:119], v[164:167], v[44:47], 0
  v_exp_f32 v96, v96
  v_mfma_f32_16x16x32_bf16 v[56:59], v[192:195], v[128:131], v[56:59]
  v_exp_f32 v97, v97
  v_mfma_f32_16x16x32_bf16 v[56:59], v[200:203], v[132:135], v[56:59]
  v_exp_f32 v98, v98
  v_mfma_f32_16x16x32_bf16 v[60:63], v[204:207], v[132:135], v[60:63]
  s_waitcnt lgkmcnt(0)
  v_exp_f32 v99, v99
  v_mfma_f32_16x16x32_bf16 v[60:63], v[196:199], v[128:131], v[60:63]
  v_cvt_pk_bf16_f32 v124, v96, v97
  v_cvt_pk_bf16_f32 v125, v98, v99
  v_smfmac_f32_16x16x64_bf16 v[80:83], v[172:175], v[128:135], v255
  ds_read_b128 v[176:179], v248 offset:51200
  ds_read_b128 v[180:183], v248 offset:52224
  v_exp_f32 v100, v100
  v_exp_f32 v101, v101
  v_exp_f32 v102, v102
  v_exp_f32 v103, v103
  v_cvt_pk_bf16_f32 v126, v100, v101
  v_cvt_pk_bf16_f32 v127, v102, v103
  v_exp_f32 v104, v104
  v_exp_f32 v105, v105
  v_exp_f32 v106, v106
  v_exp_f32 v107, v107
  v_exp_f32 v108, v108
  v_exp_f32 v109, v109
  v_exp_f32 v110, v110
  v_mfma_f32_16x16x32_bf16 v[88:91], v[136:139], v[32:35], 0
  s_add_u32 s79, s79, s81
  v_cvt_pk_bf16_f32 v128, v104, v105
  v_cvt_pk_bf16_f32 v129, v106, v107
  v_mfma_f32_16x16x32_bf16 v[92:95], v[140:143], v[32:35], 0
  v_exp_f32 v111, v111
  v_mfma_f32_16x16x32_bf16 v[96:99], v[144:147], v[32:35], 0
  v_cvt_pk_bf16_f32 v130, v108, v109
  v_cvt_pk_bf16_f32 v131, v110, v111
  v_mfma_f32_16x16x32_bf16 v[100:103], v[148:151], v[32:35], 0
  v_exp_f32 v112, v112
  v_mfma_f32_16x16x32_bf16 v[64:67], v[192:195], v[120:123], v[64:67]
  v_exp_f32 v113, v113
  v_mfma_f32_16x16x32_bf16 v[64:67], v[200:203], v[124:127], v[64:67]
  v_exp_f32 v114, v114
  v_mfma_f32_16x16x32_bf16 v[68:71], v[204:207], v[124:127], v[68:71]
  s_waitcnt lgkmcnt(0)
  v_exp_f32 v115, v115
  v_mfma_f32_16x16x32_bf16 v[68:71], v[196:199], v[120:123], v[68:71]
  v_cvt_pk_bf16_f32 v132, v112, v113
  v_cvt_pk_bf16_f32 v133, v114, v115
  v_smfmac_f32_16x16x64_bf16 v[84:87], v[168:171], v[120:127], v255
  ds_read_b128 v[184:187], v248 offset:55296
  ds_read_b128 v[188:191], v248 offset:56320
  v_exp_f32 v116, v116
  v_exp_f32 v117, v117
  v_exp_f32 v118, v118
  v_exp_f32 v119, v119
  v_cvt_pk_bf16_f32 v134, v116, v117
  v_cvt_pk_bf16_f32 v135, v118, v119
  v_exp_f32 v88, v88
  v_exp_f32 v89, v89
  v_exp_f32 v90, v90
  v_exp_f32 v91, v91
  v_exp_f32 v92, v92
  v_exp_f32 v93, v93
  v_exp_f32 v94, v94
  v_mfma_f32_16x16x32_bf16 v[104:107], v[136:139], v[36:39], 0
  v_cvt_pk_bf16_f32 v120, v88, v89
  v_cvt_pk_bf16_f32 v121, v90, v91
  v_mfma_f32_16x16x32_bf16 v[108:111], v[140:143], v[36:39], 0
  v_exp_f32 v95, v95
  v_mfma_f32_16x16x32_bf16 v[112:115], v[144:147], v[36:39], 0
  v_cvt_pk_bf16_f32 v122, v92, v93
  v_cvt_pk_bf16_f32 v123, v94, v95
  v_mfma_f32_16x16x32_bf16 v[116:119], v[148:151], v[36:39], 0
  v_exp_f32 v96, v96
  v_mfma_f32_16x16x32_bf16 v[72:75], v[192:195], v[128:131], v[72:75]
  v_exp_f32 v97, v97
  v_mfma_f32_16x16x32_bf16 v[72:75], v[200:203], v[132:135], v[72:75]
  v_exp_f32 v98, v98
  v_mfma_f32_16x16x32_bf16 v[76:79], v[204:207], v[132:135], v[76:79]
  s_waitcnt vmcnt(4) lgkmcnt(0)
  v_exp_f32 v99, v99
  v_mfma_f32_16x16x32_bf16 v[76:79], v[196:199], v[128:131], v[76:79]
  v_cvt_pk_bf16_f32 v124, v96, v97
  v_cvt_pk_bf16_f32 v125, v98, v99
  v_smfmac_f32_16x16x64_bf16 v[84:87], v[172:175], v[128:135], v255
  ds_read_b128 v[152:155], v248 offset:57344
  ds_read_b128 v[156:159], v248 offset:58368
  ds_add_u32 v251, v252
  v_exp_f32 v100, v100
  v_exp_f32 v101, v101
  v_exp_f32 v102, v102
  v_exp_f32 v103, v103
  v_cvt_pk_bf16_f32 v126, v100, v101
  v_cvt_pk_bf16_f32 v127, v102, v103
  v_exp_f32 v104, v104
  v_exp_f32 v105, v105
  v_exp_f32 v106, v106
  v_exp_f32 v107, v107
  v_exp_f32 v108, v108
  v_exp_f32 v109, v109
  v_exp_f32 v110, v110
  v_mfma_f32_16x16x32_bf16 v[88:91], v[136:139], v[40:43], 0
  s_add_u32 m0, s80, 32768
  v_cvt_pk_bf16_f32 v128, v104, v105
  v_cvt_pk_bf16_f32 v129, v106, v107
  v_mfma_f32_16x16x32_bf16 v[92:95], v[140:143], v[40:43], 0
  s_cmp_eq_u32 s76, 3
  v_exp_f32 v111, v111
  v_mfma_f32_16x16x32_bf16 v[96:99], v[144:147], v[40:43], 0
  v_cvt_pk_bf16_f32 v130, v108, v109
  v_cvt_pk_bf16_f32 v131, v110, v111
  v_mfma_f32_16x16x32_bf16 v[100:103], v[148:151], v[40:43], 0
  v_exp_f32 v112, v112
  v_mfma_f32_16x16x32_bf16 v[48:51], v[176:179], v[120:123], v[48:51]
  s_cbranch_scc1 L_attwo
L_attwo_r:
  v_exp_f32 v113, v113
  v_mfma_f32_16x16x32_bf16 v[48:51], v[184:187], v[124:127], v[48:51]
  v_exp_f32 v114, v114
  v_mfma_f32_16x16x32_bf16 v[52:55], v[188:191], v[124:127], v[52:55]
  s_waitcnt lgkmcnt(1)
  v_exp_f32 v115, v115
  v_mfma_f32_16x16x32_bf16 v[52:55], v[180:183], v[120:123], v[52:55]
  v_cvt_pk_bf16_f32 v132, v112, v113
  v_cvt_pk_bf16_f32 v133, v114, v115
  v_smfmac_f32_16x16x64_bf16 v[80:83], v[168:171], v[120:127], v255
  ds_read_b128 v[160:163], v248 offset:61440
  ds_read_b128 v[164:167], v248 offset:62464
  v_exp_f32 v116, v116
  v_exp_f32 v117, v117
  v_exp_f32 v118, v118
  v_exp_f32 v119, v119
  v_cvt_pk_bf16_f32 v134, v116, v117
  v_cvt_pk_bf16_f32 v135, v118, v119
  v_exp_f32 v88, v88
  v_exp_f32 v89, v89
  v_exp_f32 v90, v90
  v_exp_f32 v91, v91
  v_exp_f32 v92, v92
  v_exp_f32 v93, v93
  v_exp_f32 v94, v94
  v_mfma_f32_16x16x32_bf16 v[104:107], v[136:139], v[44:47], 0
  v_cvt_pk_bf16_f32 v120, v88, v89
  v_cvt_pk_bf16_f32 v121, v90, v91
  v_mfma_f32_16x16x32_bf16 v[108:111], v[140:143], v[44:47], 0
  v_exp_f32 v95, v95
  v_mfma_f32_16x16x32_bf16 v[112:115], v[144:147], v[44:47], 0
  v_cvt_pk_bf16_f32 v122, v92, v93
  v_cvt_pk_bf16_f32 v123, v94, v95
  v_mfma_f32_16x16x32_bf16 v[116:119], v[148:151], v[44:47], 0
  v_exp_f32 v96, v96
  v_mfma_f32_16x16x32_bf16 v[56:59], v[176:179], v[128:131], v[56:59]
  v_exp_f32 v97, v97
  v_mfma_f32_16x16x32_bf16 v[56:59], v[184:187], v[132:135], v[56:59]
  v_exp_f32 v98, v98
  v_mfma_f32_16x16x32_bf16 v[60:63], v[188:191], v[132:135], v[60:63]
  s_waitcnt lgkmcnt(0)
  v_exp_f32 v99, v99
  v_mfma_f32_16x16x32_bf16 v[60:63], v[180:183], v[128:131], v[60:63]
  v_cvt_pk_bf16_f32 v124, v96, v97
  v_cvt_pk_bf16_f32 v125, v98, v99
  v_smfmac_f32_16x16x64_bf16 v[80:83], v[172:175], v[128:135], v255
  ds_read_b128 v[192:195], v248 offset:59392
  ds_read_b128 v[196:199], v248 offset:60416
  ds_read_b32 v20, v249
  v_exp_f32 v100, v100
  v_exp_f32 v101, v101
  v_exp_f32 v102, v102
  v_exp_f32 v103, v103
  v_cvt_pk_bf16_f32 v126, v100, v101
  v_cvt_pk_bf16_f32 v127, v102, v103
  v_exp_f32 v104, v104
  v_exp_f32 v105, v105
  v_exp_f32 v106, v106
  v_exp_f32 v107, v107
  v_exp_f32 v108, v108
  v_exp_f32 v109, v109
  v_exp_f32 v110, v110
  v_mfma_f32_16x16x32_bf16 v[88:91], v[152:155], v[32:35], 0
  v_cvt_pk_bf16_f32 v128, v104, v105
  v_cvt_pk_bf16_f32 v129, v106, v107
  v_mfma_f32_16x16x32_bf16 v[92:95], v[156:159], v[32:35], 0
  v_exp_f32 v111, v111
  v_mfma_f32_16x16x32_bf16 v[96:99], v[160:163], v[32:35], 0
  v_cvt_pk_bf16_f32 v130, v108, v109
  v_cvt_pk_bf16_f32 v131, v110, v111
  v_mfma_f32_16x16x32_bf16 v[100:103], v[164:167], v[32:35], 0
  v_exp_f32 v112, v112
  v_mfma_f32_16x16x32_bf16 v[64:67], v[176:179], v[120:123], v[64:67]
  v_exp_f32 v113, v113
  v_mfma_f32_16x16x32_bf16 v[64:67], v[184:187], v[124:127], v[64:67]
  v_exp_f32 v114, v114
  v_mfma_f32_16x16x32_bf16 v[68:71], v[188:191], v[124:127], v[68:71]
  s_waitcnt lgkmcnt(0)
  v_exp_f32 v115, v115
  v_mfma_f32_16x16x32_bf16 v[68:71], v[180:183], v[120:123], v[68:71]
  v_cvt_pk_bf16_f32 v132, v112, v113
  v_cvt_pk_bf16_f32 v133, v114, v115
  v_smfmac_f32_16x16x64_bf16 v[84:87], v[168:171], v[120:127], v255
  ds_read_b128 v[200:203], v248 offset:63488
  ds_read_b128 v[204:207], v248 offset:64512
  v_exp_f32 v116, v116
  v_cmp_gt_u32 vcc, s78, v20
  v_exp_f32 v117, v117
  v_exp_f32 v118, v118
  v_exp_f32 v119, v119
  v_cvt_pk_bf16_f32 v134, v116, v117
  v_cvt_pk_bf16_f32 v135, v118, v119
  v_exp_f32 v88, v88
  v_exp_f32 v89, v89
  v_exp_f32 v90, v90
  v_exp_f32 v91, v91
  v_exp_f32 v92, v92
  v_exp_f32 v93, v93
  v_exp_f32 v94, v94
  v_mfma_f32_16x16x32_bf16 v[104:107], v[152:155], v[36:39], 0
  s_cbranch_vccnz L_attspin1
L_attgo1:
  v_cvt_pk_bf16_f32 v120, v88, v89
  v_cvt_pk_bf16_f32 v121, v90, v91
  v_mfma_f32_16x16x32_bf16 v[108:111], v[156:159], v[36:39], 0
  s_add_u32 s78, s78, 4
  v_exp_f32 v95, v95
  v_mfma_f32_16x16x32_bf16 v[112:115], v[160:163], v[36:39], 0
  v_cvt_pk_bf16_f32 v122, v92, v93
  v_cvt_pk_bf16_f32 v123, v94, v95
  v_mfma_f32_16x16x32_bf16 v[116:119], v[164:167], v[36:39], 0
  v_exp_f32 v96, v96
  v_mfma_f32_16x16x32_bf16 v[72:75], v[176:179], v[128:131], v[72:75]
  s_cmp_eq_u32 s76, 0
  v_exp_f32 v97, v97
  v_mfma_f32_16x16x32_bf16 v[72:75], v[184:187], v[132:135], v[72:75]
  v_exp_f32 v98, v98
  v_mfma_f32_16x16x32_bf16 v[76:79], v[188:191], v[132:135], v[76:79]
  s_waitcnt lgkmcnt(0)
  v_exp_f32 v99, v99
  v_mfma_f32_16x16x32_bf16 v[76:79], v[180:183], v[128:131], v[76:79]
  v_cvt_pk_bf16_f32 v124, v96, v97
  v_cvt_pk_bf16_f32 v125, v98, v99
  v_smfmac_f32_16x16x64_bf16 v[84:87], v[172:175], v[128:135], v255
  ds_read_b128 v[136:139], v248 offset:0
  ds_read_b128 v[140:143], v248 offset:1024
  s_cbranch_scc1 L_regdma1_0
  buffer_load_dwordx4 v240, s[60:63], s79 offen offset:0 sc1 lds
  buffer_load_dwordx4 v241, s[60:63], s79 offen offset:1024 sc1 lds
L_nodma1_0:
  v_exp_f32 v100, v100
  v_exp_f32 v101, v101
  v_exp_f32 v102, v102
  v_exp_f32 v103, v103
  v_cvt_pk_bf16_f32 v126, v100, v101
  v_cvt_pk_bf16_f32 v127, v102, v103
  v_exp_f32 v104, v104
  v_exp_f32 v105, v105
  v_exp_f32 v106, v106
  v_exp_f32 v107, v107
  v_exp_f32 v108, v108
  v_exp_f32 v109, v109
  v_exp_f32 v110, v110
  v_mfma_f32_16x16x32_bf16 v[88:91], v[152:155], v[40:43], 0
  v_cvt_pk_bf16_f32 v128, v104, v105
  v_cvt_pk_bf16_f32 v129, v106, v107
  v_mfma_f32_16x16x32_bf16 v[92:95], v[156:159], v[40:43], 0
  v_exp_f32 v111, v111
  v_mfma_f32_16x16x32_bf16 v[96:99], v[160:163], v[40:43], 0
  v_cvt_pk_bf16_f32 v130, v108, v109
  v_cvt_pk_bf16_f32 v131, v110, v111
  v_mfma_f32_16x16x32_bf16 v[100:103], v[164:167], v[40:43], 0
  v_exp_f32 v112, v112
  v_mfma_f32_16x16x32_bf16 v[48:51], v[192:195], v[120:123], v[48:51]
  v_exp_f32 v113, v113
  v_mfma_f32_16x16x32_bf16 v[48:51], v[200:203], v[124:127], v[48:51]
  v_exp_f32 v114, v114
  v_mfma_f32_16x16x32_bf16 v[52:55], v[204:207], v[124:127], v[52:55]
  s_waitcnt lgkmcnt(0)
  v_exp_f32 v115, v115
  v_mfma_f32_16x16x32_bf16 v[52:55], v[196:199], v[120:123], v[52:55]
  v_cvt_pk_bf16_f32 v132, v112, v113
  v_cvt_pk_bf16_f32 v133, v114, v115
  v_smfmac_f32_16x16x64_bf16 v[80:83], v[168:171], v[120:127], v255
  ds_read_b128 v[144:147], v248 offset:4096
  ds_read_b128 v[148:151], v248 offset:5120
  s_cbranch_scc1 L_regdma1_2
  buffer_load_dwordx4 v242, s[60:63], s79 offen offset:2048 sc1 lds
  buffer_load_dwordx4 v243, s[60:63], s79 offen offset:3072 sc1 lds
L_nodma1_2:
  v_exp_f32 v116, v116
  v_exp_f32 v117, v117
  v_exp_f32 v118, v118
  v_exp_f32 v119, v119
  v_cvt_pk_bf16_f32 v134, v116, v117
  v_cvt_pk_bf16_f32 v135, v118, v119
  v_exp_f32 v88, v88
  v_exp_f32 v89, v89
  v_exp_f32 v90, v90
  v_exp_f32 v91, v91
  v_exp_f32 v92, v92
  v_exp_f32 v93, v93
  v_exp_f32 v94, v94
  v_mfma_f32_16x16x32_bf16 v[104:107], v[152:155], v[44:47], 0
  v_cvt_pk_bf16_f32 v120, v88, v89
  v_cvt_pk_bf16_f32 v121, v90, v91
  v_mfma_f32_16x16x32_bf16 v[108:111], v[156:159], v[44:47], 0
  v_exp_f32 v95, v95
  v_mfma_f32_16x16x32_bf16 v[112:115], v[160:163], v[44:47], 0
  v_cvt_pk_bf16_f32 v122, v92, v93
  v_cvt_pk_bf16_f32 v123, v94, v95
  v_mfma_f32_16x16x32_bf16 v[116:119], v[164:167], v[44:47], 0
  v_exp_f32 v96, v96
  v_mfma_f32_16x16x32_bf16 v[56:59], v[192:195], v[128:131], v[56:59]
  v_exp_f32 v97, v97
  v_mfma_f32_16x16x32_bf16 v[56:59], v[200:203], v[132:135], v[56:59]
  v_exp_f32 v98, v98
  v_mfma_f32_16x16x32_bf16 v[60:63], v[204:207], v[132:135], v[60:63]
  s_waitcnt lgkmcnt(0)
  v_exp_f32 v99, v99
  v_mfma_f32_16x16x32_bf16 v[60:63], v[196:199], v[128:131], v[60:63]
  v_cvt_pk_bf16_f32 v124, v96, v97
  v_cvt_pk_bf16_f32 v125, v98, v99
  v_smfmac_f32_16x16x64_bf16 v[80:83], v[172:175], v[128:135], v255
  ds_read_b128 v[176:179], v248 offset:2048
  ds_read_b128 v[180:183], v248 offset:3072
  v_exp_f32 v100, v100
  v_exp_f32 v101, v101
  v_exp_f32 v102, v102
  v_exp_f32 v103, v103
  v_cvt_pk_bf16_f32 v126, v100, v101
  v_cvt_pk_bf16_f32 v127, v102, v103
  v_exp_f32 v104, v104
  v_exp_f32 v105, v105
  v_exp_f32 v106, v106
  v_exp_f32 v107, v107
  v_exp_f32 v108, v108
  v_exp_f32 v109, v109
  v_exp_f32 v110, v110
  v_mfma_f32_16x16x32_bf16 v[88:91], v[136:139], v[32:35], 0
  s_add_u32 s79, s79, s77
  v_cvt_pk_bf16_f32 v128, v104, v105
  v_cvt_pk_bf16_f32 v129, v106, v107
  v_mfma_f32_16x16x32_bf16 v[92:95], v[140:143], v[32:35], 0
  v_exp_f32 v111, v111
  v_mfma_f32_16x16x32_bf16 v[96:99], v[144:147], v[32:35], 0
  v_cvt_pk_bf16_f32 v130, v108, v109
  v_cvt_pk_bf16_f32 v131, v110, v111
  v_mfma_f32_16x16x32_bf16 v[100:103], v[148:151], v[32:35], 0
  v_exp_f32 v112, v112
  v_mfma_f32_16x16x32_bf16 v[64:67], v[192:195], v[120:123], v[64:67]
  v_exp_f32 v113, v113
  v_mfma_f32_16x16x32_bf16 v[64:67], v[200:203], v[124:127], v[64:67]
  v_exp_f32 v114, v114
  v_mfma_f32_16x16x32_bf16 v[68:71], v[204:207], v[124:127], v[68:71]
  s_waitcnt lgkmcnt(0)
  v_exp_f32 v115, v115
  v_mfma_f32_16x16x32_bf16 v[68:71], v[196:199], v[120:123], v[68:71]
  v_cvt_pk_bf16_f32 v132, v112, v113
  v_cvt_pk_bf16_f32 v133, v114, v115
  v_smfmac_f32_16x16x64_bf16 v[84:87], v[168:171], v[120:127], v255
  ds_read_b128 v[184:187], v248 offset:6144
  ds_read_b128 v[188:191], v248 offset:7168
  v_exp_f32 v116, v116
  v_exp_f32 v117, v117
  v_exp_f32 v118, v118
  v_exp_f32 v119, v119
  v_cvt_pk_bf16_f32 v134, v116, v117
  v_cvt_pk_bf16_f32 v135, v118, v119
  v_exp_f32 v88, v88
  v_exp_f32 v89, v89
  v_exp_f32 v90, v90
  v_exp_f32 v91, v91
  v_exp_f32 v92, v92
  v_exp_f32 v93, v93
  v_exp_f32 v94, v94
  v_mfma_f32_16x16x32_bf16 v[104:107], v[136:139], v[36:39], 0
  v_cvt_pk_bf16_f32 v120, v88, v89
  v_cvt_pk_bf16_f32 v121, v90, v91
  v_mfma_f32_16x16x32_bf16 v[108:111], v[140:143], v[36:39], 0
  v_exp_f32 v95, v95
  v_mfma_f32_16x16x32_bf16 v[112:115], v[144:147], v[36:39], 0
  v_cvt_pk_bf16_f32 v122, v92, v93
  v_cvt_pk_bf16_f32 v123, v94, v95
  v_mfma_f32_16x16x32_bf16 v[116:119], v[148:151], v[36:39], 0
  v_exp_f32 v96, v96
  v_mfma_f32_16x16x32_bf16 v[72:75], v[192:195], v[128:131], v[72:75]
  v_exp_f32 v97, v97
  v_mfma_f32_16x16x32_bf16 v[72:75], v[200:203], v[132:135], v[72:75]
  v_exp_f32 v98, v98
  v_mfma_f32_16x16x32_bf16 v[76:79], v[204:207], v[132:135], v[76:79]
  s_waitcnt vmcnt(4) lgkmcnt(0)
  v_exp_f32 v99, v99
  v_mfma_f32_16x16x32_bf16 v[76:79], v[196:199], v[128:131], v[76:79]
  v_cvt_pk_bf16_f32 v124, v96, v97
  v_cvt_pk_bf16_f32 v125, v98, v99
  v_smfmac_f32_16x16x64_bf16 v[84:87], v[172:175], v[128:135], v255
  ds_read_b128 v[152:155], v248 offset:8192
  ds_read_b128 v[156:159], v248 offset:9216
  ds_add_u32 v251, v252
  v_exp_f32 v100, v100
  v_exp_f32 v101, v101
  v_exp_f32 v102, v102
  v_exp_f32 v103, v103
  v_cvt_pk_bf16_f32 v126, v100, v101
  v_cvt_pk_bf16_f32 v127, v102, v103
  v_exp_f32 v104, v104
  v_exp_f32 v105, v105
  v_exp_f32 v106, v106
  v_exp_f32 v107, v107
  v_exp_f32 v108, v108
  v_exp_f32 v109, v109
  v_exp_f32 v110, v110
  v_mfma_f32_16x16x32_bf16 v[88:91], v[136:139], v[40:43], 0
  s_add_u32 m0, s80, 49152
  v_cvt_pk_bf16_f32 v128, v104, v105
  v_cvt_pk_bf16_f32 v129, v106, v107
  v_mfma_f32_16x16x32_bf16 v[92:95], v[140:143], v[40:43], 0
  v_exp_f32 v111, v111
  v_mfma_f32_16x16x32_bf16 v[96:99], v[144:147], v[40:43], 0
  v_cvt_pk_bf16_f32 v130, v108, v109
  v_cvt_pk_bf16_f32 v131, v110, v111
  v_mfma_f32_16x16x32_bf16 v[100:103], v[148:151], v[40:43], 0
  v_exp_f32 v112, v112
  v_mfma_f32_16x16x32_bf16 v[48:51], v[176:179], v[120:123], v[48:51]
  v_exp_f32 v113, v113
  v_mfma_f32_16x16x32_bf16 v[48:51], v[184:187], v[124:127], v[48:51]
  v_exp_f32 v114, v114
  v_mfma_f32_16x16x32_bf16 v[52:55], v[188:191], v[124:127], v[52:55]
  s_waitcnt lgkmcnt(1)
  v_exp_f32 v115, v115
  v_mfma_f32_16x16x32_bf16 v[52:55], v[180:183], v[120:123], v[52:55]
  v_cvt_pk_bf16_f32 v132, v112, v113
  v_cvt_pk_bf16_f32 v133, v114, v115
  v_smfmac_f32_16x16x64_bf16 v[80:83], v[168:171], v[120:127], v255
  ds_read_b128 v[160:163], v248 offset:12288
  ds_read_b128 v[164:167], v248 offset:13312
  v_exp_f32 v116, v116
  v_exp_f32 v117, v117
  v_exp_f32 v118, v118
  v_exp_f32 v119, v119
  v_cvt_pk_bf16_f32 v134, v116, v117
  v_cvt_pk_bf16_f32 v135, v118, v119
  v_exp_f32 v88, v88
  v_exp_f32 v89, v89
  v_exp_f32 v90, v90
  v_exp_f32 v91, v91
  v_exp_f32 v92, v92
  v_exp_f32 v93, v93
  v_exp_f32 v94, v94
  v_mfma_f32_16x16x32_bf16 v[104:107], v[136:139], v[44:47], 0
  v_cvt_pk_bf16_f32 v120, v88, v89
  v_cvt_pk_bf16_f32 v121, v90, v91
  v_mfma_f32_16x16x32_bf16 v[108:111], v[140:143], v[44:47], 0
  v_exp_f32 v95, v95
  v_mfma_f32_16x16x32_bf16 v[112:115], v[144:147], v[44:47], 0
  v_cvt_pk_bf16_f32 v122, v92, v93
  v_cvt_pk_bf16_f32 v123, v94, v95
  v_mfma_f32_16x16x32_bf16 v[116:119], v[148:151], v[44:47], 0
  v_exp_f32 v96, v96
  v_mfma_f32_16x16x32_bf16 v[56:59], v[176:179], v[128:131], v[56:59]
  v_exp_f32 v97, v97
  v_mfma_f32_16x16x32_bf16 v[56:59], v[184:187], v[132:135], v[56:59]
  v_exp_f32 v98, v98
  v_mfma_f32_16x16x32_bf16 v[60:63], v[188:191], v[132:135], v[60:63]
  s_waitcnt lgkmcnt(0)
  v_exp_f32 v99, v99
  v_mfma_f32_16x16x32_bf16 v[60:63], v[180:183], v[128:131], v[60:63]
  v_cvt_pk_bf16_f32 v124, v96, v97
  v_cvt_pk_bf16_f32 v125, v98, v99
  v_smfmac_f32_16x16x64_bf16 v[80:83], v[172:175], v[128:135], v255
  ds_read_b128 v[192:195], v248 offset:10240
  ds_read_b128 v[196:199], v248 offset:11264
  ds_read_b32 v20, v249
  v_exp_f32 v100, v100
  v_exp_f32 v101, v101
  v_exp_f32 v102, v102
  v_exp_f32 v103, v103
  v_cvt_pk_bf16_f32 v126, v100, v101
  v_cvt_pk_bf16_f32 v127, v102, v103
  v_exp_f32 v104, v104
  v_exp_f32 v105, v105
  v_exp_f32 v106, v106
  v_exp_f32 v107, v107
  v_exp_f32 v108, v108
  v_exp_f32 v109, v109
  v_exp_f32 v110, v110
  v_mfma_f32_16x16x32_bf16 v[88:91], v[152:155], v[32:35], 0
  v_cvt_pk_bf16_f32 v128, v104, v105
  v_cvt_pk_bf16_f32 v129, v106, v107
  v_mfma_f32_16x16x32_bf16 v[92:95], v[156:159], v[32:35], 0
  v_exp_f32 v111, v111
  v_mfma_f32_16x16x32_bf16 v[96:99], v[160:163], v[32:35], 0
  v_cvt_pk_bf16_f32 v130, v108, v109
  v_cvt_pk_bf16_f32 v131, v110, v111
  v_mfma_f32_16x16x32_bf16 v[100:103], v[164:167], v[32:35], 0
  v_exp_f32 v112, v112
  v_mfma_f32_16x16x32_bf16 v[64:67], v[176:179], v[120:123], v[64:67]
  v_exp_f32 v113, v113
  v_mfma_f32_16x16x32_bf16 v[64:67], v[184:187], v[124:127], v[64:67]
  v_exp_f32 v114, v114
  v_mfma_f32_16x16x32_bf16 v[68:71], v[188:191], v[124:127], v[68:71]
  s_waitcnt lgkmcnt(0)
  v_exp_f32 v115, v115
  v_mfma_f32_16x16x32_bf16 v[68:71], v[180:183], v[120:123], v[68:71]
  v_cvt_pk_bf16_f32 v132, v112, v113
  v_cvt_pk_bf16_f32 v133, v114, v115
  v_smfmac_f32_16x16x64_bf16 v[84:87], v[168:171], v[120:127], v255
  ds_read_b128 v[200:203], v248 offset:14336
  ds_read_b128 v[204:207], v248 offset:15360
  v_exp_f32 v116, v116
  v_cmp_gt_u32 vcc, s78, v20
  v_exp_f32 v117, v117
  v_exp_f32 v118, v118
  v_exp_f32 v119, v119
  v_cvt_pk_bf16_f32 v134, v116, v117
  v_cvt_pk_bf16_f32 v135, v118, v119
  v_exp_f32 v88, v88
  v_exp_f32 v89, v89
  v_exp_f32 v90, v90
  v_exp_f32 v91, v91
  v_exp_f32 v92, v92
  v_exp_f32 v93, v93
  v_exp_f32 v94, v94
  v_mfma_f32_16x16x32_bf16 v[104:107], v[152:155], v[36:39], 0
  s_cbranch_vccnz L_attspin2
L_attgo2:
  v_cvt_pk_bf16_f32 v120, v88, v89
  v_cvt_pk_bf16_f32 v121, v90, v91
  v_mfma_f32_16x16x32_bf16 v[108:111], v[156:159], v[36:39], 0
  s_add_u32 s78, s78, 4
  v_exp_f32 v95, v95
  v_mfma_f32_16x16x32_bf16 v[112:115], v[160:163], v[36:39], 0
  v_cvt_pk_bf16_f32 v122, v92, v93
  v_cvt_pk_bf16_f32 v123, v94, v95
  v_mfma_f32_16x16x32_bf16 v[116:119], v[164:167], v[36:39], 0
  v_exp_f32 v96, v96
  v_mfma_f32_16x16x32_bf16 v[72:75], v[176:179], v[128:131], v[72:75]
  s_cmp_eq_u32 s76, 0
  v_exp_f32 v97, v97
  v_mfma_f32_16x16x32_bf16 v[72:75], v[184:187], v[132:135], v[72:75]
  v_exp_f32 v98, v98
  v_mfma_f32_16x16x32_bf16 v[76:79], v[188:191], v[132:135], v[76:79]
  s_waitcnt lgkmcnt(0)
  v_exp_f32 v99, v99
  v_mfma_f32_16x16x32_bf16 v[76:79], v[180:183], v[128:131], v[76:79]
  v_cvt_pk_bf16_f32 v124, v96, v97
  v_cvt_pk_bf16_f32 v125, v98, v99
  v_smfmac_f32_16x16x64_bf16 v[84:87], v[172:175], v[128:135], v255
  ds_read_b128 v[136:139], v248 offset:16384
  ds_read_b128 v[140:143], v248 offset:17408
  s_cbranch_scc1 L_regdma2_0
  buffer_load_dwordx4 v240, s[60:63], s79 offen offset:0 sc1 lds
  buffer_load_dwordx4 v241, s[60:63], s79 offen offset:1024 sc1 lds
L_nodma2_0:
  v_exp_f32 v100, v100
  v_exp_f32 v101, v101
  v_exp_f32 v102, v102
  v_exp_f32 v103, v103
  v_cvt_pk_bf16_f32 v126, v100, v101
  v_cvt_pk_bf16_f32 v127, v102, v103
  v_exp_f32 v104, v104
  v_exp_f32 v105, v105
  v_exp_f32 v106, v106
  v_exp_f32 v107, v107
  v_exp_f32 v108, v108
  v_exp_f32 v109, v109
  v_exp_f32 v110, v110
  v_mfma_f32_16x16x32_bf16 v[88:91], v[152:155], v[40:43], 0
  v_cvt_pk_bf16_f32 v128, v104, v105
  v_cvt_pk_bf16_f32 v129, v106, v107
  v_mfma_f32_16x16x32_bf16 v[92:95], v[156:159], v[40:43], 0
  v_exp_f32 v111, v111
  v_mfma_f32_16x16x32_bf16 v[96:99], v[160:163], v[40:43], 0
  v_cvt_pk_bf16_f32 v130, v108, v109
  v_cvt_pk_bf16_f32 v131, v110, v111
  v_mfma_f32_16x16x32_bf16 v[100:103], v[164:167], v[40:43], 0
  v_exp_f32 v112, v112
  v_mfma_f32_16x16x32_bf16 v[48:51], v[192:195], v[120:123], v[48:51]
  v_exp_f32 v113, v113
  v_mfma_f32_16x16x32_bf16 v[48:51], v[200:203], v[124:127], v[48:51]
  v_exp_f32 v114, v114
  v_mfma_f32_16x16x32_bf16 v[52:55], v[204:207], v[124:127], v[52:55]
  s_waitcnt lgkmcnt(0)
  v_exp_f32 v115, v115
  v_mfma_f32_16x16x32_bf16 v[52:55], v[196:199], v[120:123], v[52:55]
  v_cvt_pk_bf16_f32 v132, v112, v113
  v_cvt_pk_bf16_f32 v133, v114, v115
  v_smfmac_f32_16x16x64_bf16 v[80:83], v[168:171], v[120:127], v255
  ds_read_b128 v[144:147], v248 offset:20480
  ds_read_b128 v[148:151], v248 offset:21504
  s_cbranch_scc1 L_regdma2_2
  buffer_load_dwordx4 v242, s[60:63], s79 offen offset:2048 sc1 lds
  buffer_load_dwordx4 v243, s[60:63], s79 offen offset:3072 sc1 lds
L_nodma2_2:
  v_exp_f32 v116, v116
  v_exp_f32 v117, v117
  v_exp_f32 v118, v118
  v_exp_f32 v119, v119
  v_cvt_pk_bf16_f32 v134, v116, v117
  v_cvt_pk_bf16_f32 v135, v118, v119
  v_exp_f32 v88, v88
  v_exp_f32 v89, v89
  v_exp_f32 v90, v90
  v_exp_f32 v91, v91
  v_exp_f32 v92, v92
  v_exp_f32 v93, v93
  v_exp_f32 v94, v94
  v_mfma_f32_16x16x32_bf16 v[104:107], v[152:155], v[44:47], 0
  v_cvt_pk_bf16_f32 v120, v88, v89
  v_cvt_pk_bf16_f32 v121, v90, v91
  v_mfma_f32_16x16x32_bf16 v[108:111], v[156:159], v[44:47], 0
  v_exp_f32 v95, v95
  v_mfma_f32_16x16x32_bf16 v[112:115], v[160:163], v[44:47], 0
  v_cvt_pk_bf16_f32 v122, v92, v93
  v_cvt_pk_bf16_f32 v123, v94, v95
  v_mfma_f32_16x16x32_bf16 v[116:119], v[164:167], v[44:47], 0
  v_exp_f32 v96, v96
  v_mfma_f32_16x16x32_bf16 v[56:59], v[192:195], v[128:131], v[56:59]
  v_exp_f32 v97, v97
  v_mfma_f32_16x16x32_bf16 v[56:59], v[200:203], v[132:135], v[56:59]
  v_exp_f32 v98, v98
  v_mfma_f32_16x16x32_bf16 v[60:63], v[204:207], v[132:135], v[60:63]
  s_waitcnt lgkmcnt(0)
  v_exp_f32 v99, v99
  v_mfma_f32_16x16x32_bf16 v[60:63], v[196:199], v[128:131], v[60:63]
  v_cvt_pk_bf16_f32 v124, v96, v97
  v_cvt_pk_bf16_f32 v125, v98, v99
  v_smfmac_f32_16x16x64_bf16 v[80:83], v[172:175], v[128:135], v255
  ds_read_b128 v[176:179], v248 offset:18432
  ds_read_b128 v[180:183], v248 offset:19456
  v_exp_f32 v100, v100
  v_exp_f32 v101, v101
  v_exp_f32 v102, v102
  v_exp_f32 v103, v103
  v_cvt_pk_bf16_f32 v126, v100, v101
  v_cvt_pk_bf16_f32 v127, v102, v103
  v_exp_f32 v104, v104
  v_exp_f32 v105, v105
  v_exp_f32 v106, v106
  v_exp_f32 v107, v107
  v_exp_f32 v108, v108
  v_exp_f32 v109, v109
  v_exp_f32 v110, v110
  v_mfma_f32_16x16x32_bf16 v[88:91], v[136:139], v[32:35], 0
  s_add_u32 s79, s79, s81
  v_cvt_pk_bf16_f32 v128, v104, v105
  v_cvt_pk_bf16_f32 v129, v106, v107
  v_mfma_f32_16x16x32_bf16 v[92:95], v[140:143], v[32:35], 0
  v_exp_f32 v111, v111
  v_mfma_f32_16x16x32_bf16 v[96:99], v[144:147], v[32:35], 0
  v_cvt_pk_bf16_f32 v130, v108, v109
  v_cvt_pk_bf16_f32 v131, v110, v111
  v_mfma_f32_16x16x32_bf16 v[100:103], v[148:151], v[32:35], 0
  v_exp_f32 v112, v112
  v_mfma_f32_16x16x32_bf16 v[64:67], v[192:195], v[120:123], v[64:67]
  v_exp_f32 v113, v113
  v_mfma_f32_16x16x32_bf16 v[64:67], v[200:203], v[124:127], v[64:67]
  v_exp_f32 v114, v114
  v_mfma_f32_16x16x32_bf16 v[68:71], v[204:207], v[124:127], v[68:71]
  s_waitcnt lgkmcnt(0)
  v_exp_f32 v115, v115
  v_mfma_f32_16x16x32_bf16 v[68:71], v[196:199], v[120:123], v[68:71]
  v_cvt_pk_bf16_f32 v132, v112, v113
  v_cvt_pk_bf16_f32 v133, v114, v115
  v_smfmac_f32_16x16x64_bf16 v[84:87], v[168:171], v[120:127], v255
  ds_read_b128 v[184:187], v248 offset:22528
  ds_read_b128 v[188:191], v248 offset:23552
  v_exp_f32 v116, v116
  v_exp_f32 v117, v117
  v_exp_f32 v118, v118
  v_exp_f32 v119, v119
  v_cvt_pk_bf16_f32 v134, v116, v117
  v_cvt_pk_bf16_f32 v135, v118, v119
  v_exp_f32 v88, v88
  v_exp_f32 v89, v89
  v_exp_f32 v90, v90
  v_exp_f32 v91, v91
  v_exp_f32 v92, v92
  v_exp_f32 v93, v93
  v_exp_f32 v94, v94
  v_mfma_f32_16x16x32_bf16 v[104:107], v[136:139], v[36:39], 0
  v_cvt_pk_bf16_f32 v120, v88, v89
  v_cvt_pk_bf16_f32 v121, v90, v91
  v_mfma_f32_16x16x32_bf16 v[108:111], v[140:143], v[36:39], 0
  v_exp_f32 v95, v95
  v_mfma_f32_16x16x32_bf16 v[112:115], v[144:147], v[36:39], 0
  v_cvt_pk_bf16_f32 v122, v92, v93
  v_cvt_pk_bf16_f32 v123, v94, v95
  v_mfma_f32_16x16x32_bf16 v[116:119], v[148:151], v[36:39], 0
  v_exp_f32 v96, v96
  v_mfma_f32_16x16x32_bf16 v[72:75], v[192:195], v[128:131], v[72:75]
  v_exp_f32 v97, v97
  v_mfma_f32_16x16x32_bf16 v[72:75], v[200:203], v[132:135], v[72:75]
  v_exp_f32 v98, v98
  v_mfma_f32_16x16x32_bf16 v[76:79], v[204:207], v[132:135], v[76:79]
  s_waitcnt vmcnt(4) lgkmcnt(0)
  v_exp_f32 v99, v99
  v_mfma_f32_16x16x32_bf16 v[76:79], v[196:199], v[128:131], v[76:79]
  v_cvt_pk_bf16_f32 v124, v96, v97
  v_cvt_pk_bf16_f32 v125, v98, v99
  v_smfmac_f32_16x16x64_bf16 v[84:87], v[172:175], v[128:135], v255
  ds_read_b128 v[152:155], v248 offset:24576
  ds_read_b128 v[156:159], v248 offset:25600
  ds_add_u32 v251, v252
  v_exp_f32 v100, v100
  v_exp_f32 v101, v101
  v_exp_f32 v102, v102
  v_exp_f32 v103, v103
  v_cvt_pk_bf16_f32 v126, v100, v101
  v_cvt_pk_bf16_f32 v127, v102, v103
  v_exp_f32 v104, v104
  v_exp_f32 v105, v105
  v_exp_f32 v106, v106
  v_exp_f32 v107, v107
  v_exp_f32 v108, v108
  v_exp_f32 v109, v109
  v_exp_f32 v110, v110
  v_mfma_f32_16x16x32_bf16 v[88:91], v[136:139], v[40:43], 0
  s_add_u32 m0, s80, 0
  v_cvt_pk_bf16_f32 v128, v104, v105
  v_cvt_pk_bf16_f32 v129, v106, v107
  v_mfma_f32_16x16x32_bf16 v[92:95], v[140:143], v[40:43], 0
  v_exp_f32 v111, v111
  v_mfma_f32_16x16x32_bf16 v[96:99], v[144:147], v[40:43], 0
  v_cvt_pk_bf16_f32 v130, v108, v109
  v_cvt_pk_bf16_f32 v131, v110, v111
  v_mfma_f32_16x16x32_bf16 v[100:103], v[148:151], v[40:43], 0
  v_exp_f32 v112, v112
  v_mfma_f32_16x16x32_bf16 v[48:51], v[176:179], v[120:123], v[48:51]
  v_exp_f32 v113, v113
  v_mfma_f32_16x16x32_bf16 v[48:51], v[184:187], v[124:127], v[48:51]
  v_exp_f32 v114, v114
  v_mfma_f32_16x16x32_bf16 v[52:55], v[188:191], v[124:127], v[52:55]
  s_waitcnt lgkmcnt(1)
  v_exp_f32 v115, v115
  v_mfma_f32_16x16x32_bf16 v[52:55], v[180:183], v[120:123], v[52:55]
  v_cvt_pk_bf16_f32 v132, v112, v113
  v_cvt_pk_bf16_f32 v133, v114, v115
  v_smfmac_f32_16x16x64_bf16 v[80:83], v[168:171], v[120:127], v255
  ds_read_b128 v[160:163], v248 offset:28672
  ds_read_b128 v[164:167], v248 offset:29696
  v_exp_f32 v116, v116
  v_exp_f32 v117, v117
  v_exp_f32 v118, v118
  v_exp_f32 v119, v119
  v_cvt_pk_bf16_f32 v134, v116, v117
  v_cvt_pk_bf16_f32 v135, v118, v119
  v_exp_f32 v88, v88
  v_exp_f32 v89, v89
  v_exp_f32 v90, v90
  v_exp_f32 v91, v91
  v_exp_f32 v92, v92
  v_exp_f32 v93, v93
  v_exp_f32 v94, v94
  v_mfma_f32_16x16x32_bf16 v[104:107], v[136:139], v[44:47], 0
  v_cvt_pk_bf16_f32 v120, v88, v89
  v_cvt_pk_bf16_f32 v121, v90, v91
  v_mfma_f32_16x16x32_bf16 v[108:111], v[140:143], v[44:47], 0
  v_exp_f32 v95, v95
  v_mfma_f32_16x16x32_bf16 v[112:115], v[144:147], v[44:47], 0
  v_cvt_pk_bf16_f32 v122, v92, v93
  v_cvt_pk_bf16_f32 v123, v94, v95
  v_mfma_f32_16x16x32_bf16 v[116:119], v[148:151], v[44:47], 0
  v_exp_f32 v96, v96
  v_mfma_f32_16x16x32_bf16 v[56:59], v[176:179], v[128:131], v[56:59]
  v_exp_f32 v97, v97
  v_mfma_f32_16x16x32_bf16 v[56:59], v[184:187], v[132:135], v[56:59]
  v_exp_f32 v98, v98
  v_mfma_f32_16x16x32_bf16 v[60:63], v[188:191], v[132:135], v[60:63]
  s_waitcnt lgkmcnt(0)
  v_exp_f32 v99, v99
  v_mfma_f32_16x16x32_bf16 v[60:63], v[180:183], v[128:131], v[60:63]
  v_cvt_pk_bf16_f32 v124, v96, v97
  v_cvt_pk_bf16_f32 v125, v98, v99
  v_smfmac_f32_16x16x64_bf16 v[80:83], v[172:175], v[128:135], v255
  ds_read_b128 v[192:195], v248 offset:26624
  ds_read_b128 v[196:199], v248 offset:27648
  ds_read_b32 v20, v249
  v_exp_f32 v100, v100
  v_exp_f32 v101, v101
  v_exp_f32 v102, v102
  v_exp_f32 v103, v103
  v_cvt_pk_bf16_f32 v126, v100, v101
  v_cvt_pk_bf16_f32 v127, v102, v103
  v_exp_f32 v104, v104
  v_exp_f32 v105, v105
  v_exp_f32 v106, v106
  v_exp_f32 v107, v107
  v_exp_f32 v108, v108
  v_exp_f32 v109, v109
  v_exp_f32 v110, v110
  v_mfma_f32_16x16x32_bf16 v[88:91], v[152:155], v[32:35], 0
  v_cvt_pk_bf16_f32 v128, v104, v105
  v_cvt_pk_bf16_f32 v129, v106, v107
  v_mfma_f32_16x16x32_bf16 v[92:95], v[156:159], v[32:35], 0
  v_exp_f32 v111, v111
  v_mfma_f32_16x16x32_bf16 v[96:99], v[160:163], v[32:35], 0
  v_cvt_pk_bf16_f32 v130, v108, v109
  v_cvt_pk_bf16_f32 v131, v110, v111
  v_mfma_f32_16x16x32_bf16 v[100:103], v[164:167], v[32:35], 0
  v_exp_f32 v112, v112
  v_mfma_f32_16x16x32_bf16 v[64:67], v[176:179], v[120:123], v[64:67]
  v_exp_f32 v113, v113
  v_mfma_f32_16x16x32_bf16 v[64:67], v[184:187], v[124:127], v[64:67]
  v_exp_f32 v114, v114
  v_mfma_f32_16x16x32_bf16 v[68:71], v[188:191], v[124:127], v[68:71]
  s_waitcnt lgkmcnt(0)
  v_exp_f32 v115, v115
  v_mfma_f32_16x16x32_bf16 v[68:71], v[180:183], v[120:123], v[68:71]
  v_cvt_pk_bf16_f32 v132, v112, v113
  v_cvt_pk_bf16_f32 v133, v114, v115
  v_smfmac_f32_16x16x64_bf16 v[84:87], v[168:171], v[120:127], v255
  ds_read_b128 v[200:203], v248 offset:30720
  ds_read_b128 v[204:207], v248 offset:31744
  v_exp_f32 v116, v116
  v_cmp_gt_u32 vcc, s78, v20
  v_exp_f32 v117, v117
  v_exp_f32 v118, v118
  v_exp_f32 v119, v119
  v_cvt_pk_bf16_f32 v134, v116, v117
  v_cvt_pk_bf16_f32 v135, v118, v119
  v_exp_f32 v88, v88
  v_exp_f32 v89, v89
  v_exp_f32 v90, v90
  v_exp_f32 v91, v91
  v_exp_f32 v92, v92
  v_exp_f32 v93, v93
  v_exp_f32 v94, v94
  v_mfma_f32_16x16x32_bf16 v[104:107], v[152:155], v[36:39], 0
  s_cbranch_vccnz L_attspin3
L_attgo3:
  v_cvt_pk_bf16_f32 v120, v88, v89
  v_cvt_pk_bf16_f32 v121, v90, v91
  v_mfma_f32_16x16x32_bf16 v[108:111], v[156:159], v[36:39], 0
  s_add_u32 s78, s78, 4
  v_exp_f32 v95, v95
  v_mfma_f32_16x16x32_bf16 v[112:115], v[160:163], v[36:39], 0
  v_cvt_pk_bf16_f32 v122, v92, v93
  v_cvt_pk_bf16_f32 v123, v94, v95
  v_mfma_f32_16x16x32_bf16 v[116:119], v[164:167], v[36:39], 0
  v_exp_f32 v96, v96
  v_mfma_f32_16x16x32_bf16 v[72:75], v[176:179], v[128:131], v[72:75]
  v_exp_f32 v97, v97
  v_mfma_f32_16x16x32_bf16 v[72:75], v[184:187], v[132:135], v[72:75]
  v_exp_f32 v98, v98
  v_mfma_f32_16x16x32_bf16 v[76:79], v[188:191], v[132:135], v[76:79]
  s_waitcnt lgkmcnt(0)
  v_exp_f32 v99, v99
  v_mfma_f32_16x16x32_bf16 v[76:79], v[180:183], v[128:131], v[76:79]
  v_cvt_pk_bf16_f32 v124, v96, v97
  v_cvt_pk_bf16_f32 v125, v98, v99
  v_smfmac_f32_16x16x64_bf16 v[84:87], v[172:175], v[128:135], v255
  ds_read_b128 v[136:139], v248 offset:32768
  ds_read_b128 v[140:143], v248 offset:33792
  buffer_load_dwordx4 v240, s[60:63], s79 offen offset:0 sc1 lds
  buffer_load_dwordx4 v241, s[60:63], s79 offen offset:1024 sc1 lds
  v_exp_f32 v100, v100
  v_exp_f32 v101, v101
  v_exp_f32 v102, v102
  v_exp_f32 v103, v103
  v_cvt_pk_bf16_f32 v126, v100, v101
  v_cvt_pk_bf16_f32 v127, v102, v103
  v_exp_f32 v104, v104
  v_exp_f32 v105, v105
  v_exp_f32 v106, v106
  v_exp_f32 v107, v107
  v_exp_f32 v108, v108
  v_exp_f32 v109, v109
  v_exp_f32 v110, v110
  v_mfma_f32_16x16x32_bf16 v[88:91], v[152:155], v[40:43], 0
  v_cvt_pk_bf16_f32 v128, v104, v105
  v_cvt_pk_bf16_f32 v129, v106, v107
  v_mfma_f32_16x16x32_bf16 v[92:95], v[156:159], v[40:43], 0
  v_exp_f32 v111, v111
  v_mfma_f32_16x16x32_bf16 v[96:99], v[160:163], v[40:43], 0
  v_cvt_pk_bf16_f32 v130, v108, v109
  v_cvt_pk_bf16_f32 v131, v110, v111
  v_mfma_f32_16x16x32_bf16 v[100:103], v[164:167], v[40:43], 0
  v_exp_f32 v112, v112
  v_mfma_f32_16x16x32_bf16 v[48:51], v[192:195], v[120:123], v[48:51]
  v_exp_f32 v113, v113
  v_mfma_f32_16x16x32_bf16 v[48:51], v[200:203], v[124:127], v[48:51]
  v_exp_f32 v114, v114
  v_mfma_f32_16x16x32_bf16 v[52:55], v[204:207], v[124:127], v[52:55]
  s_waitcnt lgkmcnt(0)
  v_exp_f32 v115, v115
  v_mfma_f32_16x16x32_bf16 v[52:55], v[196:199], v[120:123], v[52:55]
  v_cvt_pk_bf16_f32 v132, v112, v113
  v_cvt_pk_bf16_f32 v133, v114, v115
  v_smfmac_f32_16x16x64_bf16 v[80:83], v[168:171], v[120:127], v255
  ds_read_b128 v[144:147], v248 offset:36864
  ds_read_b128 v[148:151], v248 offset:37888
  buffer_load_dwordx4 v242, s[60:63], s79 offen offset:2048 sc1 lds
  buffer_load_dwordx4 v243, s[60:63], s79 offen offset:3072 sc1 lds
  v_exp_f32 v116, v116
  v_exp_f32 v117, v117
  v_exp_f32 v118, v118
  v_exp_f32 v119, v119
  v_cvt_pk_bf16_f32 v134, v116, v117
  v_cvt_pk_bf16_f32 v135, v118, v119
  v_exp_f32 v88, v88
  v_exp_f32 v89, v89
  v_exp_f32 v90, v90
  v_exp_f32 v91, v91
  v_exp_f32 v92, v92
  v_exp_f32 v93, v93
  v_exp_f32 v94, v94
  v_mfma_f32_16x16x32_bf16 v[104:107], v[152:155], v[44:47], 0
  v_cvt_pk_bf16_f32 v120, v88, v89
  v_cvt_pk_bf16_f32 v121, v90, v91
  v_mfma_f32_16x16x32_bf16 v[108:111], v[156:159], v[44:47], 0
  v_exp_f32 v95, v95
  v_mfma_f32_16x16x32_bf16 v[112:115], v[160:163], v[44:47], 0
  v_cvt_pk_bf16_f32 v122, v92, v93
  v_cvt_pk_bf16_f32 v123, v94, v95
  v_mfma_f32_16x16x32_bf16 v[116:119], v[164:167], v[44:47], 0
  v_exp_f32 v96, v96
  v_mfma_f32_16x16x32_bf16 v[56:59], v[192:195], v[128:131], v[56:59]
  v_exp_f32 v97, v97
  v_mfma_f32_16x16x32_bf16 v[56:59], v[200:203], v[132:135], v[56:59]
  v_exp_f32 v98, v98
  v_mfma_f32_16x16x32_bf16 v[60:63], v[204:207], v[132:135], v[60:63]
  s_waitcnt lgkmcnt(0)
  v_exp_f32 v99, v99
  v_mfma_f32_16x16x32_bf16 v[60:63], v[196:199], v[128:131], v[60:63]
  v_cvt_pk_bf16_f32 v124, v96, v97
  v_cvt_pk_bf16_f32 v125, v98, v99
  v_smfmac_f32_16x16x64_bf16 v[80:83], v[172:175], v[128:135], v255
  ds_read_b128 v[176:179], v248 offset:34816
  ds_read_b128 v[180:183], v248 offset:35840
  v_exp_f32 v100, v100
  v_exp_f32 v101, v101
  v_exp_f32 v102, v102
  v_exp_f32 v103, v103
  v_cvt_pk_bf16_f32 v126, v100, v101
  v_cvt_pk_bf16_f32 v127, v102, v103
  v_exp_f32 v104, v104
  v_exp_f32 v105, v105
  v_exp_f32 v106, v106
  v_exp_f32 v107, v107
  v_exp_f32 v108, v108
  v_exp_f32 v109, v109
  v_exp_f32 v110, v110
  v_mfma_f32_16x16x32_bf16 v[88:91], v[136:139], v[32:35], 0
  s_add_u32 s79, s79, s81
  v_cvt_pk_bf16_f32 v128, v104, v105
  v_cvt_pk_bf16_f32 v129, v106, v107
  v_mfma_f32_16x16x32_bf16 v[92:95], v[140:143], v[32:35], 0
  s_add_u32 s76, s76, 1
  v_exp_f32 v111, v111
  v_mfma_f32_16x16x32_bf16 v[96:99], v[144:147], v[32:35], 0
  v_cvt_pk_bf16_f32 v130, v108, v109
  v_cvt_pk_bf16_f32 v131, v110, v111
  v_mfma_f32_16x16x32_bf16 v[100:103], v[148:151], v[32:35], 0
  v_exp_f32 v112, v112
  v_mfma_f32_16x16x32_bf16 v[64:67], v[192:195], v[120:123], v[64:67]
  s_cmp_lt_u32 s76, 4
  v_exp_f32 v113, v113
  v_mfma_f32_16x16x32_bf16 v[64:67], v[200:203], v[124:127], v[64:67]
  v_exp_f32 v114, v114
  v_mfma_f32_16x16x32_bf16 v[68:71], v[204:207], v[124:127], v[68:71]
  s_waitcnt lgkmcnt(0)
  v_exp_f32 v115, v115
  v_mfma_f32_16x16x32_bf16 v[68:71], v[196:199], v[120:123], v[68:71]
  v_cvt_pk_bf16_f32 v132, v112, v113
  v_cvt_pk_bf16_f32 v133, v114, v115
  v_smfmac_f32_16x16x64_bf16 v[84:87], v[168:171], v[120:127], v255
  ds_read_b128 v[184:187], v248 offset:38912
  ds_read_b128 v[188:191], v248 offset:39936
  v_exp_f32 v116, v116
  v_exp_f32 v117, v117
  v_exp_f32 v118, v118
  v_exp_f32 v119, v119
  v_cvt_pk_bf16_f32 v134, v116, v117
  v_cvt_pk_bf16_f32 v135, v118, v119
  s_cbranch_scc1 L_att
  s_nop 0
  v_smfmac_f32_16x16x64_bf16 v[84:87], v[172:175], v[128:135], v255
  v_mfma_f32_16x16x32_bf16 v[72:75], v[192:195], v[128:131], v[72:75]
  v_mfma_f32_16x16x32_bf16 v[72:75], v[200:203], v[132:135], v[72:75]
  v_mfma_f32_16x16x32_bf16 v[76:79], v[204:207], v[132:135], v[76:79]
  v_mfma_f32_16x16x32_bf16 v[76:79], v[196:199], v[128:131], v[76:79]
  s_mov_b32 s76, 0
L_attfin:
  v_add_f32 v24, v80, v81
  v_rcp_f32 v22, v24
  s_nop 0
  v_mul_f32 v22, v22, v253
  v_mul_f32 v48, v48, v22
  v_mul_f32 v49, v49, v22
  v_cvt_pk_bf16_f32 v88, v48, v49
  v_mul_f32 v50, v50, v22
  v_mul_f32 v51, v51, v22
  v_cvt_pk_bf16_f32 v89, v50, v51
  v_mul_f32 v52, v52, v22
  v_mul_f32 v53, v53, v22
  v_cvt_pk_bf16_f32 v90, v52, v53
  v_mul_f32 v54, v54, v22
  v_mul_f32 v55, v55, v22
  v_cvt_pk_bf16_f32 v91, v54, v55
  v_add_f32 v25, v82, v83
  v_rcp_f32 v22, v25
  v_permlane16_swap_b32 v88, v90
  v_permlane16_swap_b32 v89, v91
  buffer_store_dwordx4 v[88:91], v31, s[48:51], s82 offen offset:0 sc1
  v_mul_f32 v22, v22, v254
  v_mul_f32 v56, v56, v22
  v_mul_f32 v57, v57, v22
  v_cvt_pk_bf16_f32 v92, v56, v57
  v_mul_f32 v58, v58, v22
  v_mul_f32 v59, v59, v22
  v_cvt_pk_bf16_f32 v93, v58, v59
  v_mul_f32 v60, v60, v22
  v_mul_f32 v61, v61, v22
  v_cvt_pk_bf16_f32 v94, v60, v61
  v_mul_f32 v62, v62, v22
  v_mul_f32 v63, v63, v22
  v_cvt_pk_bf16_f32 v95, v62, v63
  v_add_f32 v26, v84, v85
  v_rcp_f32 v22, v26
  v_permlane16_swap_b32 v92, v94
  v_permlane16_swap_b32 v93, v95
  buffer_store_dwordx4 v[92:95], v31, s[48:51], s82 offen offset:1024 sc1
  v_mul_f32 v22, v22, v253
  v_mul_f32 v64, v64, v22
  v_mul_f32 v65, v65, v22
  v_cvt_pk_bf16_f32 v96, v64, v65
  v_mul_f32 v66, v66, v22
  v_mul_f32 v67, v67, v22
  v_cvt_pk_bf16_f32 v97, v66, v67
  v_mul_f32 v68, v68, v22
  v_mul_f32 v69, v69, v22
  v_cvt_pk_bf16_f32 v98, v68, v69
  v_mul_f32 v70, v70, v22
  v_mul_f32 v71, v71, v22
  v_cvt_pk_bf16_f32 v99, v70, v71
  v_add_f32 v27, v86, v87
  v_rcp_f32 v22, v27
  v_permlane16_swap_b32 v96, v98
  v_permlane16_swap_b32 v97, v99
  buffer_store_dwordx4 v[96:99], v31, s[48:51], s83 offen offset:0 sc1
  v_mul_f32 v22, v22, v254
  v_mul_f32 v72, v72, v22
  v_mul_f32 v73, v73, v22
  v_cvt_pk_bf16_f32 v100, v72, v73
  v_mul_f32 v74, v74, v22
  v_mul_f32 v75, v75, v22
  v_cvt_pk_bf16_f32 v101, v74, v75
  v_mul_f32 v76, v76, v22
  v_mul_f32 v77, v77, v22
  v_cvt_pk_bf16_f32 v102, v76, v77
  v_mul_f32 v78, v78, v22
  v_mul_f32 v79, v79, v22
  v_cvt_pk_bf16_f32 v103, v78, v79
  s_nop 1
  v_permlane16_swap_b32 v100, v102
  v_permlane16_swap_b32 v101, v103
  buffer_store_dwordx4 v[100:103], v31, s[48:51], s83 offen offset:1024 sc1
  s_cmp_lg_u32 s76, 0
  s_cbranch_scc1 L_attok
  s_waitcnt vmcnt(4) lgkmcnt(0)
  ds_add_u32 v251, v252 offset:12
  s_mov_b32 s70, 729808896
  s_mov_b32 s71, 1904214016
  v_max3_f32 v28, v24, v25, v26
  v_max_f32 v28, v28, v27
  v_mov_b32 v29, 0
  v_pk_fma_f32 v[28:29], v[48:49], 0, v[28:29]
  v_pk_fma_f32 v[28:29], v[50:51], 0, v[28:29]
  v_pk_fma_f32 v[28:29], v[52:53], 0, v[28:29]
  v_pk_fma_f32 v[28:29], v[54:55], 0, v[28:29]
  v_pk_fma_f32 v[28:29], v[56:57], 0, v[28:29]
  v_pk_fma_f32 v[28:29], v[58:59], 0, v[28:29]
  v_pk_fma_f32 v[28:29], v[60:61], 0, v[28:29]
  v_pk_fma_f32 v[28:29], v[62:63], 0, v[28:29]
  v_pk_fma_f32 v[28:29], v[64:65], 0, v[28:29]
  v_pk_fma_f32 v[28:29], v[66:67], 0, v[28:29]
  v_pk_fma_f32 v[28:29], v[68:69], 0, v[28:29]
  v_pk_fma_f32 v[28:29], v[70:71], 0, v[28:29]
  v_pk_fma_f32 v[28:29], v[72:73], 0, v[28:29]
  v_pk_fma_f32 v[28:29], v[74:75], 0, v[28:29]
  v_pk_fma_f32 v[28:29], v[76:77], 0, v[28:29]
  v_pk_fma_f32 v[28:29], v[78:79], 0, v[28:29]
  v_pk_fma_f32 v[28:29], v[24:25], 0, v[28:29]
  v_pk_fma_f32 v[28:29], v[26:27], 0, v[28:29]
  v_add_f32 v28, v28, v29
  v_min3_f32 v29, v24, v25, v26
  v_min_f32 v29, v29, v27
  v_cmp_nle_f32 vcc, v28, s71
  v_cmp_nge_f32 s[72:73], v29, s70
  s_or_b64 vcc, vcc, s[72:73]
  s_cbranch_vccnz L_slow
L_attok:
  s_and_b32 s71, s100, 3
  s_and_b32 s72, s100, 12
  s_lshr_b32 s72, 12321, s72
  s_and_b32 s72, s72, 3
  s_lshl_b32 s70, s64, 13
  s_lshl_b32 s71, s71, 7
  s_add_u32 s70, s70, s71
  s_lshl2_add_u32 s70, s72, s70
  s_add_u32 s70, s70, 19169296
  v_mov_b32 v17, 155656
  v_mov_b32 v15, 1
  s_waitcnt vmcnt(0)
  s_mov_b64 exec, 1
  ds_add_rtn_u32 v16, v17, v15
  s_mov_b64 exec, 0xffff
  v_lshlrev_b32 v17, 9, v0
  s_waitcnt lgkmcnt(0)
  v_readfirstlane_b32 s71, v16
  s_cmp_eq_u32 s71, 3
  s_cbranch_scc0 L_nofl_140
  buffer_store_dword v15, v17, s[48:51], s70 offen sc1
L_nofl_140:
  s_mov_b64 exec, -1
  s_endpgm
L_attwo:
  s_mov_b32 s60, s12
  s_mov_b32 s61, s13
  s_mov_b32 s62, 2097152
  s_mov_b32 s63, 0x20000
  s_lshl_b32 s79, s69, 17
  s_add_u32 s79, s79, 589824
  s_mov_b32 s81, 65536
  s_mov_b32 s77, 983040
  v_mov_b64 v[240:241], v[244:245]
  v_mov_b64 v[242:243], v[246:247]
  s_branch L_attwo_r
L_regdma1_0:
  s_waitcnt vmcnt(0)
  v_add_u32 v22, s80, v15
  ds_write_b128 v22, v[208:211] offset:32768
  ds_write_b128 v22, v[212:215] offset:33792
  s_branch L_nodma1_0
L_regdma1_2:
  ds_write_b128 v22, v[216:219] offset:34816
  ds_write_b128 v22, v[220:223] offset:35840
  s_branch L_nodma1_2
L_regdma2_0:
  s_waitcnt vmcnt(0)
  v_add_u32 v22, s80, v15
  ds_write_b128 v22, v[224:227] offset:49152
  ds_write_b128 v22, v[228:231] offset:50176
  s_branch L_nodma2_0
L_regdma2_2:
  ds_write_b128 v22, v[232:235] offset:51200
  ds_write_b128 v22, v[236:239] offset:52224
  s_branch L_nodma2_2
L_attspin0:
  s_mov_b32 s72, 262144
L_attspin0b:
  ds_read_b32 v20, v249
  s_waitcnt lgkmcnt(0)
  v_cmp_gt_u32 vcc, s78, v20
  s_sub_u32 s72, s72, 1
  s_cbranch_vccz L_attgo0
  s_cmp_lg_u32 s72, 0
  s_cbranch_scc1 L_attspin0b
  s_branch L_attgo0
L_attspin1:
  s_mov_b32 s72, 262144
L_attspin1b:
  ds_read_b32 v20, v249
  s_waitcnt lgkmcnt(0)
  v_cmp_gt_u32 vcc, s78, v20
  s_sub_u32 s72, s72, 1
  s_cbranch_vccz L_attgo1
  s_cmp_lg_u32 s72, 0
  s_cbranch_scc1 L_attspin1b
  s_branch L_attgo1
L_attspin2:
  s_mov_b32 s72, 262144
L_attspin2b:
  ds_read_b32 v20, v249
  s_waitcnt lgkmcnt(0)
  v_cmp_gt_u32 vcc, s78, v20
  s_sub_u32 s72, s72, 1
  s_cbranch_vccz L_attgo2
  s_cmp_lg_u32 s72, 0
  s_cbranch_scc1 L_attspin2b
  s_branch L_attgo2
L_attspin3:
  s_mov_b32 s72, 262144
L_attspin3b:
  ds_read_b32 v20, v249
  s_waitcnt lgkmcnt(0)
  v_cmp_gt_u32 vcc, s78, v20
  s_sub_u32 s72, s72, 1
  s_cbranch_vccz L_attgo3
  s_cmp_lg_u32 s72, 0
  s_cbranch_scc1 L_attspin3b
  s_branch L_attgo3
L_slow:
  s_add_u32 s60, s30, 18874368
  s_addc_u32 s61, s31, 0
  s_mov_b32 s62, 0x40000
  s_mov_b32 s63, 0x20000
  s_waitcnt vmcnt(0) lgkmcnt(0)
  s_mov_b32 s70, 0
  s_mov_b32 s76, 1
  v_mov_b32 v24, 0xff800000
  v_mov_b32 v25, 0xff800000
  v_mov_b32 v26, 0xff800000
  v_mov_b32 v27, 0xff800000
L_slow1:
  buffer_load_dwordx4 v[136:139], v15, s[60:63], s70 offen sc1
  buffer_load_dwordx4 v[140:143], v15, s[60:63], s70 offen offset:1024 sc1
  s_waitcnt vmcnt(0)
  v_mfma_f32_16x16x32_bf16 v[88:91], v[136:139], v[32:35], 0
  v_mfma_f32_16x16x32_bf16 v[92:95], v[140:143], v[32:35], 0
  v_mfma_f32_16x16x32_bf16 v[96:99], v[136:139], v[36:39], 0
  v_mfma_f32_16x16x32_bf16 v[100:103], v[140:143], v[36:39], 0
  v_mfma_f32_16x16x32_bf16 v[104:107], v[136:139], v[40:43], 0
  v_mfma_f32_16x16x32_bf16 v[108:111], v[140:143], v[40:43], 0
  v_mfma_f32_16x16x32_bf16 v[112:115], v[136:139], v[44:47], 0
  v_mfma_f32_16x16x32_bf16 v[116:119], v[140:143], v[44:47], 0
  s_nop 7
  v_max3_f32 v24, v88, v89, v24
  v_max3_f32 v24, v90, v91, v24
  v_max3_f32 v24, v92, v93, v24
  v_max3_f32 v24, v94, v95, v24
  v_max3_f32 v25, v96, v97, v25
  v_max3_f32 v25, v98, v99, v25
  v_max3_f32 v25, v100, v101, v25
  v_max3_f32 v25, v102, v103, v25
  v_max3_f32 v26, v104, v105, v26
  v_max3_f32 v26, v106, v107, v26
  v_max3_f32 v26, v108, v109, v26
  v_max3_f32 v26, v110, v111, v26
  v_max3_f32 v27, v112, v113, v27
  v_max3_f32 v27, v114, v115, v27
  v_max3_f32 v27, v116, v117, v27
  v_max3_f32 v27, v118, v119, v27
  s_add_u32 s70, s70, 4096
  s_cmp_lt_u32 s70, 0x40000
  s_cbranch_scc1 L_slow1
  v_mov_b32 v16, v24
  v_mov_b32 v17, v25
  v_mov_b32 v18, v26
  v_mov_b32 v19, v27
  s_nop 1
  v_permlane16_swap_b32 v24, v16
  v_permlane16_swap_b32 v25, v17
  v_permlane16_swap_b32 v26, v18
  v_permlane16_swap_b32 v27, v19
  v_max_f32 v24, v24, v16
  v_max_f32 v25, v25, v17
  v_max_f32 v26, v26, v18
  v_max_f32 v27, v27, v19
  v_mov_b32 v16, v24
  v_mov_b32 v17, v25
  v_mov_b32 v18, v26
  v_mov_b32 v19, v27
  s_nop 1
  v_permlane32_swap_b32 v24, v16
  v_permlane32_swap_b32 v25, v17
  v_permlane32_swap_b32 v26, v18
  v_permlane32_swap_b32 v27, v19
  v_max_f32 v24, v24, v16
  v_max_f32 v25, v25, v17
  v_max_f32 v26, v26, v18
  v_max_f32 v27, v27, v19
  v_sub_f32 v208, 0, v24
  v_sub_f32 v209, 0, v24
  v_sub_f32 v210, 0, v24
  v_sub_f32 v211, 0, v24
  v_sub_f32 v212, 0, v25
  v_sub_f32 v213, 0, v25
  v_sub_f32 v214, 0, v25
  v_sub_f32 v215, 0, v25
  v_sub_f32 v216, 0, v26
  v_sub_f32 v217, 0, v26
  v_sub_f32 v218, 0, v26
  v_sub_f32 v219, 0, v26
  v_sub_f32 v220, 0, v27
  v_sub_f32 v221, 0, v27
  v_sub_f32 v222, 0, v27
  v_sub_f32 v223, 0, v27
  v_mov_b64 v[48:49], 0
  v_mov_b64 v[50:51], 0
  v_mov_b64 v[52:53], 0
  v_mov_b64 v[54:55], 0
  v_mov_b64 v[56:57], 0
  v_mov_b64 v[58:59], 0
  v_mov_b64 v[60:61], 0
  v_mov_b64 v[62:63], 0
  v_mov_b64 v[64:65], 0
  v_mov_b64 v[66:67], 0
  v_mov_b64 v[68:69], 0
  v_mov_b64 v[70:71], 0
  v_mov_b64 v[72:73], 0
  v_mov_b64 v[74:75], 0
  v_mov_b64 v[76:77], 0
  v_mov_b64 v[78:79], 0
  v_mov_b64 v[80:81], 0
  v_mov_b64 v[82:83], 0
  v_mov_b64 v[84:85], 0
  v_mov_b64 v[86:87], 0
  s_mov_b32 s70, 0
L_slow2:
  buffer_load_dwordx4 v[136:139], v15, s[60:63], s70 offen offset:0 sc1
  buffer_load_dwordx4 v[140:143], v15, s[60:63], s70 offen offset:1024 sc1
  buffer_load_dwordx4 v[176:179], v15, s[60:63], s70 offen offset:2048 sc1
  buffer_load_dwordx4 v[180:183], v15, s[60:63], s70 offen offset:3072 sc1
  s_add_u32 s70, s70, 4096
  buffer_load_dwordx4 v[144:147], v15, s[60:63], s70 offen offset:0 sc1
  buffer_load_dwordx4 v[148:151], v15, s[60:63], s70 offen offset:1024 sc1
  buffer_load_dwordx4 v[184:187], v15, s[60:63], s70 offen offset:2048 sc1
  buffer_load_dwordx4 v[188:191], v15, s[60:63], s70 offen offset:3072 sc1
  s_add_u32 s70, s70, 4096
  s_waitcnt vmcnt(0)
  v_mfma_f32_16x16x32_bf16 v[88:91], v[136:139], v[32:35], v[208:211]
  v_mfma_f32_16x16x32_bf16 v[92:95], v[140:143], v[32:35], v[208:211]
  v_mfma_f32_16x16x32_bf16 v[96:99], v[144:147], v[32:35], v[208:211]
  v_mfma_f32_16x16x32_bf16 v[100:103], v[148:151], v[32:35], v[208:211]
  s_nop 7
  v_exp_f32 v88, v88
  v_exp_f32 v89, v89
  v_exp_f32 v90, v90
  v_exp_f32 v91, v91
  v_exp_f32 v92, v92
  v_exp_f32 v93, v93
  v_exp_f32 v94, v94
  v_exp_f32 v95, v95
  v_exp_f32 v96, v96
  v_exp_f32 v97, v97
  v_exp_f32 v98, v98
  v_exp_f32 v99, v99
  v_exp_f32 v100, v100
  v_exp_f32 v101, v101
  v_exp_f32 v102, v102
  v_exp_f32 v103, v103
  v_cvt_pk_bf16_f32 v120, v88, v89
  v_cvt_pk_bf16_f32 v121, v90, v91
  v_cvt_pk_bf16_f32 v122, v92, v93
  v_cvt_pk_bf16_f32 v123, v94, v95
  v_cvt_pk_bf16_f32 v124, v96, v97
  v_cvt_pk_bf16_f32 v125, v98, v99
  v_cvt_pk_bf16_f32 v126, v100, v101
  v_cvt_pk_bf16_f32 v127, v102, v103
  s_nop 1
  v_mfma_f32_16x16x32_bf16 v[48:51], v[176:179], v[120:123], v[48:51]
  v_mfma_f32_16x16x32_bf16 v[48:51], v[184:187], v[124:127], v[48:51]
  v_mfma_f32_16x16x32_bf16 v[52:55], v[188:191], v[124:127], v[52:55]
  v_mfma_f32_16x16x32_bf16 v[52:55], v[180:183], v[120:123], v[52:55]
  v_smfmac_f32_16x16x64_bf16 v[80:83], v[168:171], v[120:127], v255
  v_mfma_f32_16x16x32_bf16 v[88:91], v[136:139], v[36:39], v[212:215]
  v_mfma_f32_16x16x32_bf16 v[92:95], v[140:143], v[36:39], v[212:215]
  v_mfma_f32_16x16x32_bf16 v[96:99], v[144:147], v[36:39], v[212:215]
  v_mfma_f32_16x16x32_bf16 v[100:103], v[148:151], v[36:39], v[212:215]
  s_nop 7
  v_exp_f32 v88, v88
  v_exp_f32 v89, v89
  v_exp_f32 v90, v90
  v_exp_f32 v91, v91
  v_exp_f32 v92, v92
  v_exp_f32 v93, v93
  v_exp_f32 v94, v94
  v_exp_f32 v95, v95
  v_exp_f32 v96, v96
  v_exp_f32 v97, v97
  v_exp_f32 v98, v98
  v_exp_f32 v99, v99
  v_exp_f32 v100, v100
  v_exp_f32 v101, v101
  v_exp_f32 v102, v102
  v_exp_f32 v103, v103
  v_cvt_pk_bf16_f32 v120, v88, v89
  v_cvt_pk_bf16_f32 v121, v90, v91
  v_cvt_pk_bf16_f32 v122, v92, v93
  v_cvt_pk_bf16_f32 v123, v94, v95
  v_cvt_pk_bf16_f32 v124, v96, v97
  v_cvt_pk_bf16_f32 v125, v98, v99
  v_cvt_pk_bf16_f32 v126, v100, v101
  v_cvt_pk_bf16_f32 v127, v102, v103
  s_nop 1
  v_mfma_f32_16x16x32_bf16 v[56:59], v[176:179], v[120:123], v[56:59]
  v_mfma_f32_16x16x32_bf16 v[56:59], v[184:187], v[124:127], v[56:59]
  v_mfma_f32_16x16x32_bf16 v[60:63], v[188:191], v[124:127], v[60:63]
  v_mfma_f32_16x16x32_bf16 v[60:63], v[180:183], v[120:123], v[60:63]
  v_smfmac_f32_16x16x64_bf16 v[80:83], v[172:175], v[120:127], v255
  v_mfma_f32_16x16x32_bf16 v[88:91], v[136:139], v[40:43], v[216:219]
  v_mfma_f32_16x16x32_bf16 v[92:95], v[140:143], v[40:43], v[216:219]
  v_mfma_f32_16x16x32_bf16 v[96:99], v[144:147], v[40:43], v[216:219]
  v_mfma_f32_16x16x32_bf16 v[100:103], v[148:151], v[40:43], v[216:219]
  s_nop 7
  v_exp_f32 v88, v88
  v_exp_f32 v89, v89
  v_exp_f32 v90, v90
  v_exp_f32 v91, v91
  v_exp_f32 v92, v92
  v_exp_f32 v93, v93
  v_exp_f32 v94, v94
  v_exp_f32 v95, v95
  v_exp_f32 v96, v96
  v_exp_f32 v97, v97
  v_exp_f32 v98, v98
  v_exp_f32 v99, v99
  v_exp_f32 v100, v100
  v_exp_f32 v101, v101
  v_exp_f32 v102, v102
  v_exp_f32 v103, v103
  v_cvt_pk_bf16_f32 v120, v88, v89
  v_cvt_pk_bf16_f32 v121, v90, v91
  v_cvt_pk_bf16_f32 v122, v92, v93
  v_cvt_pk_bf16_f32 v123, v94, v95
  v_cvt_pk_bf16_f32 v124, v96, v97
  v_cvt_pk_bf16_f32 v125, v98, v99
  v_cvt_pk_bf16_f32 v126, v100, v101
  v_cvt_pk_bf16_f32 v127, v102, v103
  s_nop 1
  v_mfma_f32_16x16x32_bf16 v[64:67], v[176:179], v[120:123], v[64:67]
  v_mfma_f32_16x16x32_bf16 v[64:67], v[184:187], v[124:127], v[64:67]
  v_mfma_f32_16x16x32_bf16 v[68:71], v[188:191], v[124:127], v[68:71]
  v_mfma_f32_16x16x32_bf16 v[68:71], v[180:183], v[120:123], v[68:71]
  v_smfmac_f32_16x16x64_bf16 v[84:87], v[168:171], v[120:127], v255
  v_mfma_f32_16x16x32_bf16 v[88:91], v[136:139], v[44:47], v[220:223]
  v_mfma_f32_16x16x32_bf16 v[92:95], v[140:143], v[44:47], v[220:223]
  v_mfma_f32_16x16x32_bf16 v[96:99], v[144:147], v[44:47], v[220:223]
  v_mfma_f32_16x16x32_bf16 v[100:103], v[148:151], v[44:47], v[220:223]
  s_nop 7
  v_exp_f32 v88, v88
  v_exp_f32 v89, v89
  v_exp_f32 v90, v90
  v_exp_f32 v91, v91
  v_exp_f32 v92, v92
  v_exp_f32 v93, v93
  v_exp_f32 v94, v94
  v_exp_f32 v95, v95
  v_exp_f32 v96, v96
  v_exp_f32 v97, v97
  v_exp_f32 v98, v98
  v_exp_f32 v99, v99
  v_exp_f32 v100, v100
  v_exp_f32 v101, v101
  v_exp_f32 v102, v102
  v_exp_f32 v103, v103
  v_cvt_pk_bf16_f32 v120, v88, v89
  v_cvt_pk_bf16_f32 v121, v90, v91
  v_cvt_pk_bf16_f32 v122, v92, v93
  v_cvt_pk_bf16_f32 v123, v94, v95
  v_cvt_pk_bf16_f32 v124, v96, v97
  v_cvt_pk_bf16_f32 v125, v98, v99
  v_cvt_pk_bf16_f32 v126, v100, v101
  v_cvt_pk_bf16_f32 v127, v102, v103
  s_nop 1
  v_mfma_f32_16x16x32_bf16 v[72:75], v[176:179], v[120:123], v[72:75]
  v_mfma_f32_16x16x32_bf16 v[72:75], v[184:187], v[124:127], v[72:75]
  v_mfma_f32_16x16x32_bf16 v[76:79], v[188:191], v[124:127], v[76:79]
  v_mfma_f32_16x16x32_bf16 v[76:79], v[180:183], v[120:123], v[76:79]
  v_smfmac_f32_16x16x64_bf16 v[84:87], v[172:175], v[120:127], v255
  s_cmp_lt_u32 s70, 0x40000
  s_cbranch_scc1 L_slow2
  s_nop 7
  s_nop 3
  s_branch L_attfin
L_exit:
  s_endpgm
L_codeend:
.section .rodata,"a"
.p2align 6
.amdhsa_kernel gated_mix__grouped_kv_mqa__dense_activation_squared_relu__prompt_kernel
  .amdhsa_next_free_vgpr 256
  .amdhsa_next_free_sgpr 102
  .amdhsa_accum_offset 256
  .amdhsa_group_segment_fixed_size 0
  .amdhsa_kernarg_size 112
  .amdhsa_user_sgpr_count 2
  .amdhsa_user_sgpr_kernarg_segment_ptr 1
  .amdhsa_system_sgpr_workgroup_id_x 1
.end_amdhsa_kernel
```
